```python
import torch

def _softmax(x, axis=-1):
    return torch.softmax(x, dim=axis)
def _gelu(x):
    return torch.nn.functional.gelu(x, approximate="tanh")
def _silu(x):
    return torch.nn.functional.silu(x)
def _sigmoid(x):
    return torch.sigmoid(x)
def _layernorm(x, axis=-1, eps=1e-5):
    m = x.mean(dim=axis, keepdim=True)
    v = x.var(dim=axis, keepdim=True, unbiased=False)
    return (x - m) / torch.sqrt(v + eps)
def _scatter_add(tgt, idx, src, axis=0):
    return tgt.clone().index_add_(axis, idx, src)
def _segment_sum(src, seg, n):
    out = torch.zeros((n,) + src.shape[1:], dtype=src.dtype)
    return out.index_add_(0, seg, src)
def _pad(x, pw):
    flat = tuple(v for pair in reversed(pw) for v in pair)
    return torch.nn.functional.pad(x, flat)

kernel_name = 'gated_mix__sliding_block__mixer_s_mlp__prompt'

def setup_inputs():

    _w = (lambda a: (lambda t: t.to(torch.bfloat16) if t.is_floating_point() else t)(torch.as_tensor(a)))
    def _A_setup():
        B, S, D = 1, 2048, 512
        return {
            "x": _w((lambda *s: torch.randn(*s, dtype=torch.bfloat16) * 0.05)(B, S, D)),
            "wqkv": _w((lambda *s: torch.randn(*s, dtype=torch.bfloat16) * 1.6)(D, 3 * D)),
            "wo": _w((lambda *s: torch.randn(*s, dtype=torch.bfloat16) * 0.4)(D, D)),
        }
    _A_in = _A_setup()

    def _B_setup():
        B, S, D, F = 1, 2048, 512, 1792
        return {
            "x":  _w((lambda *s: torch.randn(*s, dtype=torch.bfloat16) * 0.05)(B, S, D)),
            "w1": _w((lambda *s: torch.randn(*s, dtype=torch.bfloat16) * 3.2)(D, D) * (D ** -0.5)),
            "w2": _w((lambda *s: torch.randn(*s, dtype=torch.bfloat16) * 3.2)(D, D) * (D ** -0.5)),
            "w3": _w((lambda *s: torch.randn(*s, dtype=torch.bfloat16) * 3.2)(D, F) * (D ** -0.5)),
            "w4": _w((lambda *s: torch.randn(*s, dtype=torch.bfloat16) * 3.2)(F, D) * (F ** -0.5)),
        }
    _B_in = _B_setup()

    return {
        "A_x": _A_in["x"],
        "A_wqkv": _A_in["wqkv"],
        "A_wo": _A_in["wo"],
        "B_x": _B_in["x"],
        "B_w1": _B_in["w1"],
        "B_w2": _B_in["w2"],
        "B_w3": _B_in["w3"],
        "B_w4": _B_in["w4"],
        "gate_w": _w((lambda *s: torch.randn(*s, dtype=torch.bfloat16) * 0.05)(512) * 16.0),
    }

def reference(A_x, A_wqkv, A_wo, B_x, B_w1, B_w2, B_w3, B_w4, gate_w):
    def _A_ref(x, wqkv, wo):
        B, S, D = x.shape
        H = 32; Dh = D // H; W = 256
        qkv = (lambda x, *d: x.permute(*d))((x @ wqkv).reshape(B, S, 3, H, Dh), 2, 0, 3, 1, 4)
        q, k, v = qkv[0], qkv[1], qkv[2]
        scores = torch.einsum("bhqd,bhkd->bhqk", q, k) * (Dh ** -0.5)
        idx = torch.arange(S)
        mask = (idx[:, None] - idx[None, :] >= 0) & (idx[:, None] - idx[None, :] < W)
        scores = torch.where(mask[None, None], scores, -1e9)
        p = _softmax(scores, axis=-1)
        o = torch.einsum("bhqk,bhkd->bhqd", p, v)
        return (lambda x, *d: x.permute(*d))(o, 0, 2, 1, 3).reshape(B, S, D) @ wo

    def _B_ref(x, w1, w2, w3, w4):
        B, S, D = x.shape
        h = _gelu(_layernorm(x, axis=-1) @ w1)
        c = D // 4
        g0 = _pad(h[:, :, 0*c:1*c], ((0, 0), (1, 0), (0, 0)))[:, :S, :]
        g1 = _pad(h[:, :, 1*c:2*c], ((0, 0), (0, 1), (0, 0)))[:, 1:, :]
        g2 = _pad(h[:, :, 2*c:3*c], ((0, 0), (2, 0), (0, 0)))[:, :S, :]
        g3 = _pad(h[:, :, 3*c:   ], ((0, 0), (0, 2), (0, 0)))[:, 2:, :]
        hs = torch.concatenate([g0, g1, g2, g3], axis=-1) @ w2
        x1 = x + hs
        h2 = _gelu(_layernorm(x1, axis=-1) @ w3) @ w4
        return x1 + h2

    x = A_x
    g = _sigmoid((x * gate_w).sum(-1, keepdims=True))
    a = _A_ref(x, A_wqkv, A_wo)
    b = _B_ref(x, B_w1, B_w2, B_w3, B_w4)
    return g * a + (1 - g) * b
```

```asm
; @launch grid=(256,1,1) block=(512,1,1) lds=163840
.amdgcn_target "amdgcn-amd-amdhsa--gfx950"
.text
.globl gated_mix__sliding_block__mixer_s_mlp__prompt_kernel
.p2align 8
.type gated_mix__sliding_block__mixer_s_mlp__prompt_kernel,@function
gated_mix__sliding_block__mixer_s_mlp__prompt_kernel:
    s_cmp_ge_u32 s2, 256
    s_cbranch_scc1 L_end_1
    s_load_dwordx16 s[4:19], s[0:1], 0
    s_load_dwordx8 s[20:27], s[0:1], 64
    v_lshrrev_b32 v1, 6, v0
    s_and_b32 s56, s2, 7
    s_lshr_b32 s55, s2, 3
    v_readfirstlane_b32 s44, v1
    v_and_b32 v1, 63, v0
    v_lshlrev_b32 v2, 4, v1
    s_lshr_b32 s48, s56, 1
    s_lshl_b32 s48, s48, 3
    s_and_b32 s57, s55, 7
    s_add_u32 s48, s48, s57
    s_lshr_b32 s49, s55, 3
    s_lshl_b32 s49, s49, 1
    s_and_b32 s57, s56, 1
    s_add_u32 s49, s49, s57
    s_lshr_b32 s54, s49, 1
    s_lshr_b32 s57, s48, 1
    s_add_u32 s54, s54, s57
    s_and_b32 s54, s54, 3
    s_and_b32 s57, s55, 3
    s_lshr_b32 s51, s55, 2
    s_lshl_b32 s50, s56, 2
    s_add_u32 s50, s50, s57
    s_lshr_b32 s52, s56, 1
    s_lshl_b32 s52, s52, 2
    s_add_u32 s52, s52, s57
    s_cmp_lt_u32 s51, 2
    s_cselect_b32 s53, 8, 6
    s_bitcmp1_b32 s56, 0
    s_cselect_b32 s53, s53, 0
    s_add_u32 s53, s53, s51
    s_lshr_b32 s57, s48, 1
    s_bitcmp1_b32 s48, 0
    s_cselect_b32 s57, 15, s57
    s_cmp_lg_u32 s49, 3
    s_cselect_b32 s53, s53, s57
    s_and_b32 s50, s56, 1
    s_lshl_b32 s50, s50, 4
    s_and_b32 s57, s55, 15
    s_add_u32 s50, s50, s57
    s_and_b32 s51, s56, 6
    s_lshr_b32 s57, s55, 4
    s_add_u32 s51, s51, s57
    s_and_b32 s45, s44, 3
    s_lshr_b32 s46, s45, 1
    s_and_b32 s47, s45, 1
    s_cmp_ge_u32 s44, 4
    s_cbranch_scc0 L_compute_3
L_loader_2:
    s_mov_b32 s3, 1
    s_lshl_b32 s63, s45, 12
    v_lshrrev_b32 v32, 3, v1
    v_lshrrev_b32 v33, 4, v1
    v_and_b32 v34, 7, v1
    v_xor_b32 v35, v34, v33
    v_lshlrev_b32 v35, 4, v35
    v_lshl_add_u32 v24, v32, 10, v35
    v_xor_b32 v25, 64, v24
    v_add_u32 v25, 7168, v25
    v_add_u32 v26, 14336, v24
    v_add_u32 v27, 14336, v25
    s_lshr_b32 s64, s48, 1
    s_lshl_b32 s64, s64, 17
    s_lshl_b32 s56, s45, 15
    s_add_u32 s64, s64, s56
    s_and_b32 s58, s48, 1
    s_lshl_b32 s56, s58, 7
    s_add_u32 s64, s64, s56
    s_lshl_b32 s67, s58, 11
    s_add_u32 s67, s67, 1024
    v_and_b32 v33, 1, v33
    v_lshlrev_b32 v33, 2, v33
    v_xor_b32 v34, v34, v33
    v_mul_u32_u24 v40, s67, v32
    v_lshl_add_u32 v40, v34, 4, v40
    s_lshl_b32 s56, s67, 3
    s_sub_u32 s56, s56, 1024
    v_add_u32 v41, s56, v40
    v_add_u32 v42, s56, v41
    v_add_u32 v43, s56, v42
    s_mul_i32 s65, s67, s45
    s_lshl_b32 s65, s65, 5
    s_lshl_b32 s56, s49, 7
    s_add_u32 s65, s65, s56
    s_lshl_b32 s67, s67, 7
    s_waitcnt lgkmcnt(0)
    s_mov_b32 s32, s4
    s_and_b32 s33, s5, 0xffff
    s_mov_b32 s34, 2097152
    s_mov_b32 s35, 0x20000
    s_add_u32 m0, s63, 0
    s_add_u32 s57, s54, 0
    s_and_b32 s57, s57, 3
    s_lshl_b32 s56, s57, 8
    s_add_u32 s56, s56, s64
    buffer_load_dwordx4 v24, s[32:35], s56 offen offset:0  lds
    buffer_load_dwordx4 v25, s[32:35], s56 offen offset:1024  lds
    buffer_load_dwordx4 v26, s[32:35], s56 offen offset:2048  lds
    buffer_load_dwordx4 v27, s[32:35], s56 offen offset:3072  lds
    s_bitcmp1_b32 s48, 0
    s_cselect_b64 s[36:37], s[6:7], s[12:13]
    s_cselect_b32 s38, 1048576, 0
    s_add_u32 s38, s38, 524288
    s_and_b32 s37, s37, 0xffff
    s_mov_b32 s39, 0x20000
    s_add_u32 m0, s63, 32768
    s_add_u32 s57, s54, 0
    s_and_b32 s57, s57, 3
    s_mul_i32 s56, s57, s67
    s_add_u32 s56, s56, s65
    buffer_load_dwordx4 v40, s[36:39], s56 offen offset:0  lds
    buffer_load_dwordx4 v41, s[36:39], s56 offen offset:1024  lds
    buffer_load_dwordx4 v42, s[36:39], s56 offen offset:2048  lds
    buffer_load_dwordx4 v43, s[36:39], s56 offen offset:3072  lds
    s_add_u32 m0, s63, 16384
    s_add_u32 s57, s54, 0
    s_and_b32 s57, s57, 3
    s_lshl_b32 s56, s57, 8
    s_add_u32 s56, s56, s64
    s_xor_b32 s56, s56, 128
    buffer_load_dwordx4 v24, s[32:35], s56 offen offset:0  lds
    buffer_load_dwordx4 v25, s[32:35], s56 offen offset:1024  lds
    buffer_load_dwordx4 v26, s[32:35], s56 offen offset:2048  lds
    buffer_load_dwordx4 v27, s[32:35], s56 offen offset:3072  lds
    s_branch L_lfar_5
L_compute_3:
    s_mov_b32 s3, 0
    s_getpc_b64 s[56:57]
L_pc_100001:
    s_lshl_b32 s58, s55, 2
    s_add_u32 s58, s58, s45
    s_lshl_b32 s58, s58, 9
    v_lshl_add_u32 v88, v1, 7, s58
    s_sub_u32 s56, s56, L_pc_100001-gated_mix__sliding_block__mixer_s_mlp__prompt_kernel
    s_subb_u32 s57, s57, 0
    v_cmp_gt_u32 vcc, L_end_1-gated_mix__sliding_block__mixer_s_mlp__prompt_kernel, v88
    s_and_b32 s58, vcc_lo, 15
    v_mov_b32 v89, s57
    v_add_co_u32 v88, vcc, s56, v88
    s_nop 1
    v_addc_co_u32 v89, vcc, 0, v89, vcc
    s_cmp_eq_u32 s58, 0
    s_cbranch_scc1 L_nopf_100002
    s_mov_b32 exec_lo, s58
    s_mov_b32 exec_hi, 0
    global_load_dword v111, v[88:89], off
    s_mov_b64 exec, -1
L_nopf_100002:
    s_waitcnt lgkmcnt(0)
    s_add_u32 s28, s26, 0
    s_addc_u32 s29, s27, 0
    s_and_b32 s29, s29, 0xffff
    s_mov_b32 s30, 268435456
    s_mov_b32 s31, 0x20000
    s_add_u32 s26, s26, 13107200
    s_addc_u32 s27, s27, 0
    s_mov_b32 s32, s20
    s_and_b32 s33, s21, 0xffff
    s_mov_b32 s34, 1024
    s_mov_b32 s35, 0x20000
    s_mov_b32 m0, 147456
    s_cmp_eq_u32 s45, 0
    s_cbranch_scc0 L_nog_100003
    buffer_load_dwordx4 v2, s[32:35], 0 offen lds
    buffer_load_dwordx4 v2, s[32:35], 0 offen offset:1024 lds
    buffer_load_dwordx4 v2, s[32:35], 0 offen offset:2048 lds
L_nog_100003:
    s_cmp_eq_u32 s55, 1
    s_cbranch_scc0 L_nz_100004
    v_mov_b32 v96, 0
    v_mov_b32 v97, 0
    v_mov_b32 v98, 0
    v_mov_b32 v99, 0
    s_and_b32 s56, s2, 7
    s_lshl_b32 s56, s56, 2
    s_add_u32 s56, s56, s45
    s_lshl_b32 s10, s56, 7
    s_add_u32 s10, s10, 524288
    s_load_dword s40, s[26:27], s10 glc
    s_load_dword s41, s[26:27], s10 offset:8192 glc
    s_lshl_b32 s56, s56, 11
    s_add_u32 s56, s56, 13107200
    buffer_store_dwordx4 v[96:99], v2, s[28:31], s56 offen offset:0 sc1
    buffer_store_dwordx4 v[96:99], v2, s[28:31], s56 offen offset:1024 sc1
L_nz_100004:
    v_and_b32 v89, 31, v1
    v_lshrrev_b32 v90, 5, v1
    s_lshl_b32 s63, s48, 1
    s_add_u32 s63, s63, s46
    s_lshl_b32 s62, s49, 1
    s_add_u32 s62, s62, s47
    s_mov_b32 s32, s4
    s_and_b32 s33, s5, 0xffff
    s_mov_b32 s34, 2097152
    s_mov_b32 s35, 0x20000
    v_lshlrev_b32 v91, 10, v89
    v_lshl_add_u32 v91, v90, 4, v91
    s_lshl_b32 s56, s63, 15
    s_lshl_b32 s57, s62, 6
    s_add_u32 s56, s56, s57
    buffer_load_dwordx4 v[4:7], v91, s[32:35], s56 offen
    buffer_load_dwordx4 v[8:11], v91, s[32:35], s56 offen offset:32
    v_mov_b32 v88, 0x3f803f80
    s_lshl_b32 s56, s45, 8
    s_add_u32 s56, s56, 150592
    v_lshl_add_u32 v91, v1, 2, s56
    ds_write_b32 v91, v88
    v_bfe_u32 v91, v1, 1, 3
    v_xor_b32 v91, v91, v90
    v_lshlrev_b32 v91, 4, v91
    v_lshl_add_u32 v76, v89, 7, v91
    s_lshl_b32 s56, s45, 12
    v_add_u32 v76, s56, v76
    v_xor_b32 v77, 32, v76
    v_xor_b32 v78, 64, v76
    v_xor_b32 v79, 96, v76
    v_lshrrev_b32 v91, 5, v1
    v_bfe_u32 v92, v1, 2, 2
    v_lshl_add_u32 v92, v91, 3, v92
    v_lshlrev_b32 v15, 7, v92
    v_bfe_u32 v92, v1, 3, 1
    v_xor_b32 v92, s47, v92
    v_lshl_add_u32 v15, v92, 6, v15
    v_bfe_u32 v92, v1, 4, 1
    v_lshl_add_u32 v15, v92, 5, v15
    v_and_b32 v92, 3, v1
    v_lshl_add_u32 v15, v92, 3, v15
    v_xor_b32 v0, 64, v15
    v_bfe_u32 v91, v1, 2, 1
    v_bfe_u32 v92, v1, 4, 1
    v_cmp_eq_u32 vcc, v91, v92
    v_and_b32 v91, 3, v1
    v_mov_b32 v92, 7
    v_cndmask_b32 v72, 0, v88, vcc
    v_cndmask_b32 v73, 0, v88, vcc
    v_cndmask_b32 v74, 0, v88, vcc
    v_cndmask_b32 v75, 0, v88, vcc
    v_cndmask_b32 v91, v92, v91, vcc
    v_mov_b32 v80, 148512
    v_cmp_eq_u32 vcc, 0, v91
    v_mov_b32 v92, 150592
    v_lshlrev_b32 v93, 4, v90
    v_cndmask_b32 v80, v80, v92, vcc
    v_cmp_eq_u32 vcc, 1, v91
    v_add_u32 v93, 147456, v93
    s_lshl_b32 s60, s54, 8
    v_cndmask_b32 v80, v80, v93, vcc
    v_add_u32 v81, s60, v80
    v_mov_b32 v82, 0
    v_mov_b32 v83, 0
    s_add_u32 s58, s48, 0
    s_and_b32 s58, s58, 3
    s_lshr_b32 s56, s58, 1
    s_add_u32 s56, s56, 1
    s_sub_u32 s57, 0, s56
    s_bitcmp1_b32 s58, 0
    s_cselect_b32 s56, s56, s57
    s_lshl_b32 s57, s46, 5
    s_add_u32 s56, s56, s57
    v_add_u32 v91, s56, v89
    v_cmp_gt_u32 vcc, 64, v91
    v_lshrrev_b32 v92, 5, v91
    v_and_b32 v93, 31, v91
    v_lshl_add_u32 v93, v90, 5, v93
    v_lshlrev_b32 v93, 4, v93
    v_lshl_add_u32 v93, v92, 13, v93
    v_add_u32 v93, 147456, v93
    v_and_b32 v91, 1, v91
    v_lshl_add_u32 v91, v90, 1, v91
    s_lshl_b32 s58, s58, 6
    v_lshl_add_u32 v91, v91, 4, s58
    v_cndmask_b32 v13, v91, v93, vcc
    s_add_u32 s58, s48, 1
    s_and_b32 s58, s58, 3
    s_lshr_b32 s56, s58, 1
    s_add_u32 s56, s56, 1
    s_sub_u32 s57, 0, s56
    s_bitcmp1_b32 s58, 0
    s_cselect_b32 s56, s56, s57
    s_lshl_b32 s57, s46, 5
    s_add_u32 s56, s56, s57
    v_add_u32 v91, s56, v89
    v_cmp_gt_u32 vcc, 64, v91
    v_lshrrev_b32 v92, 5, v91
    v_and_b32 v93, 31, v91
    v_lshl_add_u32 v93, v90, 5, v93
    v_lshlrev_b32 v93, 4, v93
    v_lshl_add_u32 v93, v92, 13, v93
    v_add_u32 v93, 81920, v93
    v_and_b32 v91, 1, v91
    v_lshl_add_u32 v91, v90, 1, v91
    s_lshl_b32 s58, s58, 6
    v_lshl_add_u32 v91, v91, 4, s58
    v_cndmask_b32 v17, v91, v93, vcc
    s_add_u32 s58, s48, 2
    s_and_b32 s58, s58, 3
    s_lshr_b32 s56, s58, 1
    s_add_u32 s56, s56, 1
    s_sub_u32 s57, 0, s56
    s_bitcmp1_b32 s58, 0
    s_cselect_b32 s56, s56, s57
    s_lshl_b32 s57, s46, 5
    s_add_u32 s56, s56, s57
    v_add_u32 v91, s56, v89
    v_cmp_gt_u32 vcc, 64, v91
    v_lshrrev_b32 v92, 5, v91
    v_and_b32 v93, 31, v91
    v_lshl_add_u32 v93, v90, 5, v93
    v_lshlrev_b32 v93, 4, v93
    v_lshl_add_u32 v93, v92, 13, v93
    v_add_u32 v93, 98304, v93
    v_and_b32 v91, 1, v91
    v_lshl_add_u32 v91, v90, 1, v91
    s_lshl_b32 s58, s58, 6
    v_lshl_add_u32 v91, v91, 4, s58
    v_cndmask_b32 v18, v91, v93, vcc
    s_add_u32 s58, s48, 3
    s_and_b32 s58, s58, 3
    s_lshr_b32 s56, s58, 1
    s_add_u32 s56, s56, 1
    s_sub_u32 s57, 0, s56
    s_bitcmp1_b32 s58, 0
    s_cselect_b32 s56, s56, s57
    s_lshl_b32 s57, s46, 5
    s_add_u32 s56, s56, s57
    v_add_u32 v91, s56, v89
    v_cmp_gt_u32 vcc, 64, v91
    v_lshrrev_b32 v92, 5, v91
    v_and_b32 v93, 31, v91
    v_lshl_add_u32 v93, v90, 5, v93
    v_lshlrev_b32 v93, 4, v93
    v_lshl_add_u32 v93, v92, 13, v93
    v_add_u32 v93, 114688, v93
    v_and_b32 v91, 1, v91
    v_lshl_add_u32 v91, v90, 1, v91
    s_lshl_b32 s58, s58, 6
    v_lshl_add_u32 v91, v91, 4, s58
    v_cndmask_b32 v16, v91, v93, vcc
    s_lshl_b32 s57, s63, 15
    s_lshl_b32 s6, s62, 11
    s_add_u32 s6, s6, s57
    s_add_u32 s6, s6, 25165824
    s_andn2_b32 s59, s6, 0x1fff
    s_add_u32 s6, s6, s59
    s_andn2_b32 s59, s6, 0x1fffff
    s_add_u32 s6, s6, s59
    s_lshl_b32 s7, s63, 12
    s_lshl_b32 s57, s62, 8
    s_add_u32 s7, s7, s57
    s_add_u32 s7, s7, 29360128
    s_andn2_b32 s59, s7, 0x1fff
    s_add_u32 s7, s7, s59
    s_andn2_b32 s59, s7, 0x1fffff
    s_add_u32 s7, s7, s59
    s_andn2_b32 s58, s48, 1
    s_lshl_b32 s58, s58, 1
    s_add_u32 s58, s58, s45
    s_lshl_b32 s56, s62, 17
    s_lshl_b32 s57, s58, 10
    s_add_u32 s56, s56, s57
    s_add_u32 s56, s56, 16777216
    s_lshl_b32 s57, s62, 11
    s_lshl_b32 s58, s58, 15
    s_add_u32 s57, s57, s58
    s_add_u32 s57, s57, 23068672
    s_bitcmp1_b32 s48, 0
    s_cselect_b32 s4, s56, s57
    s_cselect_b32 s57, 17, 11
    s_cselect_b32 s58, 1, 2
    s_lshl_b32 s57, 1, s57
    s_xor_b32 s5, s4, s57
    s_lshl_b32 s58, s58, 21
    s_add_u32 s12, s56, s58
    s_xor_b32 s13, s12, 131072
    s_andn2_b32 s59, s4, 0x1fff
    s_add_u32 s4, s4, s59
    s_andn2_b32 s59, s4, 0x1fffff
    s_add_u32 s4, s4, s59
    s_andn2_b32 s59, s5, 0x1fff
    s_add_u32 s5, s5, s59
    s_andn2_b32 s59, s5, 0x1fffff
    s_add_u32 s5, s5, s59
    s_andn2_b32 s59, s12, 0x1fff
    s_add_u32 s12, s12, s59
    s_andn2_b32 s59, s12, 0x1fffff
    s_add_u32 s12, s12, s59
    s_andn2_b32 s59, s13, 0x1fff
    s_add_u32 s13, s13, s59
    s_andn2_b32 s59, s13, 0x1fffff
    s_add_u32 s13, s13, s59
    s_lshl_b32 s64, -1, 0
    s_lshl_b32 s65, -1, 4
    s_lshl_b32 s66, -1, 1
    s_lshl_b32 s67, -1, 5
    s_lshl_b32 s68, -1, 2
    s_lshl_b32 s69, -1, 6
    s_lshl_b32 s70, -1, 3
    s_lshl_b32 s71, -1, 7
    s_lshl_b32 s72, -1, 8
    s_lshl_b32 s73, -1, 12
    s_lshl_b32 s74, -1, 9
    s_lshl_b32 s75, -1, 13
    s_lshl_b32 s76, -1, 10
    s_lshl_b32 s77, -1, 14
    s_lshl_b32 s78, -1, 11
    s_lshl_b32 s79, -1, 15
    s_lshl_b32 s80, -1, 16
    s_lshl_b32 s81, -1, 20
    s_lshl_b32 s82, -1, 17
    s_lshl_b32 s83, -1, 21
    s_lshl_b32 s84, -1, 18
    s_lshl_b32 s85, -1, 22
    s_lshl_b32 s86, -1, 19
    s_lshl_b32 s87, -1, 23
    s_lshl_b32 s88, -1, 24
    s_lshl_b32 s89, -1, 28
    s_lshl_b32 s90, -1, 25
    s_lshl_b32 s91, -1, 29
    s_lshl_b32 s92, -1, 26
    s_lshl_b32 s93, -1, 30
    s_lshl_b32 s94, -1, 27
    s_lshl_b32 s95, -1, 31
    s_mov_b32 s96, 0xffff
    s_mov_b32 s97, 0xffff
    s_load_dwordx2 s[8:9], s[0:1], 16
    s_cmp_eq_u32 s45, 2
    s_cselect_b32 s57, 4, 5
    s_cmp_eq_u32 s45, 3
    s_cselect_b32 s57, 4, s57
    s_cselect_b32 s59, 0, s45
    s_mul_i32 s59, s59, 655360
    s_waitcnt lgkmcnt(0)
    s_cselect_b64 s[36:37], s[8:9], s[18:19]
    s_lshl_b32 s57, s57, 9
    s_mul_i32 s15, s57, s2
    s_add_u32 s15, s15, s59
    s_and_b32 s37, s37, 0xffff
    s_add_u32 s38, s15, s57
    s_mov_b32 s39, 0x20000
    v_and_b32 v14, 15, v1
    v_lshlrev_b32 v14, 4, v14
    v_lshl_add_u32 v14, v90, 8, v14
    v_bfe_u32 v91, v1, 4, 1
    v_lshl_add_u32 v14, v91, 17, v14
    v_lshlrev_b32 v91, 3, v90
    v_sub_u32 v91, v89, v91
    v_mov_b32 v92, 0x3f80
    v_mov_b32 v93, 0x3f800000
    v_and_b32 v88, 1, v1
    v_cmp_eq_u32 vcc, 1, v88
    v_lshrrev_b32 v91, 1, v91
    s_nop 0
    v_cndmask_b32 v92, v92, v93, vcc
    v_cmp_eq_u32 vcc, 0, v91
    s_nop 1
    v_cndmask_b32 v20, 0, v92, vcc
    v_cmp_eq_u32 vcc, 1, v91
    s_nop 1
    v_cndmask_b32 v21, 0, v92, vcc
    v_cmp_eq_u32 vcc, 2, v91
    s_nop 1
    v_cndmask_b32 v22, 0, v92, vcc
    v_cmp_eq_u32 vcc, 3, v91
    s_nop 1
    v_cndmask_b32 v23, 0, v92, vcc
    v_cmp_eq_u32 vcc, 8, v91
    s_nop 1
    v_cndmask_b32 v24, 0, v92, vcc
    v_cmp_eq_u32 vcc, 9, v91
    s_nop 1
    v_cndmask_b32 v25, 0, v92, vcc
    v_cmp_eq_u32 vcc, 10, v91
    s_nop 1
    v_cndmask_b32 v26, 0, v92, vcc
    v_cmp_eq_u32 vcc, 11, v91
    s_nop 1
    v_cndmask_b32 v27, 0, v92, vcc
    s_lshl_b32 s56, s47, 7
    s_add_u32 s56, s56, 152576
    v_lshl_add_u32 v88, v89, 2, s56
    v_lshl_add_u32 v91, v90, 4, s56
    v_xor_b32 v92, 128, v91
    s_lshl_b32 s56, s45, 7
    s_add_u32 s56, s56, 153088
    v_lshl_add_u32 v93, v89, 2, s56
    s_cmp_eq_u32 s45, 0
    s_cbranch_scc0 L_walk1
    s_getpc_b64 s[56:57]
L_ph0:
    s_add_u32 s56, s56, L_pg0-L_ph0
    s_addc_u32 s57, s57, 0
    s_swappc_b64 s[58:59], s[56:57]
    s_getpc_b64 s[56:57]
L_ph4:
    s_add_u32 s56, s56, L_pg4-L_ph4
    s_addc_u32 s57, s57, 0
    s_swappc_b64 s[58:59], s[56:57]
    s_getpc_b64 s[56:57]
L_ph8:
    s_add_u32 s56, s56, L_pg8-L_ph8
    s_addc_u32 s57, s57, 0
    s_swappc_b64 s[58:59], s[56:57]
    s_branch L_walkdone
L_walk1:
    s_cmp_eq_u32 s45, 1
    s_cbranch_scc0 L_walk2
    s_getpc_b64 s[56:57]
L_ph1:
    s_add_u32 s56, s56, L_pg1-L_ph1
    s_addc_u32 s57, s57, 0
    s_swappc_b64 s[58:59], s[56:57]
    s_getpc_b64 s[56:57]
L_ph5:
    s_add_u32 s56, s56, L_pg5-L_ph5
    s_addc_u32 s57, s57, 0
    s_swappc_b64 s[58:59], s[56:57]
    s_getpc_b64 s[56:57]
L_ph9:
    s_add_u32 s56, s56, L_pg9-L_ph9
    s_addc_u32 s57, s57, 0
    s_swappc_b64 s[58:59], s[56:57]
    s_branch L_walkdone
L_walk2:
    s_cmp_eq_u32 s45, 2
    s_cbranch_scc0 L_walk3
    s_getpc_b64 s[56:57]
L_ph2:
    s_add_u32 s56, s56, L_pg2-L_ph2
    s_addc_u32 s57, s57, 0
    s_swappc_b64 s[58:59], s[56:57]
    s_getpc_b64 s[56:57]
L_ph6:
    s_add_u32 s56, s56, L_pg6-L_ph6
    s_addc_u32 s57, s57, 0
    s_swappc_b64 s[58:59], s[56:57]
    s_branch L_walkdone
L_walk3:
    s_getpc_b64 s[56:57]
L_ph3:
    s_add_u32 s56, s56, L_pg3-L_ph3
    s_addc_u32 s57, s57, 0
    s_swappc_b64 s[58:59], s[56:57]
    s_getpc_b64 s[56:57]
L_ph7:
    s_add_u32 s56, s56, L_pg7-L_ph7
    s_addc_u32 s57, s57, 0
    s_swappc_b64 s[58:59], s[56:57]
L_walkdone:
    s_cmp_eq_u32 s55, 1
    s_cbranch_scc0 L_nv_100007
    s_waitcnt lgkmcnt(0)
    s_not_b32 s42, s40
    s_not_b32 s43, s41
    s_mov_b32 s56, 0
    s_mov_b32 s41, s43
    s_load_dword s40, s[26:27], s10 offset:0 glc
    s_load_dword s41, s[26:27], s10 offset:8192 glc
    s_waitcnt lgkmcnt(1)
    s_cmp_eq_u32 s41, s43
    s_cselect_b32 s57, -1, 0
    s_add_u32 s56, s56, s57
    s_waitcnt lgkmcnt(0)
    s_mov_b32 s40, s42
    s_load_dword s41, s[26:27], s10 offset:8192 glc
    s_load_dword s40, s[26:27], s10 offset:0 glc
    s_waitcnt lgkmcnt(1)
    s_cmp_eq_u32 s40, s42
    s_cselect_b32 s57, 1, 0
    s_add_u32 s56, s56, s57
    s_waitcnt lgkmcnt(0)
    s_getreg_b32 s57, hwreg(HW_REG_XCC_ID, 2, 1)
    s_sub_u32 s58, 0, s56
    s_cmp_eq_u32 s57, 0
    s_cselect_b32 s56, s56, s58
    s_add_u32 s56, s56, 1
    s_lshl_b32 s56, s56, 8
    s_add_u32 s56, s56, 1
    s_and_b32 s58, s2, 7
    s_add_u32 s58, s58, 20
    s_lshl_b32 s57, s57, s58
    s_cmp_eq_u32 s45, 0
    s_cselect_b32 s57, s57, 0
    s_add_u32 s56, s56, s57
    s_waitcnt vmcnt(0)
    s_atomic_add s56, s[24:25], 0
L_nv_100007:
    s_bitcmp1_b32 s48, 0
    s_cbranch_scc1 L_typ1_100005
    s_branch L_main
.p2align 12
L_main:
    s_waitcnt vmcnt(0) lgkmcnt(0)
    s_barrier
    ds_read_b128 v[128:131], v76 offset:0
    ds_read_b64_tr_b16 v[40:41], v15 offset:32768
    ds_read_b64_tr_b16 v[42:43], v15 offset:33280
    ds_read_b64_tr_b16 v[44:45], v0 offset:32768
    ds_read_b64_tr_b16 v[46:47], v0 offset:33280
    ds_read_b128 v[132:135], v77 offset:0
    ds_read_b64_tr_b16 v[48:49], v15 offset:34816
    ds_read_b64_tr_b16 v[50:51], v15 offset:35328
    ds_read_b64_tr_b16 v[52:53], v0 offset:34816
    ds_read_b64_tr_b16 v[54:55], v0 offset:35328
    s_waitcnt lgkmcnt(5)
    v_mfma_f32_32x32x16_bf16 v[96:111], v[40:43], v[128:131], 0
    ds_read_b128 v[136:139], v78 offset:0
    ds_read_b64_tr_b16 v[56:57], v15 offset:36864
    ds_read_b64_tr_b16 v[58:59], v15 offset:37376
    ds_read_b64_tr_b16 v[60:61], v0 offset:36864
    ds_read_b64_tr_b16 v[62:63], v0 offset:37376
    v_mfma_f32_32x32x16_bf16 v[112:127], v[44:47], v[128:131], 0
    v_mfma_f32_16x16x32_bf16 v[64:67], v[72:75], v[128:131], 0
    v_mfma_f32_16x16x32_bf16 v[68:71], v[72:75], v[40:43], 0
    s_waitcnt lgkmcnt(5)
    v_mfma_f32_32x32x16_bf16 v[96:111], v[48:51], v[132:135], v[96:111]
    ds_read_b128 v[140:143], v79 offset:0
    ds_read_b64_tr_b16 v[40:41], v15 offset:38912
    ds_read_b64_tr_b16 v[42:43], v15 offset:39424
    ds_read_b64_tr_b16 v[44:45], v0 offset:38912
    ds_read_b64_tr_b16 v[46:47], v0 offset:39424
    v_mfma_f32_32x32x16_bf16 v[112:127], v[52:55], v[132:135], v[112:127]
    v_mfma_f32_16x16x32_bf16 v[64:67], v[72:75], v[132:135], v[64:67]
    v_mfma_f32_16x16x32_bf16 v[68:71], v[72:75], v[48:51], v[68:71]
    s_waitcnt lgkmcnt(5)
    v_mfma_f32_32x32x16_bf16 v[96:111], v[56:59], v[136:139], v[96:111]
    s_barrier
    ds_read_b128 v[144:147], v76 offset:16384
    ds_read_b64_tr_b16 v[48:49], v15 offset:40960
    ds_read_b64_tr_b16 v[50:51], v15 offset:41472
    ds_read_b64_tr_b16 v[52:53], v0 offset:40960
    ds_read_b64_tr_b16 v[54:55], v0 offset:41472
    v_mfma_f32_32x32x16_bf16 v[112:127], v[60:63], v[136:139], v[112:127]
    v_mfma_f32_16x16x32_bf16 v[64:67], v[72:75], v[136:139], v[64:67]
    v_mfma_f32_16x16x32_bf16 v[68:71], v[72:75], v[56:59], v[68:71]
    s_waitcnt lgkmcnt(5)
    v_mfma_f32_32x32x16_bf16 v[96:111], v[40:43], v[140:143], v[96:111]
    ds_read_b128 v[148:151], v77 offset:16384
    ds_read_b64_tr_b16 v[56:57], v15 offset:43008
    ds_read_b64_tr_b16 v[58:59], v15 offset:43520
    ds_read_b64_tr_b16 v[60:61], v0 offset:43008
    ds_read_b64_tr_b16 v[62:63], v0 offset:43520
    v_mfma_f32_32x32x16_bf16 v[112:127], v[44:47], v[140:143], v[112:127]
    v_mfma_f32_16x16x32_bf16 v[64:67], v[72:75], v[140:143], v[64:67]
    v_mfma_f32_16x16x32_bf16 v[68:71], v[72:75], v[40:43], v[68:71]
    s_waitcnt lgkmcnt(5)
    v_mfma_f32_32x32x16_bf16 v[96:111], v[48:51], v[144:147], v[96:111]
    ds_read_b128 v[152:155], v78 offset:16384
    ds_read_b64_tr_b16 v[40:41], v15 offset:45056
    ds_read_b64_tr_b16 v[42:43], v15 offset:45568
    ds_read_b64_tr_b16 v[44:45], v0 offset:45056
    ds_read_b64_tr_b16 v[46:47], v0 offset:45568
    v_mfma_f32_32x32x16_bf16 v[112:127], v[52:55], v[144:147], v[112:127]
    v_lshlrev_b32 v84, 16, v144
    v_and_b32 v85, 0xffff0000, v144
    v_lshlrev_b32 v86, 16, v145
    v_mfma_f32_16x16x32_bf16 v[64:67], v[72:75], v[144:147], v[64:67]
    v_and_b32 v87, 0xffff0000, v145
    v_fmac_f32 v82, v84, v84
    v_fmac_f32 v83, v85, v85
    v_mfma_f32_16x16x32_bf16 v[68:71], v[72:75], v[48:51], v[68:71]
    v_fmac_f32 v82, v86, v86
    v_fmac_f32 v83, v87, v87
    s_waitcnt lgkmcnt(5)
    v_mfma_f32_32x32x16_bf16 v[96:111], v[56:59], v[148:151], v[96:111]
    ds_read_b128 v[156:159], v79 offset:16384
    ds_read_b64_tr_b16 v[48:49], v15 offset:47104
    ds_read_b64_tr_b16 v[50:51], v15 offset:47616
    ds_read_b64_tr_b16 v[52:53], v0 offset:47104
    ds_read_b64_tr_b16 v[54:55], v0 offset:47616
    v_mfma_f32_32x32x16_bf16 v[112:127], v[60:63], v[148:151], v[112:127]
    v_lshlrev_b32 v84, 16, v146
    v_and_b32 v85, 0xffff0000, v146
    v_lshlrev_b32 v86, 16, v147
    v_mfma_f32_16x16x32_bf16 v[64:67], v[72:75], v[148:151], v[64:67]
    v_and_b32 v87, 0xffff0000, v147
    v_fmac_f32 v82, v84, v84
    v_fmac_f32 v83, v85, v85
    v_mfma_f32_16x16x32_bf16 v[68:71], v[72:75], v[56:59], v[68:71]
    v_fmac_f32 v82, v86, v86
    v_fmac_f32 v83, v87, v87
    s_waitcnt lgkmcnt(5)
    v_mfma_f32_32x32x16_bf16 v[96:111], v[40:43], v[152:155], v[96:111]
    v_add_u32 v76, 49152, v76
    v_add_u32 v15, 49152, v15
    v_add_u32 v0, 49152, v0
    s_barrier
    ds_read_b128 v[160:163], v76 offset:0
    ds_read_b64_tr_b16 v[56:57], v15 offset:32768
    ds_read_b64_tr_b16 v[58:59], v15 offset:33280
    ds_read_b64_tr_b16 v[60:61], v0 offset:32768
    ds_read_b64_tr_b16 v[62:63], v0 offset:33280
    v_mfma_f32_32x32x16_bf16 v[112:127], v[44:47], v[152:155], v[112:127]
    v_lshlrev_b32 v84, 16, v148
    v_and_b32 v85, 0xffff0000, v148
    v_lshlrev_b32 v86, 16, v149
    v_mfma_f32_16x16x32_bf16 v[64:67], v[72:75], v[152:155], v[64:67]
    v_and_b32 v87, 0xffff0000, v149
    v_fmac_f32 v82, v84, v84
    v_fmac_f32 v83, v85, v85
    v_mfma_f32_16x16x32_bf16 v[68:71], v[72:75], v[40:43], v[68:71]
    v_fmac_f32 v82, v86, v86
    v_fmac_f32 v83, v87, v87
    s_waitcnt lgkmcnt(5)
    v_mfma_f32_32x32x16_bf16 v[96:111], v[48:51], v[156:159], v[96:111]
    v_add_u32 v77, 49152, v77
    ds_read_b128 v[164:167], v77 offset:0
    ds_read_b64_tr_b16 v[40:41], v15 offset:34816
    ds_read_b64_tr_b16 v[42:43], v15 offset:35328
    ds_read_b64_tr_b16 v[44:45], v0 offset:34816
    ds_read_b64_tr_b16 v[46:47], v0 offset:35328
    v_mfma_f32_32x32x16_bf16 v[112:127], v[52:55], v[156:159], v[112:127]
    v_lshlrev_b32 v84, 16, v150
    v_and_b32 v85, 0xffff0000, v150
    v_lshlrev_b32 v86, 16, v151
    v_mfma_f32_16x16x32_bf16 v[64:67], v[72:75], v[156:159], v[64:67]
    v_and_b32 v87, 0xffff0000, v151
    v_fmac_f32 v82, v84, v84
    v_fmac_f32 v83, v85, v85
    v_mfma_f32_16x16x32_bf16 v[68:71], v[72:75], v[48:51], v[68:71]
    v_fmac_f32 v82, v86, v86
    v_fmac_f32 v83, v87, v87
    s_waitcnt lgkmcnt(5)
    v_mfma_f32_32x32x16_bf16 v[96:111], v[56:59], v[160:163], v[96:111]
    v_add_u32 v78, 49152, v78
    ds_read_b128 v[168:171], v78 offset:0
    ds_read_b64_tr_b16 v[48:49], v15 offset:36864
    ds_read_b64_tr_b16 v[50:51], v15 offset:37376
    ds_read_b64_tr_b16 v[52:53], v0 offset:36864
    ds_read_b64_tr_b16 v[54:55], v0 offset:37376
    v_mfma_f32_32x32x16_bf16 v[112:127], v[60:63], v[160:163], v[112:127]
    v_lshlrev_b32 v84, 16, v152
    v_and_b32 v85, 0xffff0000, v152
    v_lshlrev_b32 v86, 16, v153
    v_mfma_f32_16x16x32_bf16 v[64:67], v[72:75], v[160:163], v[64:67]
    v_and_b32 v87, 0xffff0000, v153
    v_fmac_f32 v82, v84, v84
    v_fmac_f32 v83, v85, v85
    v_mfma_f32_16x16x32_bf16 v[68:71], v[72:75], v[56:59], v[68:71]
    v_fmac_f32 v82, v86, v86
    v_fmac_f32 v83, v87, v87
    s_waitcnt lgkmcnt(5)
    v_mfma_f32_32x32x16_bf16 v[96:111], v[40:43], v[164:167], v[96:111]
    v_add_u32 v79, 49152, v79
    ds_read_b128 v[172:175], v79 offset:0
    ds_read_b64_tr_b16 v[56:57], v15 offset:38912
    ds_read_b64_tr_b16 v[58:59], v15 offset:39424
    ds_read_b64_tr_b16 v[60:61], v0 offset:38912
    ds_read_b64_tr_b16 v[62:63], v0 offset:39424
    v_mfma_f32_32x32x16_bf16 v[112:127], v[44:47], v[164:167], v[112:127]
    v_lshlrev_b32 v84, 16, v154
    v_and_b32 v85, 0xffff0000, v154
    v_lshlrev_b32 v86, 16, v155
    v_mfma_f32_16x16x32_bf16 v[64:67], v[72:75], v[164:167], v[64:67]
    v_and_b32 v87, 0xffff0000, v155
    v_fmac_f32 v82, v84, v84
    v_fmac_f32 v83, v85, v85
    v_mfma_f32_16x16x32_bf16 v[68:71], v[72:75], v[40:43], v[68:71]
    v_fmac_f32 v82, v86, v86
    v_fmac_f32 v83, v87, v87
    s_waitcnt lgkmcnt(5)
    v_mfma_f32_32x32x16_bf16 v[96:111], v[48:51], v[168:171], v[96:111]
    s_barrier
    ds_read_b128 v[176:179], v76 offset:16384
    ds_read_b64_tr_b16 v[40:41], v15 offset:40960
    ds_read_b64_tr_b16 v[42:43], v15 offset:41472
    ds_read_b64_tr_b16 v[44:45], v0 offset:40960
    ds_read_b64_tr_b16 v[46:47], v0 offset:41472
    v_mfma_f32_32x32x16_bf16 v[112:127], v[52:55], v[168:171], v[112:127]
    v_lshlrev_b32 v84, 16, v156
    v_and_b32 v85, 0xffff0000, v156
    v_lshlrev_b32 v86, 16, v157
    v_mfma_f32_16x16x32_bf16 v[64:67], v[72:75], v[168:171], v[64:67]
    v_and_b32 v87, 0xffff0000, v157
    v_fmac_f32 v82, v84, v84
    v_fmac_f32 v83, v85, v85
    v_mfma_f32_16x16x32_bf16 v[68:71], v[72:75], v[48:51], v[68:71]
    v_fmac_f32 v82, v86, v86
    v_fmac_f32 v83, v87, v87
    s_waitcnt lgkmcnt(5)
    v_mfma_f32_32x32x16_bf16 v[96:111], v[56:59], v[172:175], v[96:111]
    ds_read_b128 v[180:183], v77 offset:16384
    ds_read_b64_tr_b16 v[48:49], v15 offset:43008
    ds_read_b64_tr_b16 v[50:51], v15 offset:43520
    ds_read_b64_tr_b16 v[52:53], v0 offset:43008
    ds_read_b64_tr_b16 v[54:55], v0 offset:43520
    v_mfma_f32_32x32x16_bf16 v[112:127], v[60:63], v[172:175], v[112:127]
    v_lshlrev_b32 v84, 16, v158
    v_and_b32 v85, 0xffff0000, v158
    v_lshlrev_b32 v86, 16, v159
    v_mfma_f32_16x16x32_bf16 v[64:67], v[72:75], v[172:175], v[64:67]
    v_and_b32 v87, 0xffff0000, v159
    v_fmac_f32 v82, v84, v84
    v_fmac_f32 v83, v85, v85
    v_mfma_f32_16x16x32_bf16 v[68:71], v[72:75], v[56:59], v[68:71]
    v_fmac_f32 v82, v86, v86
    v_fmac_f32 v83, v87, v87
    s_waitcnt lgkmcnt(5)
    v_mfma_f32_32x32x16_bf16 v[96:111], v[40:43], v[176:179], v[96:111]
    ds_read_b128 v[184:187], v78 offset:16384
    ds_read_b64_tr_b16 v[56:57], v15 offset:45056
    ds_read_b64_tr_b16 v[58:59], v15 offset:45568
    ds_read_b64_tr_b16 v[60:61], v0 offset:45056
    ds_read_b64_tr_b16 v[62:63], v0 offset:45568
    v_mfma_f32_32x32x16_bf16 v[112:127], v[44:47], v[176:179], v[112:127]
    v_lshlrev_b32 v84, 16, v176
    v_and_b32 v85, 0xffff0000, v176
    v_lshlrev_b32 v86, 16, v177
    v_mfma_f32_16x16x32_bf16 v[64:67], v[72:75], v[176:179], v[64:67]
    v_and_b32 v87, 0xffff0000, v177
    v_fmac_f32 v82, v84, v84
    v_fmac_f32 v83, v85, v85
    v_mfma_f32_16x16x32_bf16 v[68:71], v[72:75], v[40:43], v[68:71]
    v_fmac_f32 v82, v86, v86
    v_fmac_f32 v83, v87, v87
    s_waitcnt lgkmcnt(5)
    v_mfma_f32_32x32x16_bf16 v[96:111], v[48:51], v[180:183], v[96:111]
    ds_read_b128 v[188:191], v79 offset:16384
    ds_read_b64_tr_b16 v[40:41], v15 offset:47104
    ds_read_b64_tr_b16 v[42:43], v15 offset:47616
    ds_read_b64_tr_b16 v[44:45], v0 offset:47104
    ds_read_b64_tr_b16 v[46:47], v0 offset:47616
    v_mfma_f32_32x32x16_bf16 v[112:127], v[52:55], v[180:183], v[112:127]
    v_lshlrev_b32 v84, 16, v178
    v_and_b32 v85, 0xffff0000, v178
    v_lshlrev_b32 v86, 16, v179
    v_mfma_f32_16x16x32_bf16 v[64:67], v[72:75], v[180:183], v[64:67]
    v_and_b32 v87, 0xffff0000, v179
    v_fmac_f32 v82, v84, v84
    v_fmac_f32 v83, v85, v85
    v_mfma_f32_16x16x32_bf16 v[68:71], v[72:75], v[48:51], v[68:71]
    v_fmac_f32 v82, v86, v86
    v_fmac_f32 v83, v87, v87
    s_waitcnt lgkmcnt(5)
    v_mfma_f32_32x32x16_bf16 v[96:111], v[56:59], v[184:187], v[96:111]
    v_add_u32 v76, 49152, v76
    v_add_u32 v15, 49152, v15
    v_add_u32 v0, 49152, v0
    s_barrier
    ds_read_b128 v[192:195], v76 offset:0
    ds_read_b64_tr_b16 v[48:49], v15 offset:32768
    ds_read_b64_tr_b16 v[50:51], v15 offset:33280
    ds_read_b64_tr_b16 v[52:53], v0 offset:32768
    ds_read_b64_tr_b16 v[54:55], v0 offset:33280
    v_mfma_f32_32x32x16_bf16 v[112:127], v[60:63], v[184:187], v[112:127]
    v_lshlrev_b32 v84, 16, v180
    v_and_b32 v85, 0xffff0000, v180
    v_lshlrev_b32 v86, 16, v181
    v_mfma_f32_16x16x32_bf16 v[64:67], v[72:75], v[184:187], v[64:67]
    v_and_b32 v87, 0xffff0000, v181
    v_fmac_f32 v82, v84, v84
    v_fmac_f32 v83, v85, v85
    v_mfma_f32_16x16x32_bf16 v[68:71], v[72:75], v[56:59], v[68:71]
    v_fmac_f32 v82, v86, v86
    v_fmac_f32 v83, v87, v87
    s_waitcnt lgkmcnt(5)
    v_mfma_f32_32x32x16_bf16 v[96:111], v[40:43], v[188:191], v[96:111]
    v_add_u32 v77, 49152, v77
    ds_read_b128 v[196:199], v77 offset:0
    ds_read_b64_tr_b16 v[56:57], v15 offset:34816
    ds_read_b64_tr_b16 v[58:59], v15 offset:35328
    ds_read_b64_tr_b16 v[60:61], v0 offset:34816
    ds_read_b64_tr_b16 v[62:63], v0 offset:35328
    v_mfma_f32_32x32x16_bf16 v[112:127], v[44:47], v[188:191], v[112:127]
    v_lshlrev_b32 v84, 16, v182
    v_and_b32 v85, 0xffff0000, v182
    v_lshlrev_b32 v86, 16, v183
    v_mfma_f32_16x16x32_bf16 v[64:67], v[72:75], v[188:191], v[64:67]
    v_and_b32 v87, 0xffff0000, v183
    v_fmac_f32 v82, v84, v84
    v_fmac_f32 v83, v85, v85
    v_mfma_f32_16x16x32_bf16 v[68:71], v[72:75], v[40:43], v[68:71]
    v_fmac_f32 v82, v86, v86
    v_fmac_f32 v83, v87, v87
    s_waitcnt lgkmcnt(5)
    v_mfma_f32_32x32x16_bf16 v[96:111], v[48:51], v[192:195], v[96:111]
    v_add_u32 v78, 49152, v78
    ds_read_b128 v[200:203], v78 offset:0
    ds_read_b64_tr_b16 v[40:41], v15 offset:36864
    ds_read_b64_tr_b16 v[42:43], v15 offset:37376
    ds_read_b64_tr_b16 v[44:45], v0 offset:36864
    ds_read_b64_tr_b16 v[46:47], v0 offset:37376
    v_mfma_f32_32x32x16_bf16 v[112:127], v[52:55], v[192:195], v[112:127]
    v_lshlrev_b32 v84, 16, v184
    v_and_b32 v85, 0xffff0000, v184
    v_lshlrev_b32 v86, 16, v185
    v_mfma_f32_16x16x32_bf16 v[64:67], v[72:75], v[192:195], v[64:67]
    v_and_b32 v87, 0xffff0000, v185
    v_fmac_f32 v82, v84, v84
    v_fmac_f32 v83, v85, v85
    v_mfma_f32_16x16x32_bf16 v[68:71], v[72:75], v[48:51], v[68:71]
    v_fmac_f32 v82, v86, v86
    v_fmac_f32 v83, v87, v87
    s_waitcnt lgkmcnt(5)
    v_mfma_f32_32x32x16_bf16 v[96:111], v[56:59], v[196:199], v[96:111]
    v_add_u32 v79, 49152, v79
    ds_read_b128 v[204:207], v79 offset:0
    ds_read_b64_tr_b16 v[48:49], v15 offset:38912
    ds_read_b64_tr_b16 v[50:51], v15 offset:39424
    ds_read_b64_tr_b16 v[52:53], v0 offset:38912
    ds_read_b64_tr_b16 v[54:55], v0 offset:39424
    v_mfma_f32_32x32x16_bf16 v[112:127], v[60:63], v[196:199], v[112:127]
    v_lshlrev_b32 v84, 16, v186
    v_and_b32 v85, 0xffff0000, v186
    v_lshlrev_b32 v86, 16, v187
    v_mfma_f32_16x16x32_bf16 v[64:67], v[72:75], v[196:199], v[64:67]
    v_and_b32 v87, 0xffff0000, v187
    v_fmac_f32 v82, v84, v84
    v_fmac_f32 v83, v85, v85
    v_mfma_f32_16x16x32_bf16 v[68:71], v[72:75], v[56:59], v[68:71]
    v_fmac_f32 v82, v86, v86
    v_fmac_f32 v83, v87, v87
    s_waitcnt lgkmcnt(5)
    v_mfma_f32_32x32x16_bf16 v[96:111], v[40:43], v[200:203], v[96:111]
    s_barrier
    ds_read_b128 v[208:211], v76 offset:16384
    ds_read_b64_tr_b16 v[56:57], v15 offset:40960
    ds_read_b64_tr_b16 v[58:59], v15 offset:41472
    ds_read_b64_tr_b16 v[60:61], v0 offset:40960
    ds_read_b64_tr_b16 v[62:63], v0 offset:41472
    v_mfma_f32_32x32x16_bf16 v[112:127], v[44:47], v[200:203], v[112:127]
    v_lshlrev_b32 v84, 16, v188
    v_and_b32 v85, 0xffff0000, v188
    v_lshlrev_b32 v86, 16, v189
    v_mfma_f32_16x16x32_bf16 v[64:67], v[72:75], v[200:203], v[64:67]
    v_and_b32 v87, 0xffff0000, v189
    v_fmac_f32 v82, v84, v84
    v_fmac_f32 v83, v85, v85
    v_mfma_f32_16x16x32_bf16 v[68:71], v[72:75], v[40:43], v[68:71]
    v_fmac_f32 v82, v86, v86
    v_fmac_f32 v83, v87, v87
    s_waitcnt lgkmcnt(5)
    v_mfma_f32_32x32x16_bf16 v[96:111], v[48:51], v[204:207], v[96:111]
    ds_read_b128 v[212:215], v77 offset:16384
    ds_read_b64_tr_b16 v[40:41], v15 offset:43008
    ds_read_b64_tr_b16 v[42:43], v15 offset:43520
    ds_read_b64_tr_b16 v[44:45], v0 offset:43008
    ds_read_b64_tr_b16 v[46:47], v0 offset:43520
    v_mfma_f32_32x32x16_bf16 v[112:127], v[52:55], v[204:207], v[112:127]
    v_lshlrev_b32 v84, 16, v190
    v_and_b32 v85, 0xffff0000, v190
    v_lshlrev_b32 v86, 16, v191
    v_mfma_f32_16x16x32_bf16 v[64:67], v[72:75], v[204:207], v[64:67]
    v_and_b32 v87, 0xffff0000, v191
    v_fmac_f32 v82, v84, v84
    v_fmac_f32 v83, v85, v85
    v_mfma_f32_16x16x32_bf16 v[68:71], v[72:75], v[48:51], v[68:71]
    v_fmac_f32 v82, v86, v86
    v_fmac_f32 v83, v87, v87
    s_waitcnt lgkmcnt(5)
    v_mfma_f32_32x32x16_bf16 v[96:111], v[56:59], v[208:211], v[96:111]
    ds_read_b128 v[216:219], v78 offset:16384
    ds_read_b64_tr_b16 v[48:49], v15 offset:45056
    ds_read_b64_tr_b16 v[50:51], v15 offset:45568
    ds_read_b64_tr_b16 v[52:53], v0 offset:45056
    ds_read_b64_tr_b16 v[54:55], v0 offset:45568
    v_mfma_f32_32x32x16_bf16 v[112:127], v[60:63], v[208:211], v[112:127]
    v_lshlrev_b32 v84, 16, v208
    v_and_b32 v85, 0xffff0000, v208
    v_lshlrev_b32 v86, 16, v209
    v_mfma_f32_16x16x32_bf16 v[64:67], v[72:75], v[208:211], v[64:67]
    v_and_b32 v87, 0xffff0000, v209
    v_fmac_f32 v82, v84, v84
    v_fmac_f32 v83, v85, v85
    v_mfma_f32_16x16x32_bf16 v[68:71], v[72:75], v[56:59], v[68:71]
    v_fmac_f32 v82, v86, v86
    v_fmac_f32 v83, v87, v87
    s_waitcnt lgkmcnt(5)
    v_mfma_f32_32x32x16_bf16 v[96:111], v[40:43], v[212:215], v[96:111]
    ds_read_b128 v[220:223], v79 offset:16384
    ds_read_b64_tr_b16 v[56:57], v15 offset:47104
    ds_read_b64_tr_b16 v[58:59], v15 offset:47616
    ds_read_b64_tr_b16 v[60:61], v0 offset:47104
    ds_read_b64_tr_b16 v[62:63], v0 offset:47616
    v_mfma_f32_32x32x16_bf16 v[112:127], v[44:47], v[212:215], v[112:127]
    v_lshlrev_b32 v84, 16, v210
    v_and_b32 v85, 0xffff0000, v210
    v_lshlrev_b32 v86, 16, v211
    v_mfma_f32_16x16x32_bf16 v[64:67], v[72:75], v[212:215], v[64:67]
    v_and_b32 v87, 0xffff0000, v211
    v_fmac_f32 v82, v84, v84
    v_fmac_f32 v83, v85, v85
    v_mfma_f32_16x16x32_bf16 v[68:71], v[72:75], v[40:43], v[68:71]
    v_fmac_f32 v82, v86, v86
    v_fmac_f32 v83, v87, v87
    s_waitcnt lgkmcnt(5)
    v_mfma_f32_32x32x16_bf16 v[96:111], v[48:51], v[216:219], v[96:111]
    v_subrev_u32 v76, 98304, v76
    v_subrev_u32 v15, 98304, v15
    v_subrev_u32 v0, 98304, v0
    s_barrier
    ds_read_b128 v[224:227], v76 offset:0
    ds_read_b64_tr_b16 v[40:41], v15 offset:32768
    ds_read_b64_tr_b16 v[42:43], v15 offset:33280
    ds_read_b64_tr_b16 v[44:45], v0 offset:32768
    ds_read_b64_tr_b16 v[46:47], v0 offset:33280
    v_mfma_f32_32x32x16_bf16 v[112:127], v[52:55], v[216:219], v[112:127]
    v_lshlrev_b32 v84, 16, v212
    v_and_b32 v85, 0xffff0000, v212
    v_lshlrev_b32 v86, 16, v213
    v_mfma_f32_16x16x32_bf16 v[64:67], v[72:75], v[216:219], v[64:67]
    v_and_b32 v87, 0xffff0000, v213
    v_fmac_f32 v82, v84, v84
    v_fmac_f32 v83, v85, v85
    v_mfma_f32_16x16x32_bf16 v[68:71], v[72:75], v[48:51], v[68:71]
    v_fmac_f32 v82, v86, v86
    v_fmac_f32 v83, v87, v87
    s_waitcnt lgkmcnt(5)
    v_mfma_f32_32x32x16_bf16 v[96:111], v[56:59], v[220:223], v[96:111]
    v_subrev_u32 v77, 98304, v77
    ds_read_b128 v[228:231], v77 offset:0
    ds_read_b64_tr_b16 v[48:49], v15 offset:34816
    ds_read_b64_tr_b16 v[50:51], v15 offset:35328
    ds_read_b64_tr_b16 v[52:53], v0 offset:34816
    ds_read_b64_tr_b16 v[54:55], v0 offset:35328
    v_mfma_f32_32x32x16_bf16 v[112:127], v[60:63], v[220:223], v[112:127]
    v_lshlrev_b32 v84, 16, v214
    v_and_b32 v85, 0xffff0000, v214
    v_lshlrev_b32 v86, 16, v215
    v_mfma_f32_16x16x32_bf16 v[64:67], v[72:75], v[220:223], v[64:67]
    v_and_b32 v87, 0xffff0000, v215
    v_fmac_f32 v82, v84, v84
    v_fmac_f32 v83, v85, v85
    v_mfma_f32_16x16x32_bf16 v[68:71], v[72:75], v[56:59], v[68:71]
    v_fmac_f32 v82, v86, v86
    v_fmac_f32 v83, v87, v87
    s_waitcnt lgkmcnt(5)
    v_mfma_f32_32x32x16_bf16 v[96:111], v[40:43], v[224:227], v[96:111]
    v_subrev_u32 v78, 98304, v78
    ds_read_b128 v[232:235], v78 offset:0
    ds_read_b64_tr_b16 v[56:57], v15 offset:36864
    ds_read_b64_tr_b16 v[58:59], v15 offset:37376
    ds_read_b64_tr_b16 v[60:61], v0 offset:36864
    ds_read_b64_tr_b16 v[62:63], v0 offset:37376
    v_mfma_f32_32x32x16_bf16 v[112:127], v[44:47], v[224:227], v[112:127]
    v_lshlrev_b32 v84, 16, v216
    v_and_b32 v85, 0xffff0000, v216
    v_lshlrev_b32 v86, 16, v217
    v_mfma_f32_16x16x32_bf16 v[64:67], v[72:75], v[224:227], v[64:67]
    v_and_b32 v87, 0xffff0000, v217
    v_fmac_f32 v82, v84, v84
    v_fmac_f32 v83, v85, v85
    v_mfma_f32_16x16x32_bf16 v[68:71], v[72:75], v[40:43], v[68:71]
    v_fmac_f32 v82, v86, v86
    v_fmac_f32 v83, v87, v87
    s_waitcnt lgkmcnt(5)
    v_mfma_f32_32x32x16_bf16 v[96:111], v[48:51], v[228:231], v[96:111]
    v_subrev_u32 v79, 98304, v79
    ds_read_b128 v[236:239], v79 offset:0
    ds_read_b64_tr_b16 v[40:41], v15 offset:38912
    ds_read_b64_tr_b16 v[42:43], v15 offset:39424
    ds_read_b64_tr_b16 v[44:45], v0 offset:38912
    ds_read_b64_tr_b16 v[46:47], v0 offset:39424
    v_mfma_f32_32x32x16_bf16 v[112:127], v[52:55], v[228:231], v[112:127]
    v_lshlrev_b32 v84, 16, v218
    v_and_b32 v85, 0xffff0000, v218
    v_lshlrev_b32 v86, 16, v219
    v_mfma_f32_16x16x32_bf16 v[64:67], v[72:75], v[228:231], v[64:67]
    v_and_b32 v87, 0xffff0000, v219
    v_fmac_f32 v82, v84, v84
    v_fmac_f32 v83, v85, v85
    v_mfma_f32_16x16x32_bf16 v[68:71], v[72:75], v[48:51], v[68:71]
    v_fmac_f32 v82, v86, v86
    v_fmac_f32 v83, v87, v87
    s_waitcnt lgkmcnt(5)
    v_mfma_f32_32x32x16_bf16 v[96:111], v[56:59], v[232:235], v[96:111]
    s_barrier
    ds_read_b128 v[240:243], v76 offset:16384
    ds_read_b64_tr_b16 v[48:49], v15 offset:40960
    ds_read_b64_tr_b16 v[50:51], v15 offset:41472
    ds_read_b64_tr_b16 v[52:53], v0 offset:40960
    ds_read_b64_tr_b16 v[54:55], v0 offset:41472
    v_mfma_f32_32x32x16_bf16 v[112:127], v[60:63], v[232:235], v[112:127]
    v_lshlrev_b32 v84, 16, v220
    v_and_b32 v85, 0xffff0000, v220
    v_lshlrev_b32 v86, 16, v221
    v_mfma_f32_16x16x32_bf16 v[64:67], v[72:75], v[232:235], v[64:67]
    v_and_b32 v87, 0xffff0000, v221
    v_fmac_f32 v82, v84, v84
    v_fmac_f32 v83, v85, v85
    v_mfma_f32_16x16x32_bf16 v[68:71], v[72:75], v[56:59], v[68:71]
    v_fmac_f32 v82, v86, v86
    v_fmac_f32 v83, v87, v87
    s_waitcnt lgkmcnt(5)
    v_mfma_f32_32x32x16_bf16 v[96:111], v[40:43], v[236:239], v[96:111]
    ds_read_b128 v[244:247], v77 offset:16384
    ds_read_b64_tr_b16 v[56:57], v15 offset:43008
    ds_read_b64_tr_b16 v[58:59], v15 offset:43520
    ds_read_b64_tr_b16 v[60:61], v0 offset:43008
    ds_read_b64_tr_b16 v[62:63], v0 offset:43520
    v_mfma_f32_32x32x16_bf16 v[112:127], v[44:47], v[236:239], v[112:127]
    v_lshlrev_b32 v84, 16, v222
    v_and_b32 v85, 0xffff0000, v222
    v_lshlrev_b32 v86, 16, v223
    v_mfma_f32_16x16x32_bf16 v[64:67], v[72:75], v[236:239], v[64:67]
    v_and_b32 v87, 0xffff0000, v223
    v_fmac_f32 v82, v84, v84
    v_fmac_f32 v83, v85, v85
    v_mfma_f32_16x16x32_bf16 v[68:71], v[72:75], v[40:43], v[68:71]
    v_fmac_f32 v82, v86, v86
    v_fmac_f32 v83, v87, v87
    s_waitcnt lgkmcnt(5)
    v_mfma_f32_32x32x16_bf16 v[96:111], v[48:51], v[240:243], v[96:111]
    ds_read_b128 v[248:251], v78 offset:16384
    ds_read_b64_tr_b16 v[40:41], v15 offset:45056
    ds_read_b64_tr_b16 v[42:43], v15 offset:45568
    ds_read_b64_tr_b16 v[44:45], v0 offset:45056
    ds_read_b64_tr_b16 v[46:47], v0 offset:45568
    v_mfma_f32_32x32x16_bf16 v[112:127], v[52:55], v[240:243], v[112:127]
    v_lshlrev_b32 v84, 16, v240
    v_and_b32 v85, 0xffff0000, v240
    v_lshlrev_b32 v86, 16, v241
    v_and_b32 v87, 0xffff0000, v241
    v_fmac_f32 v82, v84, v84
    v_fmac_f32 v83, v85, v85
    v_mfma_f32_16x16x32_bf16 v[64:67], v[72:75], v[240:243], v[64:67]
    v_fmac_f32 v82, v86, v86
    v_fmac_f32 v83, v87, v87
    v_lshlrev_b32 v84, 16, v242
    v_and_b32 v85, 0xffff0000, v242
    v_lshlrev_b32 v86, 16, v243
    v_and_b32 v87, 0xffff0000, v243
    v_mfma_f32_16x16x32_bf16 v[68:71], v[72:75], v[48:51], v[68:71]
    v_fmac_f32 v82, v84, v84
    v_fmac_f32 v83, v85, v85
    v_fmac_f32 v82, v86, v86
    v_fmac_f32 v83, v87, v87
    s_waitcnt lgkmcnt(5)
    v_mfma_f32_32x32x16_bf16 v[96:111], v[56:59], v[244:247], v[96:111]
    ds_read_b128 v[252:255], v79 offset:16384
    ds_read_b64_tr_b16 v[48:49], v15 offset:47104
    ds_read_b64_tr_b16 v[50:51], v15 offset:47616
    ds_read_b64_tr_b16 v[52:53], v0 offset:47104
    ds_read_b64_tr_b16 v[54:55], v0 offset:47616
    v_mfma_f32_32x32x16_bf16 v[112:127], v[60:63], v[244:247], v[112:127]
    v_lshlrev_b32 v84, 16, v244
    v_and_b32 v85, 0xffff0000, v244
    v_lshlrev_b32 v86, 16, v245
    v_and_b32 v87, 0xffff0000, v245
    v_fmac_f32 v82, v84, v84
    v_fmac_f32 v83, v85, v85
    v_mfma_f32_16x16x32_bf16 v[64:67], v[72:75], v[244:247], v[64:67]
    v_fmac_f32 v82, v86, v86
    v_fmac_f32 v83, v87, v87
    v_lshlrev_b32 v84, 16, v246
    v_and_b32 v85, 0xffff0000, v246
    v_lshlrev_b32 v86, 16, v247
    v_and_b32 v87, 0xffff0000, v247
    v_mfma_f32_16x16x32_bf16 v[68:71], v[72:75], v[56:59], v[68:71]
    v_fmac_f32 v82, v84, v84
    v_fmac_f32 v83, v85, v85
    v_fmac_f32 v82, v86, v86
    v_fmac_f32 v83, v87, v87
    s_waitcnt lgkmcnt(5)
    v_mfma_f32_32x32x16_bf16 v[96:111], v[40:43], v[248:251], v[96:111]
    v_mfma_f32_32x32x16_bf16 v[112:127], v[44:47], v[248:251], v[112:127]
    v_lshlrev_b32 v84, 16, v248
    v_and_b32 v85, 0xffff0000, v248
    v_lshlrev_b32 v86, 16, v249
    v_and_b32 v87, 0xffff0000, v249
    v_fmac_f32 v82, v84, v84
    v_fmac_f32 v83, v85, v85
    v_mfma_f32_16x16x32_bf16 v[64:67], v[72:75], v[248:251], v[64:67]
    v_fmac_f32 v82, v86, v86
    v_fmac_f32 v83, v87, v87
    v_lshlrev_b32 v84, 16, v250
    v_and_b32 v85, 0xffff0000, v250
    v_lshlrev_b32 v86, 16, v251
    v_and_b32 v87, 0xffff0000, v251
    v_mfma_f32_16x16x32_bf16 v[68:71], v[72:75], v[40:43], v[68:71]
    v_fmac_f32 v82, v84, v84
    v_fmac_f32 v83, v85, v85
    v_fmac_f32 v82, v86, v86
    v_fmac_f32 v83, v87, v87
    s_waitcnt lgkmcnt(0)
    v_mfma_f32_16x16x32_bf16 v[64:67], v[72:75], v[252:255], v[64:67]
    v_mfma_f32_16x16x32_bf16 v[68:71], v[72:75], v[48:51], v[68:71]
    v_lshlrev_b32 v84, 16, v252
    v_and_b32 v85, 0xffff0000, v252
    v_lshlrev_b32 v86, 16, v253
    v_and_b32 v87, 0xffff0000, v253
    v_fmac_f32 v82, v84, v84
    v_fmac_f32 v83, v85, v85
    v_mfma_f32_32x32x16_bf16 v[96:111], v[48:51], v[252:255], v[96:111]
    v_fmac_f32 v82, v86, v86
    v_fmac_f32 v83, v87, v87
    v_lshlrev_b32 v84, 16, v254
    v_and_b32 v85, 0xffff0000, v254
    v_lshlrev_b32 v86, 16, v255
    v_and_b32 v87, 0xffff0000, v255
    v_mfma_f32_32x32x16_bf16 v[112:127], v[52:55], v[252:255], v[112:127]
    v_fmac_f32 v82, v84, v84
    v_fmac_f32 v83, v85, v85
    v_fmac_f32 v82, v86, v86
    v_fmac_f32 v83, v87, v87
    v_add_u32 v15, 81920, v15
    v_add_u32 v0, 81920, v0
    ds_write_b32 v88, v68
    v_add_f32 v82, v82, v83
    v_mov_b32 v83, v82
    s_nop 1
    v_permlane32_swap_b32 v82, v83
    s_waitcnt lgkmcnt(0)
    s_barrier
    s_load_dword s59, s[24:25], 0
    ds_read_b32 v87, v93 offset:512
    ds_read_b128 v[28:31], v91 offset:0
    ds_read_b128 v[32:35], v91 offset:32
    ds_read_b128 v[36:39], v91 offset:64
    ds_read_b128 v[40:43], v91 offset:96
    ds_read_b128 v[44:47], v92 offset:0
    ds_read_b128 v[48:51], v92 offset:32
    ds_read_b128 v[52:55], v92 offset:64
    ds_read_b128 v[56:59], v92 offset:96
    v_add_f32 v82, v82, v83
    s_waitcnt lgkmcnt(8)
    v_add_f32 v82, v82, v87
    v_mul_f32 v60, 0xbb000000, v64
    v_mul_f32 v86, 0x3b000000, v82
    v_fma_f32 v86, -v60, v60, v86
    v_max_f32 v86, 0, v86
    v_add_f32 v86, 0x3727c5ac, v86
    v_rsq_f32 v62, v86
    v_sqrt_f32 v84, v86
    v_mul_f32 v63, 0xc0135761, v62
    v_mul_f32 v86, v62, v62
    v_mul_f32 v86, 0x3d372713, v86
    s_branch L_pgo0
L_pg0:
    s_setpc_b64 s[58:59]
L_pgo0:
    v_mul_f32 v62, v86, v63
    s_waitcnt lgkmcnt(4)
    v_pk_fma_f32 v[96:97], v[60:61], v[28:29], v[96:97] op_sel_hi:[0,1,1]
    v_pk_fma_f32 v[98:99], v[60:61], v[30:31], v[98:99] op_sel_hi:[0,1,1]
    v_pk_fma_f32 v[100:101], v[60:61], v[32:33], v[100:101] op_sel_hi:[0,1,1]
    v_pk_fma_f32 v[102:103], v[60:61], v[34:35], v[102:103] op_sel_hi:[0,1,1]
    v_pk_fma_f32 v[104:105], v[60:61], v[36:37], v[104:105] op_sel_hi:[0,1,1]
    v_pk_fma_f32 v[106:107], v[60:61], v[38:39], v[106:107] op_sel_hi:[0,1,1]
    v_pk_fma_f32 v[108:109], v[60:61], v[40:41], v[108:109] op_sel_hi:[0,1,1]
    v_pk_fma_f32 v[110:111], v[60:61], v[42:43], v[110:111] op_sel_hi:[0,1,1]
    v_pk_mul_f32 v[28:29], v[96:97], v[96:97]
    v_pk_mul_f32 v[30:31], v[98:99], v[98:99]
    v_pk_mul_f32 v[32:33], v[100:101], v[100:101]
    v_pk_mul_f32 v[34:35], v[102:103], v[102:103]
    v_pk_mul_f32 v[36:37], v[104:105], v[104:105]
    v_pk_mul_f32 v[38:39], v[106:107], v[106:107]
    v_pk_mul_f32 v[40:41], v[108:109], v[108:109]
    v_pk_mul_f32 v[42:43], v[110:111], v[110:111]
    v_pk_fma_f32 v[28:29], v[28:29], v[62:63], v[62:63] op_sel:[0,0,1] op_sel_hi:[1,0,1]
    v_pk_fma_f32 v[30:31], v[30:31], v[62:63], v[62:63] op_sel:[0,0,1] op_sel_hi:[1,0,1]
    v_pk_fma_f32 v[32:33], v[32:33], v[62:63], v[62:63] op_sel:[0,0,1] op_sel_hi:[1,0,1]
    v_pk_fma_f32 v[34:35], v[34:35], v[62:63], v[62:63] op_sel:[0,0,1] op_sel_hi:[1,0,1]
    v_pk_fma_f32 v[36:37], v[36:37], v[62:63], v[62:63] op_sel:[0,0,1] op_sel_hi:[1,0,1]
    v_pk_fma_f32 v[38:39], v[38:39], v[62:63], v[62:63] op_sel:[0,0,1] op_sel_hi:[1,0,1]
    v_pk_fma_f32 v[40:41], v[40:41], v[62:63], v[62:63] op_sel:[0,0,1] op_sel_hi:[1,0,1]
    v_pk_fma_f32 v[42:43], v[42:43], v[62:63], v[62:63] op_sel:[0,0,1] op_sel_hi:[1,0,1]
    v_pk_mul_f32 v[28:29], v[28:29], v[96:97]
    v_pk_mul_f32 v[30:31], v[30:31], v[98:99]
    v_pk_mul_f32 v[32:33], v[32:33], v[100:101]
    v_pk_mul_f32 v[34:35], v[34:35], v[102:103]
    v_pk_mul_f32 v[36:37], v[36:37], v[104:105]
    v_pk_mul_f32 v[38:39], v[38:39], v[106:107]
    v_pk_mul_f32 v[40:41], v[40:41], v[108:109]
    v_pk_mul_f32 v[42:43], v[42:43], v[110:111]
    v_exp_f32 v28, v28
    v_exp_f32 v29, v29
    v_exp_f32 v30, v30
    v_exp_f32 v31, v31
    v_exp_f32 v32, v32
    v_exp_f32 v33, v33
    v_exp_f32 v34, v34
    v_exp_f32 v35, v35
    v_exp_f32 v36, v36
    v_exp_f32 v37, v37
    v_exp_f32 v38, v38
    v_exp_f32 v39, v39
    v_exp_f32 v40, v40
    v_exp_f32 v41, v41
    v_exp_f32 v42, v42
    v_exp_f32 v43, v43
    v_pk_fma_f32 v[28:29], v[28:29], v[84:85], v[84:85] op_sel_hi:[1,0,0]
    v_pk_fma_f32 v[30:31], v[30:31], v[84:85], v[84:85] op_sel_hi:[1,0,0]
    v_pk_fma_f32 v[32:33], v[32:33], v[84:85], v[84:85] op_sel_hi:[1,0,0]
    v_pk_fma_f32 v[34:35], v[34:35], v[84:85], v[84:85] op_sel_hi:[1,0,0]
    v_pk_fma_f32 v[36:37], v[36:37], v[84:85], v[84:85] op_sel_hi:[1,0,0]
    v_pk_fma_f32 v[38:39], v[38:39], v[84:85], v[84:85] op_sel_hi:[1,0,0]
    v_pk_fma_f32 v[40:41], v[40:41], v[84:85], v[84:85] op_sel_hi:[1,0,0]
    v_pk_fma_f32 v[42:43], v[42:43], v[84:85], v[84:85] op_sel_hi:[1,0,0]
    v_rcp_f32 v28, v28
    v_rcp_f32 v29, v29
    v_rcp_f32 v30, v30
    v_rcp_f32 v31, v31
    v_rcp_f32 v32, v32
    v_rcp_f32 v33, v33
    v_rcp_f32 v34, v34
    v_rcp_f32 v35, v35
    v_rcp_f32 v36, v36
    v_rcp_f32 v37, v37
    v_rcp_f32 v38, v38
    v_rcp_f32 v39, v39
    v_rcp_f32 v40, v40
    v_rcp_f32 v41, v41
    v_rcp_f32 v42, v42
    v_rcp_f32 v43, v43
    v_pk_mul_f32 v[28:29], v[28:29], v[96:97]
    v_pk_mul_f32 v[30:31], v[30:31], v[98:99]
    v_pk_mul_f32 v[32:33], v[32:33], v[100:101]
    v_pk_mul_f32 v[34:35], v[34:35], v[102:103]
    v_pk_mul_f32 v[36:37], v[36:37], v[104:105]
    v_pk_mul_f32 v[38:39], v[38:39], v[106:107]
    v_pk_mul_f32 v[40:41], v[40:41], v[108:109]
    v_pk_mul_f32 v[42:43], v[42:43], v[110:111]
    v_cvt_pk_bf16_f32 v96, v28, v29
    v_cvt_pk_bf16_f32 v97, v30, v31
    v_cvt_pk_bf16_f32 v98, v32, v33
    v_cvt_pk_bf16_f32 v99, v34, v35
    v_cvt_pk_bf16_f32 v100, v36, v37
    v_cvt_pk_bf16_f32 v101, v38, v39
    v_cvt_pk_bf16_f32 v102, v40, v41
    v_cvt_pk_bf16_f32 v103, v42, v43
    s_waitcnt lgkmcnt(0)
    s_bfe_u32 s57, s59, 0xc0008
    s_cmp_gt_u32 s57, 32
    s_cselect_b32 s24, 15, 0
    s_bfe_u32 s57, s59, 0x10014
    s_lshl_b32 s57, s57, 0
    s_xor_b32 s24, s24, s57
    s_bfe_u32 s57, s59, 0x10016
    s_lshl_b32 s57, s57, 1
    s_xor_b32 s24, s24, s57
    s_bfe_u32 s57, s59, 0x10018
    s_lshl_b32 s57, s57, 2
    s_xor_b32 s24, s24, s57
    s_bfe_u32 s57, s59, 0x1001a
    s_lshl_b32 s57, s57, 3
    s_xor_b32 s24, s24, s57
    s_lshr_b32 s57, s48, 3
    s_lshr_b32 s57, s24, s57
    s_and_b32 s57, s57, 1
    s_lshl_b32 s25, s57, 13
    s_add_u32 s4, s4, s25
    s_add_u32 s5, s5, s25
    s_add_u32 s12, s12, s25
    s_add_u32 s13, s13, s25
    s_add_u32 s6, s6, s25
    s_add_u32 s7, s7, s25
    buffer_store_dwordx4 v[96:99], v2, s[28:31], s4 offen sc1
    buffer_store_dwordx4 v[100:103], v2, s[28:31], s4 offen offset:1024 sc1
    s_waitcnt lgkmcnt(0)
    v_pk_fma_f32 v[112:113], v[60:61], v[44:45], v[112:113] op_sel_hi:[0,1,1]
    v_pk_fma_f32 v[114:115], v[60:61], v[46:47], v[114:115] op_sel_hi:[0,1,1]
    v_pk_fma_f32 v[116:117], v[60:61], v[48:49], v[116:117] op_sel_hi:[0,1,1]
    v_pk_fma_f32 v[118:119], v[60:61], v[50:51], v[118:119] op_sel_hi:[0,1,1]
    v_pk_fma_f32 v[120:121], v[60:61], v[52:53], v[120:121] op_sel_hi:[0,1,1]
    v_pk_fma_f32 v[122:123], v[60:61], v[54:55], v[122:123] op_sel_hi:[0,1,1]
    v_pk_fma_f32 v[124:125], v[60:61], v[56:57], v[124:125] op_sel_hi:[0,1,1]
    v_pk_fma_f32 v[126:127], v[60:61], v[58:59], v[126:127] op_sel_hi:[0,1,1]
    v_pk_mul_f32 v[44:45], v[112:113], v[112:113]
    v_pk_mul_f32 v[46:47], v[114:115], v[114:115]
    v_pk_mul_f32 v[48:49], v[116:117], v[116:117]
    v_pk_mul_f32 v[50:51], v[118:119], v[118:119]
    v_pk_mul_f32 v[52:53], v[120:121], v[120:121]
    v_pk_mul_f32 v[54:55], v[122:123], v[122:123]
    v_pk_mul_f32 v[56:57], v[124:125], v[124:125]
    v_pk_mul_f32 v[58:59], v[126:127], v[126:127]
    v_pk_fma_f32 v[44:45], v[44:45], v[62:63], v[62:63] op_sel:[0,0,1] op_sel_hi:[1,0,1]
    v_pk_fma_f32 v[46:47], v[46:47], v[62:63], v[62:63] op_sel:[0,0,1] op_sel_hi:[1,0,1]
    v_pk_fma_f32 v[48:49], v[48:49], v[62:63], v[62:63] op_sel:[0,0,1] op_sel_hi:[1,0,1]
    v_pk_fma_f32 v[50:51], v[50:51], v[62:63], v[62:63] op_sel:[0,0,1] op_sel_hi:[1,0,1]
    v_pk_fma_f32 v[52:53], v[52:53], v[62:63], v[62:63] op_sel:[0,0,1] op_sel_hi:[1,0,1]
    v_pk_fma_f32 v[54:55], v[54:55], v[62:63], v[62:63] op_sel:[0,0,1] op_sel_hi:[1,0,1]
    v_pk_fma_f32 v[56:57], v[56:57], v[62:63], v[62:63] op_sel:[0,0,1] op_sel_hi:[1,0,1]
    v_pk_fma_f32 v[58:59], v[58:59], v[62:63], v[62:63] op_sel:[0,0,1] op_sel_hi:[1,0,1]
    v_pk_mul_f32 v[44:45], v[44:45], v[112:113]
    v_pk_mul_f32 v[46:47], v[46:47], v[114:115]
    v_pk_mul_f32 v[48:49], v[48:49], v[116:117]
    v_pk_mul_f32 v[50:51], v[50:51], v[118:119]
    v_pk_mul_f32 v[52:53], v[52:53], v[120:121]
    v_pk_mul_f32 v[54:55], v[54:55], v[122:123]
    v_pk_mul_f32 v[56:57], v[56:57], v[124:125]
    v_pk_mul_f32 v[58:59], v[58:59], v[126:127]
    v_exp_f32 v44, v44
    v_exp_f32 v45, v45
    v_exp_f32 v46, v46
    v_exp_f32 v47, v47
    v_exp_f32 v48, v48
    v_exp_f32 v49, v49
    v_exp_f32 v50, v50
    v_exp_f32 v51, v51
    v_exp_f32 v52, v52
    v_exp_f32 v53, v53
    v_exp_f32 v54, v54
    v_exp_f32 v55, v55
    v_exp_f32 v56, v56
    v_exp_f32 v57, v57
    v_exp_f32 v58, v58
    v_exp_f32 v59, v59
    v_pk_fma_f32 v[44:45], v[44:45], v[84:85], v[84:85] op_sel_hi:[1,0,0]
    v_pk_fma_f32 v[46:47], v[46:47], v[84:85], v[84:85] op_sel_hi:[1,0,0]
    v_pk_fma_f32 v[48:49], v[48:49], v[84:85], v[84:85] op_sel_hi:[1,0,0]
    v_pk_fma_f32 v[50:51], v[50:51], v[84:85], v[84:85] op_sel_hi:[1,0,0]
    v_pk_fma_f32 v[52:53], v[52:53], v[84:85], v[84:85] op_sel_hi:[1,0,0]
    v_pk_fma_f32 v[54:55], v[54:55], v[84:85], v[84:85] op_sel_hi:[1,0,0]
    v_pk_fma_f32 v[56:57], v[56:57], v[84:85], v[84:85] op_sel_hi:[1,0,0]
    v_pk_fma_f32 v[58:59], v[58:59], v[84:85], v[84:85] op_sel_hi:[1,0,0]
    v_rcp_f32 v44, v44
    v_rcp_f32 v45, v45
    v_rcp_f32 v46, v46
    v_rcp_f32 v47, v47
    v_rcp_f32 v48, v48
    v_rcp_f32 v49, v49
    v_rcp_f32 v50, v50
    v_rcp_f32 v51, v51
    v_rcp_f32 v52, v52
    v_rcp_f32 v53, v53
    v_rcp_f32 v54, v54
    v_rcp_f32 v55, v55
    v_rcp_f32 v56, v56
    v_rcp_f32 v57, v57
    v_rcp_f32 v58, v58
    v_rcp_f32 v59, v59
    v_pk_mul_f32 v[44:45], v[44:45], v[112:113]
    v_pk_mul_f32 v[46:47], v[46:47], v[114:115]
    v_pk_mul_f32 v[48:49], v[48:49], v[116:117]
    v_pk_mul_f32 v[50:51], v[50:51], v[118:119]
    v_pk_mul_f32 v[52:53], v[52:53], v[120:121]
    v_pk_mul_f32 v[54:55], v[54:55], v[122:123]
    v_pk_mul_f32 v[56:57], v[56:57], v[124:125]
    v_pk_mul_f32 v[58:59], v[58:59], v[126:127]
    v_cvt_pk_bf16_f32 v112, v44, v45
    v_cvt_pk_bf16_f32 v113, v46, v47
    v_cvt_pk_bf16_f32 v114, v48, v49
    v_cvt_pk_bf16_f32 v115, v50, v51
    v_cvt_pk_bf16_f32 v116, v52, v53
    v_cvt_pk_bf16_f32 v117, v54, v55
    v_cvt_pk_bf16_f32 v118, v56, v57
    v_cvt_pk_bf16_f32 v119, v58, v59
    s_barrier
    ds_read_b64_tr_b16 v[40:41], v15 offset:0
    ds_read_b64_tr_b16 v[42:43], v15 offset:512
    ds_read_b64_tr_b16 v[44:45], v0 offset:0
    ds_read_b64_tr_b16 v[46:47], v0 offset:512
    ds_read_b64_tr_b16 v[48:49], v15 offset:2048
    ds_read_b64_tr_b16 v[50:51], v15 offset:2560
    ds_read_b64_tr_b16 v[52:53], v0 offset:2048
    ds_read_b64_tr_b16 v[54:55], v0 offset:2560
    buffer_store_dwordx4 v[112:115], v2, s[28:31], s5 offen sc1
    buffer_store_dwordx4 v[116:119], v2, s[28:31], s5 offen offset:1024 sc1
    s_waitcnt lgkmcnt(4)
    v_mfma_f32_32x32x16_bf16 v[64:79], v[128:131], v[40:43], 0
    ds_read_b64_tr_b16 v[56:57], v15 offset:4096
    ds_read_b64_tr_b16 v[58:59], v15 offset:4608
    ds_read_b64_tr_b16 v[60:61], v0 offset:4096
    ds_read_b64_tr_b16 v[62:63], v0 offset:4608
    v_mfma_f32_32x32x16_bf16 v[80:95], v[128:131], v[44:47], 0
    s_waitcnt lgkmcnt(4)
    v_mfma_f32_32x32x16_bf16 v[64:79], v[132:135], v[48:51], v[64:79]
    ds_read_b64_tr_b16 v[40:41], v15 offset:6144
    ds_read_b64_tr_b16 v[42:43], v15 offset:6656
    ds_read_b64_tr_b16 v[44:45], v0 offset:6144
    ds_read_b64_tr_b16 v[46:47], v0 offset:6656
    v_mfma_f32_32x32x16_bf16 v[80:95], v[132:135], v[52:55], v[80:95]
    s_waitcnt lgkmcnt(4)
    v_mfma_f32_32x32x16_bf16 v[64:79], v[136:139], v[56:59], v[64:79]
    ds_read_b64_tr_b16 v[48:49], v15 offset:8192
    ds_read_b64_tr_b16 v[50:51], v15 offset:8704
    ds_read_b64_tr_b16 v[52:53], v0 offset:8192
    ds_read_b64_tr_b16 v[54:55], v0 offset:8704
    v_mfma_f32_32x32x16_bf16 v[80:95], v[136:139], v[60:63], v[80:95]
    s_waitcnt lgkmcnt(4)
    v_mfma_f32_32x32x16_bf16 v[64:79], v[140:143], v[40:43], v[64:79]
    ds_read_b64_tr_b16 v[56:57], v15 offset:10240
    ds_read_b64_tr_b16 v[58:59], v15 offset:10752
    ds_read_b64_tr_b16 v[60:61], v0 offset:10240
    ds_read_b64_tr_b16 v[62:63], v0 offset:10752
    v_mfma_f32_32x32x16_bf16 v[80:95], v[140:143], v[44:47], v[80:95]
    s_waitcnt lgkmcnt(4)
    v_mfma_f32_32x32x16_bf16 v[64:79], v[144:147], v[48:51], v[64:79]
    ds_read_b64_tr_b16 v[40:41], v15 offset:12288
    ds_read_b64_tr_b16 v[42:43], v15 offset:12800
    ds_read_b64_tr_b16 v[44:45], v0 offset:12288
    ds_read_b64_tr_b16 v[46:47], v0 offset:12800
    v_mfma_f32_32x32x16_bf16 v[80:95], v[144:147], v[52:55], v[80:95]
    s_waitcnt lgkmcnt(4)
    v_mfma_f32_32x32x16_bf16 v[64:79], v[148:151], v[56:59], v[64:79]
    ds_read_b64_tr_b16 v[48:49], v15 offset:14336
    ds_read_b64_tr_b16 v[50:51], v15 offset:14848
    ds_read_b64_tr_b16 v[52:53], v0 offset:14336
    ds_read_b64_tr_b16 v[54:55], v0 offset:14848
    v_mfma_f32_32x32x16_bf16 v[80:95], v[148:151], v[60:63], v[80:95]
    s_waitcnt lgkmcnt(4)
    v_mfma_f32_32x32x16_bf16 v[64:79], v[152:155], v[40:43], v[64:79]
    s_barrier
    ds_read_b64_tr_b16 v[56:57], v15 offset:16384
    ds_read_b64_tr_b16 v[58:59], v15 offset:16896
    ds_read_b64_tr_b16 v[60:61], v0 offset:16384
    ds_read_b64_tr_b16 v[62:63], v0 offset:16896
    v_mfma_f32_32x32x16_bf16 v[80:95], v[152:155], v[44:47], v[80:95]
    s_waitcnt lgkmcnt(4)
    v_mfma_f32_32x32x16_bf16 v[64:79], v[156:159], v[48:51], v[64:79]
    ds_read_b64_tr_b16 v[40:41], v15 offset:18432
    ds_read_b64_tr_b16 v[42:43], v15 offset:18944
    ds_read_b64_tr_b16 v[44:45], v0 offset:18432
    ds_read_b64_tr_b16 v[46:47], v0 offset:18944
    v_mfma_f32_32x32x16_bf16 v[80:95], v[156:159], v[52:55], v[80:95]
    s_waitcnt lgkmcnt(4)
    v_mfma_f32_32x32x16_bf16 v[64:79], v[160:163], v[56:59], v[64:79]
    ds_read_b64_tr_b16 v[48:49], v15 offset:20480
    ds_read_b64_tr_b16 v[50:51], v15 offset:20992
    ds_read_b64_tr_b16 v[52:53], v0 offset:20480
    ds_read_b64_tr_b16 v[54:55], v0 offset:20992
    v_mfma_f32_32x32x16_bf16 v[80:95], v[160:163], v[60:63], v[80:95]
    s_waitcnt vmcnt(0)
    s_barrier
    s_waitcnt lgkmcnt(4)
    v_mfma_f32_32x32x16_bf16 v[64:79], v[164:167], v[40:43], v[64:79]
    ds_read_b64_tr_b16 v[56:57], v15 offset:22528
    ds_read_b64_tr_b16 v[58:59], v15 offset:23040
    ds_read_b64_tr_b16 v[60:61], v0 offset:22528
    ds_read_b64_tr_b16 v[62:63], v0 offset:23040
    v_mfma_f32_32x32x16_bf16 v[80:95], v[164:167], v[44:47], v[80:95]
    s_waitcnt lgkmcnt(4)
    v_mfma_f32_32x32x16_bf16 v[64:79], v[168:171], v[48:51], v[64:79]
    ds_read_b64_tr_b16 v[40:41], v15 offset:24576
    ds_read_b64_tr_b16 v[42:43], v15 offset:25088
    ds_read_b64_tr_b16 v[44:45], v0 offset:24576
    ds_read_b64_tr_b16 v[46:47], v0 offset:25088
    v_mfma_f32_32x32x16_bf16 v[80:95], v[168:171], v[52:55], v[80:95]
    s_waitcnt lgkmcnt(4)
    v_mfma_f32_32x32x16_bf16 v[64:79], v[172:175], v[56:59], v[64:79]
    ds_read_b64_tr_b16 v[48:49], v15 offset:26624
    ds_read_b64_tr_b16 v[50:51], v15 offset:27136
    ds_read_b64_tr_b16 v[52:53], v0 offset:26624
    ds_read_b64_tr_b16 v[54:55], v0 offset:27136
    v_mfma_f32_32x32x16_bf16 v[80:95], v[172:175], v[60:63], v[80:95]
    s_waitcnt lgkmcnt(4)
    v_mfma_f32_32x32x16_bf16 v[64:79], v[176:179], v[40:43], v[64:79]
    ds_read_b64_tr_b16 v[56:57], v15 offset:28672
    ds_read_b64_tr_b16 v[58:59], v15 offset:29184
    ds_read_b64_tr_b16 v[60:61], v0 offset:28672
    ds_read_b64_tr_b16 v[62:63], v0 offset:29184
    v_mfma_f32_32x32x16_bf16 v[80:95], v[176:179], v[44:47], v[80:95]
    s_waitcnt lgkmcnt(4)
    v_mfma_f32_32x32x16_bf16 v[64:79], v[180:183], v[48:51], v[64:79]
    ds_read_b64_tr_b16 v[40:41], v15 offset:30720
    ds_read_b64_tr_b16 v[42:43], v15 offset:31232
    ds_read_b64_tr_b16 v[44:45], v0 offset:30720
    ds_read_b64_tr_b16 v[46:47], v0 offset:31232
    v_mfma_f32_32x32x16_bf16 v[80:95], v[180:183], v[52:55], v[80:95]
    s_waitcnt lgkmcnt(4)
    v_mfma_f32_32x32x16_bf16 v[64:79], v[184:187], v[56:59], v[64:79]
    s_barrier
    ds_read_b64_tr_b16 v[48:49], v15 offset:32768
    ds_read_b64_tr_b16 v[50:51], v15 offset:33280
    ds_read_b64_tr_b16 v[52:53], v0 offset:32768
    ds_read_b64_tr_b16 v[54:55], v0 offset:33280
    v_mfma_f32_32x32x16_bf16 v[80:95], v[184:187], v[60:63], v[80:95]
    s_waitcnt lgkmcnt(4)
    v_mfma_f32_32x32x16_bf16 v[64:79], v[188:191], v[40:43], v[64:79]
    ds_read_b64_tr_b16 v[56:57], v15 offset:34816
    ds_read_b64_tr_b16 v[58:59], v15 offset:35328
    ds_read_b64_tr_b16 v[60:61], v0 offset:34816
    ds_read_b64_tr_b16 v[62:63], v0 offset:35328
    v_mfma_f32_32x32x16_bf16 v[80:95], v[188:191], v[44:47], v[80:95]
    s_waitcnt lgkmcnt(4)
    v_mfma_f32_32x32x16_bf16 v[64:79], v[192:195], v[48:51], v[64:79]
    ds_read_b64_tr_b16 v[40:41], v15 offset:36864
    ds_read_b64_tr_b16 v[42:43], v15 offset:37376
    ds_read_b64_tr_b16 v[44:45], v0 offset:36864
    ds_read_b64_tr_b16 v[46:47], v0 offset:37376
    v_mfma_f32_32x32x16_bf16 v[80:95], v[192:195], v[52:55], v[80:95]
    s_waitcnt lgkmcnt(4)
    v_mfma_f32_32x32x16_bf16 v[64:79], v[196:199], v[56:59], v[64:79]
    ds_read_b64_tr_b16 v[48:49], v15 offset:38912
    ds_read_b64_tr_b16 v[50:51], v15 offset:39424
    ds_read_b64_tr_b16 v[52:53], v0 offset:38912
    ds_read_b64_tr_b16 v[54:55], v0 offset:39424
    v_mfma_f32_32x32x16_bf16 v[80:95], v[196:199], v[60:63], v[80:95]
    s_waitcnt lgkmcnt(4)
    v_mfma_f32_32x32x16_bf16 v[64:79], v[200:203], v[40:43], v[64:79]
    ds_read_b64_tr_b16 v[56:57], v15 offset:40960
    ds_read_b64_tr_b16 v[58:59], v15 offset:41472
    ds_read_b64_tr_b16 v[60:61], v0 offset:40960
    ds_read_b64_tr_b16 v[62:63], v0 offset:41472
    v_mfma_f32_32x32x16_bf16 v[80:95], v[200:203], v[44:47], v[80:95]
    s_waitcnt lgkmcnt(4)
    v_mfma_f32_32x32x16_bf16 v[64:79], v[204:207], v[48:51], v[64:79]
    ds_read_b64_tr_b16 v[40:41], v15 offset:43008
    ds_read_b64_tr_b16 v[42:43], v15 offset:43520
    ds_read_b64_tr_b16 v[44:45], v0 offset:43008
    ds_read_b64_tr_b16 v[46:47], v0 offset:43520
    v_mfma_f32_32x32x16_bf16 v[80:95], v[204:207], v[52:55], v[80:95]
    s_waitcnt lgkmcnt(4)
    v_mfma_f32_32x32x16_bf16 v[64:79], v[208:211], v[56:59], v[64:79]
    ds_read_b64_tr_b16 v[48:49], v15 offset:45056
    ds_read_b64_tr_b16 v[50:51], v15 offset:45568
    ds_read_b64_tr_b16 v[52:53], v0 offset:45056
    ds_read_b64_tr_b16 v[54:55], v0 offset:45568
    v_mfma_f32_32x32x16_bf16 v[80:95], v[208:211], v[60:63], v[80:95]
    s_waitcnt lgkmcnt(4)
    v_mfma_f32_32x32x16_bf16 v[64:79], v[212:215], v[40:43], v[64:79]
    ds_read_b64_tr_b16 v[56:57], v15 offset:47104
    ds_read_b64_tr_b16 v[58:59], v15 offset:47616
    ds_read_b64_tr_b16 v[60:61], v0 offset:47104
    ds_read_b64_tr_b16 v[62:63], v0 offset:47616
    v_mfma_f32_32x32x16_bf16 v[80:95], v[212:215], v[44:47], v[80:95]
    s_waitcnt lgkmcnt(4)
    v_mfma_f32_32x32x16_bf16 v[64:79], v[216:219], v[48:51], v[64:79]
    s_barrier
    ds_read_b64_tr_b16 v[40:41], v15 offset:49152
    ds_read_b64_tr_b16 v[42:43], v15 offset:49664
    ds_read_b64_tr_b16 v[44:45], v0 offset:49152
    ds_read_b64_tr_b16 v[46:47], v0 offset:49664
    v_mfma_f32_32x32x16_bf16 v[80:95], v[216:219], v[52:55], v[80:95]
    s_waitcnt lgkmcnt(4)
    v_mfma_f32_32x32x16_bf16 v[64:79], v[220:223], v[56:59], v[64:79]
    ds_read_b64_tr_b16 v[48:49], v15 offset:51200
    ds_read_b64_tr_b16 v[50:51], v15 offset:51712
    ds_read_b64_tr_b16 v[52:53], v0 offset:51200
    ds_read_b64_tr_b16 v[54:55], v0 offset:51712
    v_mfma_f32_32x32x16_bf16 v[80:95], v[220:223], v[60:63], v[80:95]
    s_waitcnt lgkmcnt(4)
    v_mfma_f32_32x32x16_bf16 v[64:79], v[224:227], v[40:43], v[64:79]
    ds_read_b64_tr_b16 v[56:57], v15 offset:53248
    ds_read_b64_tr_b16 v[58:59], v15 offset:53760
    ds_read_b64_tr_b16 v[60:61], v0 offset:53248
    ds_read_b64_tr_b16 v[62:63], v0 offset:53760
    v_mfma_f32_32x32x16_bf16 v[80:95], v[224:227], v[44:47], v[80:95]
    s_waitcnt lgkmcnt(4)
    v_mfma_f32_32x32x16_bf16 v[64:79], v[228:231], v[48:51], v[64:79]
    ds_read_b64_tr_b16 v[40:41], v15 offset:55296
    ds_read_b64_tr_b16 v[42:43], v15 offset:55808
    ds_read_b64_tr_b16 v[44:45], v0 offset:55296
    ds_read_b64_tr_b16 v[46:47], v0 offset:55808
    v_mfma_f32_32x32x16_bf16 v[80:95], v[228:231], v[52:55], v[80:95]
    s_waitcnt lgkmcnt(4)
    v_mfma_f32_32x32x16_bf16 v[64:79], v[232:235], v[56:59], v[64:79]
    ds_read_b64_tr_b16 v[48:49], v15 offset:57344
    ds_read_b64_tr_b16 v[50:51], v15 offset:57856
    ds_read_b64_tr_b16 v[52:53], v0 offset:57344
    ds_read_b64_tr_b16 v[54:55], v0 offset:57856
    v_mfma_f32_32x32x16_bf16 v[80:95], v[232:235], v[60:63], v[80:95]
    s_waitcnt lgkmcnt(4)
    v_mfma_f32_32x32x16_bf16 v[64:79], v[236:239], v[40:43], v[64:79]
    ds_read_b64_tr_b16 v[56:57], v15 offset:59392
    ds_read_b64_tr_b16 v[58:59], v15 offset:59904
    ds_read_b64_tr_b16 v[60:61], v0 offset:59392
    ds_read_b64_tr_b16 v[62:63], v0 offset:59904
    v_mfma_f32_32x32x16_bf16 v[80:95], v[236:239], v[44:47], v[80:95]
    s_waitcnt lgkmcnt(4)
    v_mfma_f32_32x32x16_bf16 v[64:79], v[240:243], v[48:51], v[64:79]
    ds_read_b64_tr_b16 v[40:41], v15 offset:61440
    ds_read_b64_tr_b16 v[42:43], v15 offset:61952
    ds_read_b64_tr_b16 v[44:45], v0 offset:61440
    ds_read_b64_tr_b16 v[46:47], v0 offset:61952
    v_mfma_f32_32x32x16_bf16 v[80:95], v[240:243], v[52:55], v[80:95]
    s_waitcnt lgkmcnt(4)
    v_mfma_f32_32x32x16_bf16 v[64:79], v[244:247], v[56:59], v[64:79]
    ds_read_b64_tr_b16 v[48:49], v15 offset:63488
    ds_read_b64_tr_b16 v[50:51], v15 offset:64000
    ds_read_b64_tr_b16 v[52:53], v0 offset:63488
    ds_read_b64_tr_b16 v[54:55], v0 offset:64000
    v_mfma_f32_32x32x16_bf16 v[80:95], v[244:247], v[60:63], v[80:95]
    s_waitcnt lgkmcnt(4)
    v_mfma_f32_32x32x16_bf16 v[64:79], v[248:251], v[40:43], v[64:79]
    v_mfma_f32_32x32x16_bf16 v[80:95], v[248:251], v[44:47], v[80:95]
    s_waitcnt lgkmcnt(0)
    v_mfma_f32_32x32x16_bf16 v[64:79], v[252:255], v[48:51], v[64:79]
    v_mfma_f32_32x32x16_bf16 v[80:95], v[252:255], v[52:55], v[80:95]
    v_mfma_f32_32x32x16_bf16 v[112:127], v[20:23], v[4:7], 0
    v_mfma_f32_32x32x16_bf16 v[112:127], v[24:27], v[8:11], v[112:127]
    v_lshrrev_b32 v19, 5, v1
    v_lshlrev_b32 v19, 9, v19
    v_sub_u32 v15, v15, v19
    v_subrev_u32 v15, 65536, v15
    s_nop 5
    v_cvt_pk_bf16_f32 v64, v64, v65
    v_cvt_pk_bf16_f32 v65, v66, v67
    v_cvt_pk_bf16_f32 v66, v68, v69
    v_cvt_pk_bf16_f32 v67, v70, v71
    v_cvt_pk_bf16_f32 v68, v72, v73
    v_cvt_pk_bf16_f32 v69, v74, v75
    v_cvt_pk_bf16_f32 v70, v76, v77
    v_cvt_pk_bf16_f32 v71, v78, v79
    buffer_store_dwordx4 v[64:67], v14, s[28:31], s12 offen sc1
    buffer_store_dwordx4 v[68:71], v14, s[28:31], s12 offen offset:512 sc1
    v_cvt_pk_bf16_f32 v80, v80, v81
    v_cvt_pk_bf16_f32 v81, v82, v83
    v_cvt_pk_bf16_f32 v82, v84, v85
    v_cvt_pk_bf16_f32 v83, v86, v87
    v_cvt_pk_bf16_f32 v84, v88, v89
    v_cvt_pk_bf16_f32 v85, v90, v91
    v_cvt_pk_bf16_f32 v86, v92, v93
    v_cvt_pk_bf16_f32 v87, v94, v95
    buffer_store_dwordx4 v[80:83], v14, s[28:31], s13 offen sc1
    buffer_store_dwordx4 v[84:87], v14, s[28:31], s13 offen offset:512 sc1
    s_barrier
    s_branch L_typj_100006
L_typ1_100005:
    s_waitcnt vmcnt(0) lgkmcnt(0)
    s_barrier
    ds_read_b128 v[128:131], v76 offset:0
    ds_read_b64_tr_b16 v[40:41], v15 offset:40960
    ds_read_b64_tr_b16 v[42:43], v15 offset:41472
    ds_read_b64_tr_b16 v[44:45], v0 offset:40960
    ds_read_b64_tr_b16 v[46:47], v0 offset:41472
    ds_read_b128 v[28:31], v81 offset:128
    ds_read_b128 v[132:135], v77 offset:0
    ds_read_b64_tr_b16 v[48:49], v15 offset:43008
    ds_read_b64_tr_b16 v[50:51], v15 offset:43520
    ds_read_b64_tr_b16 v[52:53], v0 offset:43008
    ds_read_b64_tr_b16 v[54:55], v0 offset:43520
    ds_read_b128 v[32:35], v81 offset:160
    s_waitcnt lgkmcnt(6)
    v_mfma_f32_32x32x16_bf16 v[96:111], v[40:43], v[128:131], 0
    ds_read_b128 v[136:139], v78 offset:0
    ds_read_b64_tr_b16 v[56:57], v15 offset:45056
    ds_read_b64_tr_b16 v[58:59], v15 offset:45568
    ds_read_b64_tr_b16 v[60:61], v0 offset:45056
    ds_read_b64_tr_b16 v[62:63], v0 offset:45568
    ds_read_b128 v[36:39], v81 offset:192
    v_mfma_f32_32x32x16_bf16 v[112:127], v[44:47], v[128:131], 0
    v_mfma_f32_16x16x32_bf16 v[64:67], v[28:31], v[128:131], 0
    s_waitcnt lgkmcnt(6)
    v_mfma_f32_32x32x16_bf16 v[96:111], v[48:51], v[132:135], v[96:111]
    ds_read_b128 v[140:143], v79 offset:0
    ds_read_b64_tr_b16 v[40:41], v15 offset:47104
    ds_read_b64_tr_b16 v[42:43], v15 offset:47616
    ds_read_b64_tr_b16 v[44:45], v0 offset:47104
    ds_read_b64_tr_b16 v[46:47], v0 offset:47616
    ds_read_b128 v[28:31], v81 offset:224
    v_mfma_f32_32x32x16_bf16 v[112:127], v[52:55], v[132:135], v[112:127]
    v_mfma_f32_16x16x32_bf16 v[64:67], v[32:35], v[132:135], v[64:67]
    s_waitcnt lgkmcnt(6)
    v_mfma_f32_32x32x16_bf16 v[96:111], v[56:59], v[136:139], v[96:111]
    s_barrier
    ds_read_b128 v[144:147], v76 offset:16384
    ds_read_b64_tr_b16 v[48:49], v15 offset:32768
    ds_read_b64_tr_b16 v[50:51], v15 offset:33280
    ds_read_b64_tr_b16 v[52:53], v0 offset:32768
    ds_read_b64_tr_b16 v[54:55], v0 offset:33280
    ds_read_b128 v[32:35], v81 offset:0
    v_mfma_f32_32x32x16_bf16 v[112:127], v[60:63], v[136:139], v[112:127]
    v_mfma_f32_16x16x32_bf16 v[64:67], v[36:39], v[136:139], v[64:67]
    s_waitcnt lgkmcnt(6)
    v_mfma_f32_32x32x16_bf16 v[96:111], v[40:43], v[140:143], v[96:111]
    ds_read_b128 v[148:151], v77 offset:16384
    ds_read_b64_tr_b16 v[56:57], v15 offset:34816
    ds_read_b64_tr_b16 v[58:59], v15 offset:35328
    ds_read_b64_tr_b16 v[60:61], v0 offset:34816
    ds_read_b64_tr_b16 v[62:63], v0 offset:35328
    ds_read_b128 v[36:39], v81 offset:32
    v_mfma_f32_32x32x16_bf16 v[112:127], v[44:47], v[140:143], v[112:127]
    v_mfma_f32_16x16x32_bf16 v[64:67], v[28:31], v[140:143], v[64:67]
    s_waitcnt lgkmcnt(6)
    v_mfma_f32_32x32x16_bf16 v[96:111], v[48:51], v[144:147], v[96:111]
    ds_read_b128 v[152:155], v78 offset:16384
    ds_read_b64_tr_b16 v[40:41], v15 offset:36864
    ds_read_b64_tr_b16 v[42:43], v15 offset:37376
    ds_read_b64_tr_b16 v[44:45], v0 offset:36864
    ds_read_b64_tr_b16 v[46:47], v0 offset:37376
    ds_read_b128 v[28:31], v81 offset:64
    v_mfma_f32_32x32x16_bf16 v[112:127], v[52:55], v[144:147], v[112:127]
    v_mfma_f32_16x16x32_bf16 v[64:67], v[32:35], v[144:147], v[64:67]
    s_waitcnt lgkmcnt(6)
    v_mfma_f32_32x32x16_bf16 v[96:111], v[56:59], v[148:151], v[96:111]
    ds_read_b128 v[156:159], v79 offset:16384
    ds_read_b64_tr_b16 v[48:49], v15 offset:38912
    ds_read_b64_tr_b16 v[50:51], v15 offset:39424
    ds_read_b64_tr_b16 v[52:53], v0 offset:38912
    ds_read_b64_tr_b16 v[54:55], v0 offset:39424
    ds_read_b128 v[32:35], v81 offset:96
    v_mfma_f32_32x32x16_bf16 v[112:127], v[60:63], v[148:151], v[112:127]
    v_mfma_f32_16x16x32_bf16 v[64:67], v[36:39], v[148:151], v[64:67]
    s_waitcnt lgkmcnt(6)
    v_mfma_f32_32x32x16_bf16 v[96:111], v[40:43], v[152:155], v[96:111]
    v_add_u32 v76, 49152, v76
    v_add_u32 v15, 49152, v15
    v_add_u32 v0, 49152, v0
    s_add_u32 s60, s60, 256
    s_and_b32 s60, s60, 1023
    v_add_u32 v81, s60, v80
    s_barrier
    ds_read_b128 v[160:163], v76 offset:0
    ds_read_b64_tr_b16 v[56:57], v15 offset:40960
    ds_read_b64_tr_b16 v[58:59], v15 offset:41472
    ds_read_b64_tr_b16 v[60:61], v0 offset:40960
    ds_read_b64_tr_b16 v[62:63], v0 offset:41472
    ds_read_b128 v[36:39], v81 offset:128
    v_mfma_f32_32x32x16_bf16 v[112:127], v[44:47], v[152:155], v[112:127]
    v_mfma_f32_16x16x32_bf16 v[64:67], v[28:31], v[152:155], v[64:67]
    s_waitcnt lgkmcnt(6)
    v_mfma_f32_32x32x16_bf16 v[96:111], v[48:51], v[156:159], v[96:111]
    v_add_u32 v77, 49152, v77
    ds_read_b128 v[164:167], v77 offset:0
    ds_read_b64_tr_b16 v[40:41], v15 offset:43008
    ds_read_b64_tr_b16 v[42:43], v15 offset:43520
    ds_read_b64_tr_b16 v[44:45], v0 offset:43008
    ds_read_b64_tr_b16 v[46:47], v0 offset:43520
    ds_read_b128 v[28:31], v81 offset:160
    v_mfma_f32_32x32x16_bf16 v[112:127], v[52:55], v[156:159], v[112:127]
    v_mfma_f32_16x16x32_bf16 v[64:67], v[32:35], v[156:159], v[64:67]
    s_waitcnt lgkmcnt(6)
    v_mfma_f32_32x32x16_bf16 v[96:111], v[56:59], v[160:163], v[96:111]
    v_add_u32 v78, 49152, v78
    ds_read_b128 v[168:171], v78 offset:0
    ds_read_b64_tr_b16 v[48:49], v15 offset:45056
    ds_read_b64_tr_b16 v[50:51], v15 offset:45568
    ds_read_b64_tr_b16 v[52:53], v0 offset:45056
    ds_read_b64_tr_b16 v[54:55], v0 offset:45568
    ds_read_b128 v[32:35], v81 offset:192
    v_mfma_f32_32x32x16_bf16 v[112:127], v[60:63], v[160:163], v[112:127]
    v_mfma_f32_16x16x32_bf16 v[64:67], v[36:39], v[160:163], v[64:67]
    s_waitcnt lgkmcnt(6)
    v_mfma_f32_32x32x16_bf16 v[96:111], v[40:43], v[164:167], v[96:111]
    v_add_u32 v79, 49152, v79
    s_branch L_pgo1
L_pg1:
    s_setpc_b64 s[58:59]
L_pgo1:
    ds_read_b128 v[172:175], v79 offset:0
    ds_read_b64_tr_b16 v[56:57], v15 offset:47104
    ds_read_b64_tr_b16 v[58:59], v15 offset:47616
    ds_read_b64_tr_b16 v[60:61], v0 offset:47104
    ds_read_b64_tr_b16 v[62:63], v0 offset:47616
    ds_read_b128 v[36:39], v81 offset:224
    v_mfma_f32_32x32x16_bf16 v[112:127], v[44:47], v[164:167], v[112:127]
    v_mfma_f32_16x16x32_bf16 v[64:67], v[28:31], v[164:167], v[64:67]
    s_waitcnt lgkmcnt(6)
    v_mfma_f32_32x32x16_bf16 v[96:111], v[48:51], v[168:171], v[96:111]
    s_barrier
    ds_read_b128 v[176:179], v76 offset:16384
    ds_read_b64_tr_b16 v[40:41], v15 offset:32768
    ds_read_b64_tr_b16 v[42:43], v15 offset:33280
    ds_read_b64_tr_b16 v[44:45], v0 offset:32768
    ds_read_b64_tr_b16 v[46:47], v0 offset:33280
    ds_read_b128 v[28:31], v81 offset:0
    v_mfma_f32_32x32x16_bf16 v[112:127], v[52:55], v[168:171], v[112:127]
    v_mfma_f32_16x16x32_bf16 v[64:67], v[32:35], v[168:171], v[64:67]
    s_waitcnt lgkmcnt(6)
    v_mfma_f32_32x32x16_bf16 v[96:111], v[56:59], v[172:175], v[96:111]
    ds_read_b128 v[180:183], v77 offset:16384
    ds_read_b64_tr_b16 v[48:49], v15 offset:34816
    ds_read_b64_tr_b16 v[50:51], v15 offset:35328
    ds_read_b64_tr_b16 v[52:53], v0 offset:34816
    ds_read_b64_tr_b16 v[54:55], v0 offset:35328
    ds_read_b128 v[32:35], v81 offset:32
    v_mfma_f32_32x32x16_bf16 v[112:127], v[60:63], v[172:175], v[112:127]
    v_mfma_f32_16x16x32_bf16 v[64:67], v[36:39], v[172:175], v[64:67]
    s_waitcnt lgkmcnt(6)
    v_mfma_f32_32x32x16_bf16 v[96:111], v[40:43], v[176:179], v[96:111]
    ds_read_b128 v[184:187], v78 offset:16384
    ds_read_b64_tr_b16 v[56:57], v15 offset:36864
    ds_read_b64_tr_b16 v[58:59], v15 offset:37376
    ds_read_b64_tr_b16 v[60:61], v0 offset:36864
    ds_read_b64_tr_b16 v[62:63], v0 offset:37376
    ds_read_b128 v[36:39], v81 offset:64
    v_mfma_f32_32x32x16_bf16 v[112:127], v[44:47], v[176:179], v[112:127]
    v_mfma_f32_16x16x32_bf16 v[64:67], v[28:31], v[176:179], v[64:67]
    s_waitcnt lgkmcnt(6)
    v_mfma_f32_32x32x16_bf16 v[96:111], v[48:51], v[180:183], v[96:111]
    ds_read_b128 v[188:191], v79 offset:16384
    ds_read_b64_tr_b16 v[40:41], v15 offset:38912
    ds_read_b64_tr_b16 v[42:43], v15 offset:39424
    ds_read_b64_tr_b16 v[44:45], v0 offset:38912
    ds_read_b64_tr_b16 v[46:47], v0 offset:39424
    ds_read_b128 v[28:31], v81 offset:96
    v_mfma_f32_32x32x16_bf16 v[112:127], v[52:55], v[180:183], v[112:127]
    v_mfma_f32_16x16x32_bf16 v[64:67], v[32:35], v[180:183], v[64:67]
    s_waitcnt lgkmcnt(6)
    v_mfma_f32_32x32x16_bf16 v[96:111], v[56:59], v[184:187], v[96:111]
    v_add_u32 v76, 49152, v76
    v_add_u32 v15, 49152, v15
    v_add_u32 v0, 49152, v0
    s_add_u32 s60, s60, 256
    s_and_b32 s60, s60, 1023
    v_add_u32 v81, s60, v80
    s_barrier
    ds_read_b128 v[192:195], v76 offset:0
    ds_read_b64_tr_b16 v[48:49], v15 offset:40960
    ds_read_b64_tr_b16 v[50:51], v15 offset:41472
    ds_read_b64_tr_b16 v[52:53], v0 offset:40960
    ds_read_b64_tr_b16 v[54:55], v0 offset:41472
    ds_read_b128 v[32:35], v81 offset:128
    v_mfma_f32_32x32x16_bf16 v[112:127], v[60:63], v[184:187], v[112:127]
    v_mfma_f32_16x16x32_bf16 v[64:67], v[36:39], v[184:187], v[64:67]
    s_waitcnt lgkmcnt(6)
    v_mfma_f32_32x32x16_bf16 v[96:111], v[40:43], v[188:191], v[96:111]
    v_add_u32 v77, 49152, v77
    ds_read_b128 v[196:199], v77 offset:0
    ds_read_b64_tr_b16 v[56:57], v15 offset:43008
    ds_read_b64_tr_b16 v[58:59], v15 offset:43520
    ds_read_b64_tr_b16 v[60:61], v0 offset:43008
    ds_read_b64_tr_b16 v[62:63], v0 offset:43520
    ds_read_b128 v[36:39], v81 offset:160
    v_mfma_f32_32x32x16_bf16 v[112:127], v[44:47], v[188:191], v[112:127]
    v_mfma_f32_16x16x32_bf16 v[64:67], v[28:31], v[188:191], v[64:67]
    s_waitcnt lgkmcnt(6)
    v_mfma_f32_32x32x16_bf16 v[96:111], v[48:51], v[192:195], v[96:111]
    v_add_u32 v78, 49152, v78
    ds_read_b128 v[200:203], v78 offset:0
    ds_read_b64_tr_b16 v[40:41], v15 offset:45056
    ds_read_b64_tr_b16 v[42:43], v15 offset:45568
    ds_read_b64_tr_b16 v[44:45], v0 offset:45056
    ds_read_b64_tr_b16 v[46:47], v0 offset:45568
    ds_read_b128 v[28:31], v81 offset:192
    v_mfma_f32_32x32x16_bf16 v[112:127], v[52:55], v[192:195], v[112:127]
    v_mfma_f32_16x16x32_bf16 v[64:67], v[32:35], v[192:195], v[64:67]
    s_waitcnt lgkmcnt(6)
    v_mfma_f32_32x32x16_bf16 v[96:111], v[56:59], v[196:199], v[96:111]
    v_add_u32 v79, 49152, v79
    ds_read_b128 v[204:207], v79 offset:0
    ds_read_b64_tr_b16 v[48:49], v15 offset:47104
    ds_read_b64_tr_b16 v[50:51], v15 offset:47616
    ds_read_b64_tr_b16 v[52:53], v0 offset:47104
    ds_read_b64_tr_b16 v[54:55], v0 offset:47616
    ds_read_b128 v[32:35], v81 offset:224
    v_mfma_f32_32x32x16_bf16 v[112:127], v[60:63], v[196:199], v[112:127]
    v_mfma_f32_16x16x32_bf16 v[64:67], v[36:39], v[196:199], v[64:67]
    s_waitcnt lgkmcnt(6)
    v_mfma_f32_32x32x16_bf16 v[96:111], v[40:43], v[200:203], v[96:111]
    s_barrier
    ds_read_b128 v[208:211], v76 offset:16384
    ds_read_b64_tr_b16 v[56:57], v15 offset:32768
    ds_read_b64_tr_b16 v[58:59], v15 offset:33280
    ds_read_b64_tr_b16 v[60:61], v0 offset:32768
    ds_read_b64_tr_b16 v[62:63], v0 offset:33280
    ds_read_b128 v[36:39], v81 offset:0
    v_mfma_f32_32x32x16_bf16 v[112:127], v[44:47], v[200:203], v[112:127]
    v_mfma_f32_16x16x32_bf16 v[64:67], v[28:31], v[200:203], v[64:67]
    s_waitcnt lgkmcnt(6)
    v_mfma_f32_32x32x16_bf16 v[96:111], v[48:51], v[204:207], v[96:111]
    ds_read_b128 v[212:215], v77 offset:16384
    ds_read_b64_tr_b16 v[40:41], v15 offset:34816
    ds_read_b64_tr_b16 v[42:43], v15 offset:35328
    ds_read_b64_tr_b16 v[44:45], v0 offset:34816
    ds_read_b64_tr_b16 v[46:47], v0 offset:35328
    ds_read_b128 v[28:31], v81 offset:32
    v_mfma_f32_32x32x16_bf16 v[112:127], v[52:55], v[204:207], v[112:127]
    v_mfma_f32_16x16x32_bf16 v[64:67], v[32:35], v[204:207], v[64:67]
    s_waitcnt lgkmcnt(6)
    v_mfma_f32_32x32x16_bf16 v[96:111], v[56:59], v[208:211], v[96:111]
    ds_read_b128 v[216:219], v78 offset:16384
    ds_read_b64_tr_b16 v[48:49], v15 offset:36864
    ds_read_b64_tr_b16 v[50:51], v15 offset:37376
    ds_read_b64_tr_b16 v[52:53], v0 offset:36864
    ds_read_b64_tr_b16 v[54:55], v0 offset:37376
    ds_read_b128 v[32:35], v81 offset:64
    v_mfma_f32_32x32x16_bf16 v[112:127], v[60:63], v[208:211], v[112:127]
    v_mfma_f32_16x16x32_bf16 v[64:67], v[36:39], v[208:211], v[64:67]
    s_waitcnt lgkmcnt(6)
    v_mfma_f32_32x32x16_bf16 v[96:111], v[40:43], v[212:215], v[96:111]
    ds_read_b128 v[220:223], v79 offset:16384
    ds_read_b64_tr_b16 v[56:57], v15 offset:38912
    ds_read_b64_tr_b16 v[58:59], v15 offset:39424
    ds_read_b64_tr_b16 v[60:61], v0 offset:38912
    ds_read_b64_tr_b16 v[62:63], v0 offset:39424
    ds_read_b128 v[36:39], v81 offset:96
    v_mfma_f32_32x32x16_bf16 v[112:127], v[44:47], v[212:215], v[112:127]
    v_mfma_f32_16x16x32_bf16 v[64:67], v[28:31], v[212:215], v[64:67]
    s_waitcnt lgkmcnt(6)
    v_mfma_f32_32x32x16_bf16 v[96:111], v[48:51], v[216:219], v[96:111]
    v_subrev_u32 v76, 98304, v76
    v_subrev_u32 v15, 98304, v15
    v_subrev_u32 v0, 98304, v0
    s_add_u32 s60, s60, 256
    s_and_b32 s60, s60, 1023
    v_add_u32 v81, s60, v80
    s_barrier
    ds_read_b128 v[224:227], v76 offset:0
    ds_read_b64_tr_b16 v[40:41], v15 offset:40960
    ds_read_b64_tr_b16 v[42:43], v15 offset:41472
    ds_read_b64_tr_b16 v[44:45], v0 offset:40960
    ds_read_b64_tr_b16 v[46:47], v0 offset:41472
    ds_read_b128 v[28:31], v81 offset:128
    v_mfma_f32_32x32x16_bf16 v[112:127], v[52:55], v[216:219], v[112:127]
    v_mfma_f32_16x16x32_bf16 v[64:67], v[32:35], v[216:219], v[64:67]
    s_waitcnt lgkmcnt(6)
    v_mfma_f32_32x32x16_bf16 v[96:111], v[56:59], v[220:223], v[96:111]
    v_subrev_u32 v77, 98304, v77
    ds_read_b128 v[228:231], v77 offset:0
    ds_read_b64_tr_b16 v[48:49], v15 offset:43008
    ds_read_b64_tr_b16 v[50:51], v15 offset:43520
    ds_read_b64_tr_b16 v[52:53], v0 offset:43008
    ds_read_b64_tr_b16 v[54:55], v0 offset:43520
    ds_read_b128 v[32:35], v81 offset:160
    v_mfma_f32_32x32x16_bf16 v[112:127], v[60:63], v[220:223], v[112:127]
    v_mfma_f32_16x16x32_bf16 v[64:67], v[36:39], v[220:223], v[64:67]
    s_waitcnt lgkmcnt(6)
    v_mfma_f32_32x32x16_bf16 v[96:111], v[40:43], v[224:227], v[96:111]
    v_subrev_u32 v78, 98304, v78
    ds_read_b128 v[232:235], v78 offset:0
    ds_read_b64_tr_b16 v[56:57], v15 offset:45056
    ds_read_b64_tr_b16 v[58:59], v15 offset:45568
    ds_read_b64_tr_b16 v[60:61], v0 offset:45056
    ds_read_b64_tr_b16 v[62:63], v0 offset:45568
    ds_read_b128 v[36:39], v81 offset:192
    v_mfma_f32_32x32x16_bf16 v[112:127], v[44:47], v[224:227], v[112:127]
    v_mfma_f32_16x16x32_bf16 v[64:67], v[28:31], v[224:227], v[64:67]
    s_waitcnt lgkmcnt(6)
    v_mfma_f32_32x32x16_bf16 v[96:111], v[48:51], v[228:231], v[96:111]
    v_subrev_u32 v79, 98304, v79
    ds_read_b128 v[236:239], v79 offset:0
    ds_read_b64_tr_b16 v[40:41], v15 offset:47104
    ds_read_b64_tr_b16 v[42:43], v15 offset:47616
    ds_read_b64_tr_b16 v[44:45], v0 offset:47104
    ds_read_b64_tr_b16 v[46:47], v0 offset:47616
    ds_read_b128 v[28:31], v81 offset:224
    v_mfma_f32_32x32x16_bf16 v[112:127], v[52:55], v[228:231], v[112:127]
    v_mfma_f32_16x16x32_bf16 v[64:67], v[32:35], v[228:231], v[64:67]
    s_waitcnt lgkmcnt(6)
    v_mfma_f32_32x32x16_bf16 v[96:111], v[56:59], v[232:235], v[96:111]
    s_barrier
    ds_read_b128 v[240:243], v76 offset:16384
    ds_read_b64_tr_b16 v[48:49], v15 offset:32768
    ds_read_b64_tr_b16 v[50:51], v15 offset:33280
    ds_read_b64_tr_b16 v[52:53], v0 offset:32768
    ds_read_b64_tr_b16 v[54:55], v0 offset:33280
    ds_read_b128 v[32:35], v81 offset:0
    v_mfma_f32_32x32x16_bf16 v[112:127], v[60:63], v[232:235], v[112:127]
    v_mfma_f32_16x16x32_bf16 v[64:67], v[36:39], v[232:235], v[64:67]
    s_waitcnt lgkmcnt(6)
    v_mfma_f32_32x32x16_bf16 v[96:111], v[40:43], v[236:239], v[96:111]
    ds_read_b128 v[244:247], v77 offset:16384
    ds_read_b64_tr_b16 v[56:57], v15 offset:34816
    ds_read_b64_tr_b16 v[58:59], v15 offset:35328
    ds_read_b64_tr_b16 v[60:61], v0 offset:34816
    ds_read_b64_tr_b16 v[62:63], v0 offset:35328
    ds_read_b128 v[36:39], v81 offset:32
    v_mfma_f32_32x32x16_bf16 v[112:127], v[44:47], v[236:239], v[112:127]
    v_mfma_f32_16x16x32_bf16 v[64:67], v[28:31], v[236:239], v[64:67]
    s_waitcnt lgkmcnt(6)
    v_mfma_f32_32x32x16_bf16 v[96:111], v[48:51], v[240:243], v[96:111]
    ds_read_b128 v[248:251], v78 offset:16384
    ds_read_b64_tr_b16 v[40:41], v15 offset:36864
    ds_read_b64_tr_b16 v[42:43], v15 offset:37376
    ds_read_b64_tr_b16 v[44:45], v0 offset:36864
    ds_read_b64_tr_b16 v[46:47], v0 offset:37376
    ds_read_b128 v[28:31], v81 offset:64
    v_mfma_f32_32x32x16_bf16 v[112:127], v[52:55], v[240:243], v[112:127]
    v_mfma_f32_16x16x32_bf16 v[64:67], v[32:35], v[240:243], v[64:67]
    s_waitcnt lgkmcnt(6)
    v_mfma_f32_32x32x16_bf16 v[96:111], v[56:59], v[244:247], v[96:111]
    ds_read_b128 v[252:255], v79 offset:16384
    ds_read_b64_tr_b16 v[48:49], v15 offset:38912
    ds_read_b64_tr_b16 v[50:51], v15 offset:39424
    ds_read_b64_tr_b16 v[52:53], v0 offset:38912
    ds_read_b64_tr_b16 v[54:55], v0 offset:39424
    ds_read_b128 v[32:35], v81 offset:96
    v_mfma_f32_32x32x16_bf16 v[112:127], v[60:63], v[244:247], v[112:127]
    v_mfma_f32_16x16x32_bf16 v[64:67], v[36:39], v[244:247], v[64:67]
    s_waitcnt lgkmcnt(6)
    v_mfma_f32_32x32x16_bf16 v[96:111], v[40:43], v[248:251], v[96:111]
    v_mfma_f32_32x32x16_bf16 v[112:127], v[44:47], v[248:251], v[112:127]
    v_mfma_f32_16x16x32_bf16 v[64:67], v[28:31], v[248:251], v[64:67]
    s_waitcnt lgkmcnt(0)
    v_mfma_f32_16x16x32_bf16 v[64:67], v[32:35], v[252:255], v[64:67]
    v_mfma_f32_32x32x16_bf16 v[96:111], v[48:51], v[252:255], v[96:111]
    v_mfma_f32_32x32x16_bf16 v[112:127], v[52:55], v[252:255], v[112:127]
    v_add_u32 v15, 81920, v15
    v_add_u32 v0, 81920, v0
    s_lshr_b32 s56, s48, 1
    s_lshl_b32 s56, s56, 3
    s_add_u32 s56, s56, s49
    s_lshl_b32 s56, s56, 2
    v_mul_f32 v12, 0xbfb8aa3b, v65
    v_exp_f32 v12, v12
    s_add_u32 s56, s56, s45
    s_lshl_b32 s56, s56, 7
    s_add_u32 s56, s56, 13238272
    v_add_f32 v12, 1.0, v12
    v_rcp_f32 v12, v12
    v_lshlrev_b32 v19, 2, v1
    s_waitcnt lgkmcnt(0)
    s_barrier
    s_load_dword s59, s[24:25], 0
    s_waitcnt lgkmcnt(0)
    s_bfe_u32 s57, s59, 0xc0008
    s_cmp_gt_u32 s57, 32
    s_cselect_b32 s24, 15, 0
    s_bfe_u32 s57, s59, 0x10014
    s_lshl_b32 s57, s57, 0
    s_xor_b32 s24, s24, s57
    s_bfe_u32 s57, s59, 0x10016
    s_lshl_b32 s57, s57, 1
    s_xor_b32 s24, s24, s57
    s_bfe_u32 s57, s59, 0x10018
    s_lshl_b32 s57, s57, 2
    s_xor_b32 s24, s24, s57
    s_bfe_u32 s57, s59, 0x1001a
    s_lshl_b32 s57, s57, 3
    s_xor_b32 s24, s24, s57
    s_lshr_b32 s57, s48, 3
    s_lshr_b32 s57, s24, s57
    s_and_b32 s57, s57, 1
    s_lshl_b32 s25, s57, 13
    s_add_u32 s4, s4, s25
    s_add_u32 s5, s5, s25
    s_add_u32 s12, s12, s25
    s_add_u32 s13, s13, s25
    s_add_u32 s6, s6, s25
    s_add_u32 s7, s7, s25
    s_barrier
    ds_read_b64_tr_b16 v[40:41], v15 offset:8192
    ds_read_b64_tr_b16 v[42:43], v15 offset:8704
    ds_read_b64_tr_b16 v[44:45], v0 offset:8192
    ds_read_b64_tr_b16 v[46:47], v0 offset:8704
    ds_read_b64_tr_b16 v[48:49], v15 offset:10240
    ds_read_b64_tr_b16 v[50:51], v15 offset:10752
    ds_read_b64_tr_b16 v[52:53], v0 offset:10240
    ds_read_b64_tr_b16 v[54:55], v0 offset:10752
    s_waitcnt lgkmcnt(4)
    v_mfma_f32_32x32x16_bf16 v[64:79], v[40:43], v[128:131], 0
    ds_read_b64_tr_b16 v[56:57], v15 offset:12288
    ds_read_b64_tr_b16 v[58:59], v15 offset:12800
    ds_read_b64_tr_b16 v[60:61], v0 offset:12288
    ds_read_b64_tr_b16 v[62:63], v0 offset:12800
    v_mfma_f32_32x32x16_bf16 v[80:95], v[44:47], v[128:131], 0
    s_waitcnt lgkmcnt(4)
    v_mfma_f32_32x32x16_bf16 v[64:79], v[48:51], v[132:135], v[64:79]
    ds_read_b64_tr_b16 v[40:41], v15 offset:14336
    ds_read_b64_tr_b16 v[42:43], v15 offset:14848
    ds_read_b64_tr_b16 v[44:45], v0 offset:14336
    ds_read_b64_tr_b16 v[46:47], v0 offset:14848
    v_mfma_f32_32x32x16_bf16 v[80:95], v[52:55], v[132:135], v[80:95]
    s_mov_b32 exec_hi, 0
    buffer_store_dword v12, v19, s[28:31], s56 offen sc1
    s_mov_b32 exec_hi, -1
    s_waitcnt lgkmcnt(4)
    v_mfma_f32_32x32x16_bf16 v[64:79], v[56:59], v[136:139], v[64:79]
    ds_read_b64_tr_b16 v[48:49], v15 offset:0
    ds_read_b64_tr_b16 v[50:51], v15 offset:512
    ds_read_b64_tr_b16 v[52:53], v0 offset:0
    ds_read_b64_tr_b16 v[54:55], v0 offset:512
    v_mfma_f32_32x32x16_bf16 v[80:95], v[60:63], v[136:139], v[80:95]
    v_mul_f32 v96, 0x3eb8aa3b, v96
    v_mul_f32 v97, 0x3eb8aa3b, v97
    v_mul_f32 v98, 0x3eb8aa3b, v98
    s_waitcnt lgkmcnt(4)
    v_mfma_f32_32x32x16_bf16 v[64:79], v[40:43], v[140:143], v[64:79]
    ds_read_b64_tr_b16 v[56:57], v15 offset:2048
    ds_read_b64_tr_b16 v[58:59], v15 offset:2560
    ds_read_b64_tr_b16 v[60:61], v0 offset:2048
    ds_read_b64_tr_b16 v[62:63], v0 offset:2560
    v_mfma_f32_32x32x16_bf16 v[80:95], v[44:47], v[140:143], v[80:95]
    v_mul_f32 v99, 0x3eb8aa3b, v99
    v_mul_f32 v100, 0x3eb8aa3b, v100
    v_mul_f32 v101, 0x3eb8aa3b, v101
    s_waitcnt lgkmcnt(4)
    v_mfma_f32_32x32x16_bf16 v[64:79], v[48:51], v[144:147], v[64:79]
    ds_read_b64_tr_b16 v[40:41], v15 offset:4096
    ds_read_b64_tr_b16 v[42:43], v15 offset:4608
    ds_read_b64_tr_b16 v[44:45], v0 offset:4096
    ds_read_b64_tr_b16 v[46:47], v0 offset:4608
    v_mfma_f32_32x32x16_bf16 v[80:95], v[52:55], v[144:147], v[80:95]
    v_mul_f32 v102, 0x3eb8aa3b, v102
    v_mul_f32 v103, 0x3eb8aa3b, v103
    v_mul_f32 v104, 0x3eb8aa3b, v104
    s_waitcnt lgkmcnt(4)
    v_mfma_f32_32x32x16_bf16 v[64:79], v[56:59], v[148:151], v[64:79]
    ds_read_b64_tr_b16 v[48:49], v15 offset:6144
    ds_read_b64_tr_b16 v[50:51], v15 offset:6656
    ds_read_b64_tr_b16 v[52:53], v0 offset:6144
    ds_read_b64_tr_b16 v[54:55], v0 offset:6656
    v_mfma_f32_32x32x16_bf16 v[80:95], v[60:63], v[148:151], v[80:95]
    v_mul_f32 v105, 0x3eb8aa3b, v105
    v_mul_f32 v106, 0x3eb8aa3b, v106
    v_mul_f32 v107, 0x3eb8aa3b, v107
    s_waitcnt lgkmcnt(4)
    v_mfma_f32_32x32x16_bf16 v[64:79], v[40:43], v[152:155], v[64:79]
    s_barrier
    ds_read_b64_tr_b16 v[56:57], v15 offset:24576
    ds_read_b64_tr_b16 v[58:59], v15 offset:25088
    ds_read_b64_tr_b16 v[60:61], v0 offset:24576
    ds_read_b64_tr_b16 v[62:63], v0 offset:25088
    v_mfma_f32_32x32x16_bf16 v[80:95], v[44:47], v[152:155], v[80:95]
    v_mul_f32 v108, 0x3eb8aa3b, v108
    v_mul_f32 v109, 0x3eb8aa3b, v109
    v_mul_f32 v110, 0x3eb8aa3b, v110
    s_waitcnt lgkmcnt(4)
    v_mfma_f32_32x32x16_bf16 v[64:79], v[48:51], v[156:159], v[64:79]
    ds_read_b64_tr_b16 v[40:41], v15 offset:26624
    ds_read_b64_tr_b16 v[42:43], v15 offset:27136
    ds_read_b64_tr_b16 v[44:45], v0 offset:26624
    ds_read_b64_tr_b16 v[46:47], v0 offset:27136
    v_mfma_f32_32x32x16_bf16 v[80:95], v[52:55], v[156:159], v[80:95]
    v_mul_f32 v111, 0x3eb8aa3b, v111
    v_cvt_pk_bf16_f32 v96, v96, v97
    v_cvt_pk_bf16_f32 v97, v98, v99
    s_waitcnt lgkmcnt(4)
    v_mfma_f32_32x32x16_bf16 v[64:79], v[56:59], v[160:163], v[64:79]
    ds_read_b64_tr_b16 v[48:49], v15 offset:28672
    ds_read_b64_tr_b16 v[50:51], v15 offset:29184
    ds_read_b64_tr_b16 v[52:53], v0 offset:28672
    ds_read_b64_tr_b16 v[54:55], v0 offset:29184
    v_mfma_f32_32x32x16_bf16 v[80:95], v[60:63], v[160:163], v[80:95]
    v_cvt_pk_bf16_f32 v98, v100, v101
    v_cvt_pk_bf16_f32 v99, v102, v103
    v_cvt_pk_bf16_f32 v100, v104, v105
    s_barrier
    s_waitcnt lgkmcnt(4)
    v_mfma_f32_32x32x16_bf16 v[64:79], v[40:43], v[164:167], v[64:79]
    ds_read_b64_tr_b16 v[56:57], v15 offset:30720
    ds_read_b64_tr_b16 v[58:59], v15 offset:31232
    ds_read_b64_tr_b16 v[60:61], v0 offset:30720
    ds_read_b64_tr_b16 v[62:63], v0 offset:31232
    v_mfma_f32_32x32x16_bf16 v[80:95], v[44:47], v[164:167], v[80:95]
    v_cvt_pk_bf16_f32 v101, v106, v107
    v_cvt_pk_bf16_f32 v102, v108, v109
    v_cvt_pk_bf16_f32 v103, v110, v111
    s_waitcnt lgkmcnt(4)
    v_mfma_f32_32x32x16_bf16 v[64:79], v[48:51], v[168:171], v[64:79]
    ds_read_b64_tr_b16 v[40:41], v15 offset:16384
    ds_read_b64_tr_b16 v[42:43], v15 offset:16896
    ds_read_b64_tr_b16 v[44:45], v0 offset:16384
    ds_read_b64_tr_b16 v[46:47], v0 offset:16896
    v_mfma_f32_32x32x16_bf16 v[80:95], v[52:55], v[168:171], v[80:95]
    s_add_u32 s57, s4, 131072
    buffer_store_dwordx4 v[96:99], v2, s[28:31], s4 offen sc1
    buffer_store_dwordx4 v[100:103], v2, s[28:31], s57 offen sc1
    s_waitcnt lgkmcnt(4)
    v_mfma_f32_32x32x16_bf16 v[64:79], v[56:59], v[172:175], v[64:79]
    ds_read_b64_tr_b16 v[48:49], v15 offset:18432
    ds_read_b64_tr_b16 v[50:51], v15 offset:18944
    ds_read_b64_tr_b16 v[52:53], v0 offset:18432
    ds_read_b64_tr_b16 v[54:55], v0 offset:18944
    v_mfma_f32_32x32x16_bf16 v[80:95], v[60:63], v[172:175], v[80:95]
    v_mul_f32 v112, 0x3eb8aa3b, v112
    v_mul_f32 v113, 0x3eb8aa3b, v113
    v_mul_f32 v114, 0x3eb8aa3b, v114
    s_waitcnt lgkmcnt(4)
    v_mfma_f32_32x32x16_bf16 v[64:79], v[40:43], v[176:179], v[64:79]
    ds_read_b64_tr_b16 v[56:57], v15 offset:20480
    ds_read_b64_tr_b16 v[58:59], v15 offset:20992
    ds_read_b64_tr_b16 v[60:61], v0 offset:20480
    ds_read_b64_tr_b16 v[62:63], v0 offset:20992
    v_mfma_f32_32x32x16_bf16 v[80:95], v[44:47], v[176:179], v[80:95]
    v_mul_f32 v115, 0x3eb8aa3b, v115
    v_mul_f32 v116, 0x3eb8aa3b, v116
    v_mul_f32 v117, 0x3eb8aa3b, v117
    s_waitcnt lgkmcnt(4)
    v_mfma_f32_32x32x16_bf16 v[64:79], v[48:51], v[180:183], v[64:79]
    ds_read_b64_tr_b16 v[40:41], v15 offset:22528
    ds_read_b64_tr_b16 v[42:43], v15 offset:23040
    ds_read_b64_tr_b16 v[44:45], v0 offset:22528
    ds_read_b64_tr_b16 v[46:47], v0 offset:23040
    v_mfma_f32_32x32x16_bf16 v[80:95], v[52:55], v[180:183], v[80:95]
    v_mul_f32 v118, 0x3eb8aa3b, v118
    v_mul_f32 v119, 0x3eb8aa3b, v119
    v_mul_f32 v120, 0x3eb8aa3b, v120
    s_waitcnt lgkmcnt(4)
    v_mfma_f32_32x32x16_bf16 v[64:79], v[56:59], v[184:187], v[64:79]
    s_barrier
    ds_read_b64_tr_b16 v[48:49], v15 offset:40960
    ds_read_b64_tr_b16 v[50:51], v15 offset:41472
    ds_read_b64_tr_b16 v[52:53], v0 offset:40960
    ds_read_b64_tr_b16 v[54:55], v0 offset:41472
    v_mfma_f32_32x32x16_bf16 v[80:95], v[60:63], v[184:187], v[80:95]
    v_mul_f32 v121, 0x3eb8aa3b, v121
    v_mul_f32 v122, 0x3eb8aa3b, v122
    v_mul_f32 v123, 0x3eb8aa3b, v123
    s_waitcnt lgkmcnt(4)
    v_mfma_f32_32x32x16_bf16 v[64:79], v[40:43], v[188:191], v[64:79]
    ds_read_b64_tr_b16 v[56:57], v15 offset:43008
    ds_read_b64_tr_b16 v[58:59], v15 offset:43520
    ds_read_b64_tr_b16 v[60:61], v0 offset:43008
    ds_read_b64_tr_b16 v[62:63], v0 offset:43520
    v_mfma_f32_32x32x16_bf16 v[80:95], v[44:47], v[188:191], v[80:95]
    v_mul_f32 v124, 0x3eb8aa3b, v124
    v_mul_f32 v125, 0x3eb8aa3b, v125
    v_mul_f32 v126, 0x3eb8aa3b, v126
    s_waitcnt lgkmcnt(4)
    v_mfma_f32_32x32x16_bf16 v[64:79], v[48:51], v[192:195], v[64:79]
    ds_read_b64_tr_b16 v[40:41], v15 offset:45056
    ds_read_b64_tr_b16 v[42:43], v15 offset:45568
    ds_read_b64_tr_b16 v[44:45], v0 offset:45056
    ds_read_b64_tr_b16 v[46:47], v0 offset:45568
    v_mfma_f32_32x32x16_bf16 v[80:95], v[52:55], v[192:195], v[80:95]
    v_mul_f32 v127, 0x3eb8aa3b, v127
    v_cvt_pk_bf16_f32 v112, v112, v113
    v_cvt_pk_bf16_f32 v113, v114, v115
    s_waitcnt lgkmcnt(4)
    v_mfma_f32_32x32x16_bf16 v[64:79], v[56:59], v[196:199], v[64:79]
    ds_read_b64_tr_b16 v[48:49], v15 offset:47104
    ds_read_b64_tr_b16 v[50:51], v15 offset:47616
    ds_read_b64_tr_b16 v[52:53], v0 offset:47104
    ds_read_b64_tr_b16 v[54:55], v0 offset:47616
    v_mfma_f32_32x32x16_bf16 v[80:95], v[60:63], v[196:199], v[80:95]
    v_cvt_pk_bf16_f32 v114, v116, v117
    v_cvt_pk_bf16_f32 v115, v118, v119
    v_cvt_pk_bf16_f32 v116, v120, v121
    s_waitcnt lgkmcnt(4)
    v_mfma_f32_32x32x16_bf16 v[64:79], v[40:43], v[200:203], v[64:79]
    ds_read_b64_tr_b16 v[56:57], v15 offset:32768
    ds_read_b64_tr_b16 v[58:59], v15 offset:33280
    ds_read_b64_tr_b16 v[60:61], v0 offset:32768
    ds_read_b64_tr_b16 v[62:63], v0 offset:33280
    v_mfma_f32_32x32x16_bf16 v[80:95], v[44:47], v[200:203], v[80:95]
    v_cvt_pk_bf16_f32 v117, v122, v123
    v_cvt_pk_bf16_f32 v118, v124, v125
    v_cvt_pk_bf16_f32 v119, v126, v127
    s_waitcnt lgkmcnt(4)
    v_mfma_f32_32x32x16_bf16 v[64:79], v[48:51], v[204:207], v[64:79]
    ds_read_b64_tr_b16 v[40:41], v15 offset:34816
    ds_read_b64_tr_b16 v[42:43], v15 offset:35328
    ds_read_b64_tr_b16 v[44:45], v0 offset:34816
    ds_read_b64_tr_b16 v[46:47], v0 offset:35328
    v_mfma_f32_32x32x16_bf16 v[80:95], v[52:55], v[204:207], v[80:95]
    s_add_u32 s57, s5, 131072
    buffer_store_dwordx4 v[112:115], v2, s[28:31], s5 offen sc1
    buffer_store_dwordx4 v[116:119], v2, s[28:31], s57 offen sc1
    s_waitcnt lgkmcnt(4)
    v_mfma_f32_32x32x16_bf16 v[64:79], v[56:59], v[208:211], v[64:79]
    ds_read_b64_tr_b16 v[48:49], v15 offset:36864
    ds_read_b64_tr_b16 v[50:51], v15 offset:37376
    ds_read_b64_tr_b16 v[52:53], v0 offset:36864
    ds_read_b64_tr_b16 v[54:55], v0 offset:37376
    v_mfma_f32_32x32x16_bf16 v[80:95], v[60:63], v[208:211], v[80:95]
    s_waitcnt lgkmcnt(4)
    v_mfma_f32_32x32x16_bf16 v[64:79], v[40:43], v[212:215], v[64:79]
    ds_read_b64_tr_b16 v[56:57], v15 offset:38912
    ds_read_b64_tr_b16 v[58:59], v15 offset:39424
    ds_read_b64_tr_b16 v[60:61], v0 offset:38912
    ds_read_b64_tr_b16 v[62:63], v0 offset:39424
    v_mfma_f32_32x32x16_bf16 v[80:95], v[44:47], v[212:215], v[80:95]
    s_waitcnt lgkmcnt(4)
    v_mfma_f32_32x32x16_bf16 v[64:79], v[48:51], v[216:219], v[64:79]
    s_barrier
    ds_read_b64_tr_b16 v[40:41], v15 offset:57344
    ds_read_b64_tr_b16 v[42:43], v15 offset:57856
    ds_read_b64_tr_b16 v[44:45], v0 offset:57344
    ds_read_b64_tr_b16 v[46:47], v0 offset:57856
    v_mfma_f32_32x32x16_bf16 v[80:95], v[52:55], v[216:219], v[80:95]
    s_waitcnt lgkmcnt(4)
    v_mfma_f32_32x32x16_bf16 v[64:79], v[56:59], v[220:223], v[64:79]
    ds_read_b64_tr_b16 v[48:49], v15 offset:59392
    ds_read_b64_tr_b16 v[50:51], v15 offset:59904
    ds_read_b64_tr_b16 v[52:53], v0 offset:59392
    ds_read_b64_tr_b16 v[54:55], v0 offset:59904
    v_mfma_f32_32x32x16_bf16 v[80:95], v[60:63], v[220:223], v[80:95]
    s_waitcnt lgkmcnt(4)
    v_mfma_f32_32x32x16_bf16 v[64:79], v[40:43], v[224:227], v[64:79]
    ds_read_b64_tr_b16 v[56:57], v15 offset:61440
    ds_read_b64_tr_b16 v[58:59], v15 offset:61952
    ds_read_b64_tr_b16 v[60:61], v0 offset:61440
    ds_read_b64_tr_b16 v[62:63], v0 offset:61952
    v_mfma_f32_32x32x16_bf16 v[80:95], v[44:47], v[224:227], v[80:95]
    s_waitcnt lgkmcnt(4)
    v_mfma_f32_32x32x16_bf16 v[64:79], v[48:51], v[228:231], v[64:79]
    ds_read_b64_tr_b16 v[40:41], v15 offset:63488
    ds_read_b64_tr_b16 v[42:43], v15 offset:64000
    ds_read_b64_tr_b16 v[44:45], v0 offset:63488
    ds_read_b64_tr_b16 v[46:47], v0 offset:64000
    v_mfma_f32_32x32x16_bf16 v[80:95], v[52:55], v[228:231], v[80:95]
    s_waitcnt lgkmcnt(4)
    v_mfma_f32_32x32x16_bf16 v[64:79], v[56:59], v[232:235], v[64:79]
    ds_read_b64_tr_b16 v[48:49], v15 offset:49152
    ds_read_b64_tr_b16 v[50:51], v15 offset:49664
    ds_read_b64_tr_b16 v[52:53], v0 offset:49152
    ds_read_b64_tr_b16 v[54:55], v0 offset:49664
    v_mfma_f32_32x32x16_bf16 v[80:95], v[60:63], v[232:235], v[80:95]
    s_waitcnt lgkmcnt(4)
    v_mfma_f32_32x32x16_bf16 v[64:79], v[40:43], v[236:239], v[64:79]
    ds_read_b64_tr_b16 v[56:57], v15 offset:51200
    ds_read_b64_tr_b16 v[58:59], v15 offset:51712
    ds_read_b64_tr_b16 v[60:61], v0 offset:51200
    ds_read_b64_tr_b16 v[62:63], v0 offset:51712
    v_mfma_f32_32x32x16_bf16 v[80:95], v[44:47], v[236:239], v[80:95]
    s_waitcnt lgkmcnt(4)
    v_mfma_f32_32x32x16_bf16 v[64:79], v[48:51], v[240:243], v[64:79]
    ds_read_b64_tr_b16 v[40:41], v15 offset:53248
    ds_read_b64_tr_b16 v[42:43], v15 offset:53760
    ds_read_b64_tr_b16 v[44:45], v0 offset:53248
    ds_read_b64_tr_b16 v[46:47], v0 offset:53760
    v_mfma_f32_32x32x16_bf16 v[80:95], v[52:55], v[240:243], v[80:95]
    s_waitcnt lgkmcnt(4)
    v_mfma_f32_32x32x16_bf16 v[64:79], v[56:59], v[244:247], v[64:79]
    ds_read_b64_tr_b16 v[48:49], v15 offset:55296
    ds_read_b64_tr_b16 v[50:51], v15 offset:55808
    ds_read_b64_tr_b16 v[52:53], v0 offset:55296
    s_branch L_pgo2
L_pg2:
    s_setpc_b64 s[58:59]
L_pgo2:
    ds_read_b64_tr_b16 v[54:55], v0 offset:55808
    v_mfma_f32_32x32x16_bf16 v[80:95], v[60:63], v[244:247], v[80:95]
    s_waitcnt lgkmcnt(4)
    v_mfma_f32_32x32x16_bf16 v[64:79], v[40:43], v[248:251], v[64:79]
    v_mfma_f32_32x32x16_bf16 v[80:95], v[44:47], v[248:251], v[80:95]
    s_waitcnt vmcnt(0) lgkmcnt(0)
    v_mfma_f32_32x32x16_bf16 v[64:79], v[48:51], v[252:255], v[64:79]
    v_mfma_f32_32x32x16_bf16 v[80:95], v[52:55], v[252:255], v[80:95]
    v_mfma_f32_32x32x16_bf16 v[112:127], v[20:23], v[4:7], 0
    v_mfma_f32_32x32x16_bf16 v[112:127], v[24:27], v[8:11], v[112:127]
    v_lshrrev_b32 v19, 5, v1
    v_lshlrev_b32 v19, 9, v19
    v_sub_u32 v15, v15, v19
    v_subrev_u32 v15, 65536, v15
    s_nop 5
    v_cvt_pk_bf16_f32 v64, v64, v65
    v_cvt_pk_bf16_f32 v65, v66, v67
    v_cvt_pk_bf16_f32 v66, v68, v69
    v_cvt_pk_bf16_f32 v67, v70, v71
    v_cvt_pk_bf16_f32 v68, v72, v73
    v_cvt_pk_bf16_f32 v69, v74, v75
    v_cvt_pk_bf16_f32 v70, v76, v77
    v_cvt_pk_bf16_f32 v71, v78, v79
    s_add_u32 s57, s12, 131072
    buffer_store_dwordx4 v[64:67], v2, s[28:31], s12 offen sc1
    buffer_store_dwordx4 v[68:71], v2, s[28:31], s57 offen sc1
    v_cvt_pk_bf16_f32 v80, v80, v81
    v_cvt_pk_bf16_f32 v81, v82, v83
    v_cvt_pk_bf16_f32 v82, v84, v85
    v_cvt_pk_bf16_f32 v83, v86, v87
    v_cvt_pk_bf16_f32 v84, v88, v89
    v_cvt_pk_bf16_f32 v85, v90, v91
    v_cvt_pk_bf16_f32 v86, v92, v93
    v_cvt_pk_bf16_f32 v87, v94, v95
    s_add_u32 s57, s13, 131072
    buffer_store_dwordx4 v[80:83], v2, s[28:31], s13 offen sc1
    buffer_store_dwordx4 v[84:87], v2, s[28:31], s57 offen sc1
    s_waitcnt vmcnt(0)
    s_barrier
L_typj_100006:
    s_barrier
    ds_read_b128 v[128:131], v13 offset:0
    ds_read_b64_tr_b16 v[132:133], v15 offset:0
    ds_read_b64_tr_b16 v[134:135], v15 offset:1024
    ds_read_b128 v[136:139], v13 offset:1024
    ds_read_b64_tr_b16 v[140:141], v15 offset:2048
    ds_read_b64_tr_b16 v[142:143], v15 offset:3072
    ds_read_b128 v[144:147], v13 offset:2048
    ds_read_b64_tr_b16 v[148:149], v15 offset:4096
    ds_read_b64_tr_b16 v[150:151], v15 offset:5120
    ds_read_b128 v[152:155], v13 offset:3072
    ds_read_b64_tr_b16 v[156:157], v15 offset:6144
    ds_read_b64_tr_b16 v[158:159], v15 offset:7168
    s_waitcnt lgkmcnt(9)
    v_mfma_f32_32x32x16_bf16 v[112:127], v[132:135], v[128:131], v[112:127]
    ds_read_b128 v[160:163], v13 offset:4096
    ds_read_b64_tr_b16 v[164:165], v15 offset:8192
    ds_read_b64_tr_b16 v[166:167], v15 offset:9216
    s_waitcnt lgkmcnt(9)
    v_mfma_f32_32x32x16_bf16 v[112:127], v[140:143], v[136:139], v[112:127]
    ds_read_b128 v[128:131], v13 offset:5120
    ds_read_b64_tr_b16 v[132:133], v15 offset:10240
    ds_read_b64_tr_b16 v[134:135], v15 offset:11264
    s_lshl_b32 s58, s44, 10
    s_add_u32 s58, s58, 131072
    s_waitcnt lgkmcnt(9)
    v_mfma_f32_32x32x16_bf16 v[112:127], v[148:151], v[144:147], v[112:127]
    ds_read_b128 v[136:139], v13 offset:6144
    ds_read_b64_tr_b16 v[140:141], v15 offset:12288
    ds_read_b64_tr_b16 v[142:143], v15 offset:13312
    v_add_u32 v108, s58, v2
    v_and_b32 v0, 15, v1
    s_waitcnt lgkmcnt(9)
    v_mfma_f32_32x32x16_bf16 v[112:127], v[156:159], v[152:155], v[112:127]
    ds_read_b128 v[144:147], v13 offset:7168
    ds_read_b64_tr_b16 v[148:149], v15 offset:14336
    ds_read_b64_tr_b16 v[150:151], v15 offset:15360
    v_lshrrev_b32 v19, 5, v1
    v_lshlrev_b32 v0, 4, v0
    s_waitcnt lgkmcnt(9)
    v_mfma_f32_32x32x16_bf16 v[112:127], v[164:167], v[160:163], v[112:127]
    v_add_u32 v15, 16384, v15
    s_barrier
    ds_read_b128 v[152:155], v17 offset:0
    ds_read_b64_tr_b16 v[156:157], v15 offset:0
    ds_read_b64_tr_b16 v[158:159], v15 offset:1024
    v_lshl_add_u32 v0, v19, 8, v0
    s_add_u32 s58, s58, 16384
    s_waitcnt lgkmcnt(9)
    v_mfma_f32_32x32x16_bf16 v[112:127], v[132:135], v[128:131], v[112:127]
    ds_read_b128 v[160:163], v17 offset:1024
    ds_read_b64_tr_b16 v[164:165], v15 offset:2048
    ds_read_b64_tr_b16 v[166:167], v15 offset:3072
    v_add_u32 v109, s58, v0
    v_mov_b32 v48, 0x3f803f80
    s_waitcnt lgkmcnt(9)
    v_mfma_f32_32x32x16_bf16 v[112:127], v[140:143], v[136:139], v[112:127]
    ds_read_b128 v[128:131], v17 offset:2048
    ds_read_b64_tr_b16 v[132:133], v15 offset:4096
    ds_read_b64_tr_b16 v[134:135], v15 offset:5120
    v_mov_b32 v0, 0xffff
    v_mov_b32 v49, v48
    s_waitcnt lgkmcnt(9)
    v_mfma_f32_32x32x16_bf16 v[112:127], v[148:151], v[144:147], v[112:127]
    ds_read_b128 v[136:139], v17 offset:3072
    ds_read_b64_tr_b16 v[140:141], v15 offset:6144
    ds_read_b64_tr_b16 v[142:143], v15 offset:7168
    v_mov_b32 v50, v48
    v_mov_b32 v51, v48
    s_waitcnt lgkmcnt(9)
    v_mfma_f32_32x32x16_bf16 v[112:127], v[156:159], v[152:155], v[112:127]
    ds_read_b128 v[144:147], v17 offset:4096
    ds_read_b64_tr_b16 v[148:149], v15 offset:8192
    ds_read_b64_tr_b16 v[150:151], v15 offset:9216
    v_mov_b32 v52, v48
    v_mov_b32 v53, v48
    s_waitcnt lgkmcnt(9)
    v_mfma_f32_32x32x16_bf16 v[112:127], v[164:167], v[160:163], v[112:127]
    ds_read_b128 v[152:155], v17 offset:5120
    ds_read_b64_tr_b16 v[156:157], v15 offset:10240
    ds_read_b64_tr_b16 v[158:159], v15 offset:11264
    v_mov_b32 v54, v48
    v_mov_b32 v55, v48
    s_waitcnt lgkmcnt(9)
    v_mfma_f32_32x32x16_bf16 v[112:127], v[132:135], v[128:131], v[112:127]
    ds_read_b128 v[160:163], v17 offset:6144
    ds_read_b64_tr_b16 v[164:165], v15 offset:12288
    ds_read_b64_tr_b16 v[166:167], v15 offset:13312
    v_mov_b32 v56, v48
    v_mov_b32 v57, v48
    s_waitcnt lgkmcnt(9)
    v_mfma_f32_32x32x16_bf16 v[112:127], v[140:143], v[136:139], v[112:127]
    ds_read_b128 v[128:131], v17 offset:7168
    ds_read_b64_tr_b16 v[132:133], v15 offset:14336
    ds_read_b64_tr_b16 v[134:135], v15 offset:15360
    v_mov_b32 v58, v48
    v_mov_b32 v59, v48
    s_waitcnt lgkmcnt(9)
    v_mfma_f32_32x32x16_bf16 v[112:127], v[148:151], v[144:147], v[112:127]
    v_add_u32 v15, 16384, v15
    s_barrier
    ds_read_b128 v[136:139], v18 offset:0
    ds_read_b64_tr_b16 v[140:141], v15 offset:0
    ds_read_b64_tr_b16 v[142:143], v15 offset:1024
    v_mov_b32 v60, v48
    v_mov_b32 v61, v48
    s_waitcnt lgkmcnt(9)
    v_mfma_f32_32x32x16_bf16 v[112:127], v[156:159], v[152:155], v[112:127]
    ds_read_b128 v[144:147], v18 offset:1024
    ds_read_b64_tr_b16 v[148:149], v15 offset:2048
    ds_read_b64_tr_b16 v[150:151], v15 offset:3072
    v_mov_b32 v62, v48
    v_mov_b32 v63, v48
    s_waitcnt lgkmcnt(9)
    v_mfma_f32_32x32x16_bf16 v[112:127], v[164:167], v[160:163], v[112:127]
    ds_read_b128 v[152:155], v18 offset:2048
    ds_read_b64_tr_b16 v[156:157], v15 offset:4096
    ds_read_b64_tr_b16 v[158:159], v15 offset:5120
    v_cndmask_b32 v24, 0, v0, s[64:65]
    v_cndmask_b32 v24, v24, -1, s[66:67]
    s_waitcnt lgkmcnt(9)
    v_mfma_f32_32x32x16_bf16 v[112:127], v[132:135], v[128:131], v[112:127]
    ds_read_b128 v[160:163], v18 offset:3072
    ds_read_b64_tr_b16 v[164:165], v15 offset:6144
    ds_read_b64_tr_b16 v[166:167], v15 offset:7168
    v_cndmask_b32 v25, 0, v0, s[68:69]
    v_cndmask_b32 v25, v25, -1, s[70:71]
    s_waitcnt lgkmcnt(9)
    v_mfma_f32_32x32x16_bf16 v[112:127], v[140:143], v[136:139], v[112:127]
    ds_read_b128 v[128:131], v18 offset:4096
    ds_read_b64_tr_b16 v[132:133], v15 offset:8192
    ds_read_b64_tr_b16 v[134:135], v15 offset:9216
    v_cndmask_b32 v26, 0, v0, s[72:73]
    v_cndmask_b32 v26, v26, -1, s[74:75]
    s_waitcnt lgkmcnt(9)
    v_mfma_f32_32x32x16_bf16 v[112:127], v[148:151], v[144:147], v[112:127]
    ds_read_b128 v[136:139], v18 offset:5120
    ds_read_b64_tr_b16 v[140:141], v15 offset:10240
    ds_read_b64_tr_b16 v[142:143], v15 offset:11264
    v_cndmask_b32 v27, 0, v0, s[76:77]
    v_cndmask_b32 v27, v27, -1, s[78:79]
    s_waitcnt lgkmcnt(9)
    v_mfma_f32_32x32x16_bf16 v[112:127], v[156:159], v[152:155], v[112:127]
    ds_read_b128 v[144:147], v18 offset:6144
    ds_read_b64_tr_b16 v[148:149], v15 offset:12288
    ds_read_b64_tr_b16 v[150:151], v15 offset:13312
    v_cndmask_b32 v28, 0, v0, s[80:81]
    v_cndmask_b32 v28, v28, -1, s[82:83]
    s_waitcnt lgkmcnt(9)
    v_mfma_f32_32x32x16_bf16 v[112:127], v[164:167], v[160:163], v[112:127]
    ds_read_b128 v[152:155], v18 offset:7168
    ds_read_b64_tr_b16 v[156:157], v15 offset:14336
    ds_read_b64_tr_b16 v[158:159], v15 offset:15360
    v_cndmask_b32 v29, 0, v0, s[84:85]
    v_cndmask_b32 v29, v29, -1, s[86:87]
    s_waitcnt lgkmcnt(9)
    v_mfma_f32_32x32x16_bf16 v[112:127], v[132:135], v[128:131], v[112:127]
    v_add_u32 v15, 16384, v15
    s_waitcnt vmcnt(0)
    s_barrier
    ds_read_b128 v[160:163], v16 offset:0
    ds_read_b64_tr_b16 v[164:165], v15 offset:0
    ds_read_b64_tr_b16 v[166:167], v15 offset:1024
    v_cndmask_b32 v30, 0, v0, s[88:89]
    v_cndmask_b32 v30, v30, -1, s[90:91]
    s_waitcnt lgkmcnt(9)
    v_mfma_f32_32x32x16_bf16 v[112:127], v[140:143], v[136:139], v[112:127]
    ds_read_b128 v[128:131], v16 offset:1024
    ds_read_b64_tr_b16 v[132:133], v15 offset:2048
    ds_read_b64_tr_b16 v[134:135], v15 offset:3072
    v_cndmask_b32 v31, 0, v0, s[92:93]
    v_cndmask_b32 v31, v31, -1, s[94:95]
    s_waitcnt lgkmcnt(9)
    v_mfma_f32_32x32x16_bf16 v[112:127], v[148:151], v[144:147], v[112:127]
    ds_read_b128 v[136:139], v16 offset:2048
    ds_read_b64_tr_b16 v[140:141], v15 offset:4096
    ds_read_b64_tr_b16 v[142:143], v15 offset:5120
    s_sub_u32 s54, 8, s44
    s_cmp_eq_u32 s51, 0
    s_waitcnt lgkmcnt(9)
    v_mfma_f32_32x32x16_bf16 v[112:127], v[156:159], v[152:155], v[112:127]
    ds_read_b128 v[144:147], v16 offset:3072
    ds_read_b64_tr_b16 v[148:149], v15 offset:6144
    ds_read_b64_tr_b16 v[150:151], v15 offset:7168
    s_cselect_b32 s54, s54, 0
    s_waitcnt lgkmcnt(9)
    v_mfma_f32_32x32x16_bf16 v[112:127], v[164:167], v[160:163], v[112:127]
    ds_read_b128 v[152:155], v16 offset:4096
    ds_read_b64_tr_b16 v[156:157], v15 offset:8192
    ds_read_b64_tr_b16 v[158:159], v15 offset:9216
    s_waitcnt lgkmcnt(9)
    v_mfma_f32_32x32x16_bf16 v[112:127], v[132:135], v[128:131], v[112:127]
    ds_read_b128 v[160:163], v16 offset:5120
    ds_read_b64_tr_b16 v[164:165], v15 offset:10240
    ds_read_b64_tr_b16 v[166:167], v15 offset:11264
    s_lshl_b32 s56, s50, 3
    s_add_u32 s56, s56, s51
    s_lshl_b32 s56, s56, 3
    s_add_u32 s56, s56, s44
    s_lshl_b32 s56, s56, 10
    s_add_u32 s56, s56, 16777216
    s_andn2_b32 s59, s56, 0x1fff
    s_add_u32 s56, s56, s59
    s_andn2_b32 s59, s56, 0x1fffff
    s_add_u32 s56, s56, s59
    s_add_u32 s56, s56, s25
    buffer_load_dwordx4 v[20:23], v2, s[28:31], s56 offen sc1
    s_waitcnt lgkmcnt(9)
    v_mfma_f32_32x32x16_bf16 v[112:127], v[140:143], v[136:139], v[112:127]
    ds_read_b128 v[128:131], v16 offset:6144
    ds_read_b64_tr_b16 v[132:133], v15 offset:12288
    ds_read_b64_tr_b16 v[134:135], v15 offset:13312
    s_waitcnt lgkmcnt(9)
    v_mfma_f32_32x32x16_bf16 v[112:127], v[148:151], v[144:147], v[112:127]
    ds_read_b128 v[136:139], v16 offset:7168
    ds_read_b64_tr_b16 v[140:141], v15 offset:14336
    ds_read_b64_tr_b16 v[142:143], v15 offset:15360
    s_waitcnt lgkmcnt(9)
    v_mfma_f32_32x32x16_bf16 v[112:127], v[156:159], v[152:155], v[112:127]
    s_waitcnt lgkmcnt(6)
    v_mfma_f32_32x32x16_bf16 v[112:127], v[164:167], v[160:163], v[112:127]
    s_waitcnt lgkmcnt(3)
    v_mfma_f32_32x32x16_bf16 v[112:127], v[132:135], v[128:131], v[112:127]
    s_waitcnt lgkmcnt(0)
    v_mfma_f32_32x32x16_bf16 v[112:127], v[140:143], v[136:139], v[112:127]
    s_barrier
    s_nop 8
    v_lshlrev_b32 v19, 3, v1
    s_nop 0
    v_cvt_pk_bf16_f32 v4, v112, v113
    v_cvt_pk_bf16_f32 v5, v114, v115
    v_cvt_pk_bf16_f32 v6, v116, v117
    v_cvt_pk_bf16_f32 v7, v118, v119
    v_cvt_pk_bf16_f32 v8, v120, v121
    v_cvt_pk_bf16_f32 v9, v122, v123
    v_cvt_pk_bf16_f32 v10, v124, v125
    v_cvt_pk_bf16_f32 v11, v126, v127
    buffer_store_dwordx4 v[4:7], v2, s[28:31], s6 offen sc1
    buffer_store_dwordx4 v[8:11], v2, s[28:31], s6 offen offset:1024 sc1
    v_pk_add_f32 v[100:101], v[112:113], v[114:115]
    v_pk_mul_f32 v[102:103], v[112:113], v[112:113]
    v_pk_fma_f32 v[102:103], v[114:115], v[114:115], v[102:103]
    v_pk_add_f32 v[100:101], v[100:101], v[116:117]
    v_pk_fma_f32 v[102:103], v[116:117], v[116:117], v[102:103]
    v_pk_add_f32 v[100:101], v[100:101], v[118:119]
    v_pk_fma_f32 v[102:103], v[118:119], v[118:119], v[102:103]
    v_pk_add_f32 v[100:101], v[100:101], v[120:121]
    v_pk_fma_f32 v[102:103], v[120:121], v[120:121], v[102:103]
    v_pk_add_f32 v[100:101], v[100:101], v[122:123]
    v_pk_fma_f32 v[102:103], v[122:123], v[122:123], v[102:103]
    v_pk_add_f32 v[100:101], v[100:101], v[124:125]
    v_pk_fma_f32 v[102:103], v[124:125], v[124:125], v[102:103]
    v_pk_add_f32 v[100:101], v[100:101], v[126:127]
    v_pk_fma_f32 v[102:103], v[126:127], v[126:127], v[102:103]
    v_add_f32 v100, v100, v101
    v_add_f32 v101, v102, v103
    v_mov_b32 v102, v100
    v_mov_b32 v103, v101
    s_nop 1
    v_permlane32_swap_b32 v100, v102
    v_permlane32_swap_b32 v101, v103
    s_nop 0
    v_add_f32 v100, v100, v102
    v_add_f32 v101, v101, v103
    s_mov_b32 exec_hi, 0
    buffer_store_dwordx2 v[100:101], v19, s[28:31], s7 offen sc1
    s_mov_b32 exec_hi, -1
    s_waitcnt vmcnt(3)
    s_cmp_eq_u32 s51, 0
    s_cbranch_scc1 L_attg_100008
    s_barrier
    ds_read_b128 v[64:67], v108 offset:0
    ds_read_b128 v[68:71], v108 offset:8192
    ds_read_b128 v[72:75], v108 offset:1024
    ds_read_b128 v[76:79], v108 offset:2048
    ds_read_b128 v[80:83], v108 offset:3072
    ds_read_b128 v[84:87], v108 offset:4096
    ds_read_b128 v[88:91], v108 offset:5120
    ds_read_b128 v[92:95], v108 offset:6144
    ds_read_b128 v[96:99], v108 offset:7168
    s_waitcnt lgkmcnt(8)
    v_mfma_f32_32x32x16_bf16 v[144:159], v[64:67], v[20:23], 0
    s_waitcnt lgkmcnt(7)
    v_mfma_f32_32x32x16_bf16 v[128:143], v[68:71], v[20:23], 0
    s_nop 11
    v_cndmask_b32 v128, v144, v128, s[64:65]
    v_cndmask_b32 v129, v145, v129, s[66:67]
    v_cndmask_b32 v130, v146, v130, s[68:69]
    v_cndmask_b32 v131, v147, v131, s[70:71]
    v_cndmask_b32 v132, v148, v132, s[72:73]
    v_cndmask_b32 v133, v149, v133, s[74:75]
    s_waitcnt lgkmcnt(0)
    v_cndmask_b32 v134, v150, v134, s[76:77]
    v_cndmask_b32 v135, v151, v135, s[78:79]
    v_cndmask_b32 v136, v152, v136, s[80:81]
    v_cndmask_b32 v137, v153, v137, s[82:83]
    v_cndmask_b32 v138, v154, v138, s[84:85]
    v_cndmask_b32 v139, v155, v139, s[86:87]
    v_cndmask_b32 v140, v156, v140, s[88:89]
    v_cndmask_b32 v141, v157, v141, s[90:91]
    v_cndmask_b32 v142, v158, v142, s[92:93]
    v_cndmask_b32 v143, v159, v143, s[94:95]
    s_waitcnt vmcnt(0)
    s_barrier
    v_max_f32 v100, v128, v129
    v_max_f32 v101, v130, v131
    v_max3_f32 v100, v132, v133, v100
    v_max3_f32 v101, v134, v135, v101
    v_max3_f32 v100, v136, v137, v100
    v_max3_f32 v101, v138, v139, v101
    v_max3_f32 v100, v140, v141, v100
    v_max3_f32 v101, v142, v143, v101
    v_max_f32 v100, v100, v101
    v_mov_b32 v101, v100
    s_nop 1
    v_permlane32_swap_b32 v100, v101
    s_nop 0
    v_max_f32 v100, v100, v101
    v_sub_f32 v112, 0, v100
    v_mov_b32 v113, v112
    v_mov_b32 v114, v112
    v_mov_b32 v115, v112
    v_mov_b32 v116, v112
    v_mov_b32 v117, v112
    v_mov_b32 v118, v112
    v_mov_b32 v119, v112
    v_mov_b32 v120, v112
    v_mov_b32 v121, v112
    v_mov_b32 v122, v112
    v_mov_b32 v123, v112
    v_mov_b32 v124, v112
    v_mov_b32 v125, v112
    v_mov_b32 v126, v112
    v_mov_b32 v127, v112
    v_add_f32 v128, v128, v112
    v_add_f32 v129, v129, v113
    v_mfma_f32_32x32x16_bf16 v[144:159], v[72:75], v[20:23], v[112:127]
    v_add_f32 v130, v130, v114
    v_add_f32 v131, v131, v115
    v_add_f32 v132, v132, v116
    v_add_f32 v133, v133, v117
    v_add_f32 v134, v134, v118
    v_add_f32 v135, v135, v119
    v_add_f32 v136, v136, v120
    v_add_f32 v137, v137, v121
    v_add_f32 v138, v138, v122
    v_add_f32 v139, v139, v123
    v_add_f32 v140, v140, v124
    v_add_f32 v141, v141, v125
    v_add_f32 v142, v142, v126
    v_add_f32 v143, v143, v127
    v_exp_f32 v128, v128
    v_exp_f32 v129, v129
    v_exp_f32 v130, v130
    v_exp_f32 v131, v131
    v_exp_f32 v132, v132
    v_exp_f32 v133, v133
    v_exp_f32 v134, v134
    v_exp_f32 v135, v135
    v_exp_f32 v136, v136
    v_exp_f32 v137, v137
    v_exp_f32 v138, v138
    v_exp_f32 v139, v139
    v_exp_f32 v140, v140
    v_exp_f32 v141, v141
    v_exp_f32 v142, v142
    v_exp_f32 v143, v143
    v_cvt_pk_bf16_f32 v200, v128, v129
    v_cvt_pk_bf16_f32 v201, v130, v131
    v_cvt_pk_bf16_f32 v202, v132, v133
    v_cvt_pk_bf16_f32 v203, v134, v135
    v_cvt_pk_bf16_f32 v204, v136, v137
    v_cvt_pk_bf16_f32 v205, v138, v139
    v_cvt_pk_bf16_f32 v206, v140, v141
    v_cvt_pk_bf16_f32 v207, v142, v143
    v_mov_b32 v128, 0x3f803f80
    v_mov_b32 v129, v128
    v_mov_b32 v130, v128
    v_mov_b32 v131, v128
    v_mov_b32 v132, v128
    v_mov_b32 v133, v128
    v_mov_b32 v134, v128
    v_mov_b32 v135, v128
    s_waitcnt vmcnt(0)
    s_barrier
    s_mov_b64 exec, s[96:97]
    ds_read_b128 v[48:51], v109 offset:8192
    ds_read_b128 v[52:55], v109 offset:8704
    ds_read_b128 v[56:59], v109 offset:0
    ds_read_b128 v[60:63], v109 offset:512
    s_mov_b64 exec, -1
    v_and_b32 v192, v200, v24
    v_and_b32 v193, v201, v25
    v_and_b32 v194, v202, v26
    v_and_b32 v195, v203, v27
    v_and_b32 v196, v204, v28
    v_and_b32 v197, v205, v29
    v_and_b32 v198, v206, v30
    v_and_b32 v199, v207, v31
    v_xor_b32 v200, v200, v192
    v_xor_b32 v201, v201, v193
    v_xor_b32 v202, v202, v194
    v_xor_b32 v203, v203, v195
    v_xor_b32 v204, v204, v196
    v_xor_b32 v205, v205, v197
    v_xor_b32 v206, v206, v198
    v_xor_b32 v207, v207, v199
    v_mfma_f32_32x32x16_bf16 v[160:175], v[76:79], v[20:23], v[112:127]
    v_exp_f32 v144, v144
    s_mov_b64 exec, s[96:97]
    ds_read_b128 v[128:131], v109 offset:1024
    ds_read_b128 v[132:135], v109 offset:1536
    s_mov_b64 exec, -1
    v_exp_f32 v145, v145
    v_exp_f32 v146, v146
    v_exp_f32 v147, v147
    s_waitcnt lgkmcnt(4)
    v_mfma_f32_32x32x16_bf16 v[32:47], v[48:51], v[192:195], 0
    v_exp_f32 v148, v148
    v_exp_f32 v149, v149
    v_exp_f32 v150, v150
    v_exp_f32 v151, v151
    v_mfma_f32_32x32x16_bf16 v[32:47], v[52:55], v[196:199], v[32:47]
    v_exp_f32 v152, v152
    v_exp_f32 v153, v153
    v_exp_f32 v154, v154
    v_exp_f32 v155, v155
    s_waitcnt lgkmcnt(2)
    v_mfma_f32_32x32x16_bf16 v[32:47], v[56:59], v[200:203], v[32:47]
    v_exp_f32 v156, v156
    v_exp_f32 v157, v157
    v_exp_f32 v158, v158
    v_exp_f32 v159, v159
    v_mfma_f32_32x32x16_bf16 v[32:47], v[60:63], v[204:207], v[32:47]
    v_cvt_pk_bf16_f32 v184, v144, v145
    v_cvt_pk_bf16_f32 v185, v146, v147
    v_cvt_pk_bf16_f32 v186, v148, v149
    v_cvt_pk_bf16_f32 v187, v150, v151
    v_cvt_pk_bf16_f32 v188, v152, v153
    v_cvt_pk_bf16_f32 v189, v154, v155
    v_cvt_pk_bf16_f32 v190, v156, v157
    v_cvt_pk_bf16_f32 v191, v158, v159
    v_mfma_f32_32x32x16_bf16 v[144:159], v[80:83], v[20:23], v[112:127]
    v_exp_f32 v160, v160
    s_mov_b64 exec, s[96:97]
    ds_read_b128 v[48:51], v109 offset:2048
    ds_read_b128 v[52:55], v109 offset:2560
    s_mov_b64 exec, -1
    v_exp_f32 v161, v161
    v_exp_f32 v162, v162
    v_exp_f32 v163, v163
    v_exp_f32 v164, v164
    v_exp_f32 v165, v165
    s_waitcnt lgkmcnt(2)
    v_mfma_f32_32x32x16_bf16 v[32:47], v[128:131], v[184:187], v[32:47]
    v_exp_f32 v166, v166
    v_exp_f32 v167, v167
    v_exp_f32 v168, v168
    v_exp_f32 v169, v169
    v_exp_f32 v170, v170
    v_exp_f32 v171, v171
    v_mfma_f32_32x32x16_bf16 v[32:47], v[132:135], v[188:191], v[32:47]
    v_exp_f32 v172, v172
    v_exp_f32 v173, v173
    v_exp_f32 v174, v174
    v_exp_f32 v175, v175
    v_cvt_pk_bf16_f32 v176, v160, v161
    v_cvt_pk_bf16_f32 v177, v162, v163
    v_cvt_pk_bf16_f32 v178, v164, v165
    v_cvt_pk_bf16_f32 v179, v166, v167
    v_cvt_pk_bf16_f32 v180, v168, v169
    v_cvt_pk_bf16_f32 v181, v170, v171
    v_cvt_pk_bf16_f32 v182, v172, v173
    v_cvt_pk_bf16_f32 v183, v174, v175
    v_mfma_f32_32x32x16_bf16 v[160:175], v[84:87], v[20:23], v[112:127]
    v_exp_f32 v144, v144
    s_mov_b64 exec, s[96:97]
    ds_read_b128 v[56:59], v109 offset:3072
    ds_read_b128 v[60:63], v109 offset:3584
    s_mov_b64 exec, -1
    v_exp_f32 v145, v145
    v_exp_f32 v146, v146
    v_exp_f32 v147, v147
    v_exp_f32 v148, v148
    v_exp_f32 v149, v149
    s_waitcnt lgkmcnt(2)
    v_mfma_f32_32x32x16_bf16 v[32:47], v[48:51], v[176:179], v[32:47]
    v_exp_f32 v150, v150
    v_exp_f32 v151, v151
    v_exp_f32 v152, v152
    v_exp_f32 v153, v153
    v_exp_f32 v154, v154
    v_exp_f32 v155, v155
    v_mfma_f32_32x32x16_bf16 v[32:47], v[52:55], v[180:183], v[32:47]
    v_exp_f32 v156, v156
    v_exp_f32 v157, v157
    v_exp_f32 v158, v158
    v_exp_f32 v159, v159
    v_cvt_pk_bf16_f32 v184, v144, v145
    v_cvt_pk_bf16_f32 v185, v146, v147
    v_cvt_pk_bf16_f32 v186, v148, v149
    v_cvt_pk_bf16_f32 v187, v150, v151
    v_cvt_pk_bf16_f32 v188, v152, v153
    v_cvt_pk_bf16_f32 v189, v154, v155
    v_cvt_pk_bf16_f32 v190, v156, v157
    v_cvt_pk_bf16_f32 v191, v158, v159
    v_mfma_f32_32x32x16_bf16 v[144:159], v[88:91], v[20:23], v[112:127]
    v_exp_f32 v160, v160
    s_mov_b64 exec, s[96:97]
    ds_read_b128 v[128:131], v109 offset:4096
    ds_read_b128 v[132:135], v109 offset:4608
    s_mov_b64 exec, -1
    v_exp_f32 v161, v161
    v_exp_f32 v162, v162
    v_exp_f32 v163, v163
    v_exp_f32 v164, v164
    v_exp_f32 v165, v165
    s_waitcnt lgkmcnt(2)
    v_mfma_f32_32x32x16_bf16 v[32:47], v[56:59], v[184:187], v[32:47]
    v_exp_f32 v166, v166
    v_exp_f32 v167, v167
    v_exp_f32 v168, v168
    v_exp_f32 v169, v169
    v_exp_f32 v170, v170
    v_exp_f32 v171, v171
    v_mfma_f32_32x32x16_bf16 v[32:47], v[60:63], v[188:191], v[32:47]
    v_exp_f32 v172, v172
    v_exp_f32 v173, v173
    v_exp_f32 v174, v174
    v_exp_f32 v175, v175
    v_cvt_pk_bf16_f32 v176, v160, v161
    v_cvt_pk_bf16_f32 v177, v162, v163
    v_cvt_pk_bf16_f32 v178, v164, v165
    v_cvt_pk_bf16_f32 v179, v166, v167
    v_cvt_pk_bf16_f32 v180, v168, v169
    v_cvt_pk_bf16_f32 v181, v170, v171
    v_cvt_pk_bf16_f32 v182, v172, v173
    v_cvt_pk_bf16_f32 v183, v174, v175
    v_mfma_f32_32x32x16_bf16 v[160:175], v[92:95], v[20:23], v[112:127]
    v_exp_f32 v144, v144
    s_mov_b64 exec, s[96:97]
    ds_read_b128 v[48:51], v109 offset:5120
    ds_read_b128 v[52:55], v109 offset:5632
    s_mov_b64 exec, -1
    v_exp_f32 v145, v145
    v_exp_f32 v146, v146
    v_exp_f32 v147, v147
    v_exp_f32 v148, v148
    v_exp_f32 v149, v149
    s_waitcnt lgkmcnt(2)
    v_mfma_f32_32x32x16_bf16 v[32:47], v[128:131], v[176:179], v[32:47]
    v_exp_f32 v150, v150
    v_exp_f32 v151, v151
    v_exp_f32 v152, v152
    v_exp_f32 v153, v153
    v_exp_f32 v154, v154
    v_exp_f32 v155, v155
    v_mfma_f32_32x32x16_bf16 v[32:47], v[132:135], v[180:183], v[32:47]
    v_exp_f32 v156, v156
    v_exp_f32 v157, v157
    v_exp_f32 v158, v158
    v_exp_f32 v159, v159
    v_cvt_pk_bf16_f32 v184, v144, v145
    v_cvt_pk_bf16_f32 v185, v146, v147
    v_cvt_pk_bf16_f32 v186, v148, v149
    v_cvt_pk_bf16_f32 v187, v150, v151
    v_cvt_pk_bf16_f32 v188, v152, v153
    v_cvt_pk_bf16_f32 v189, v154, v155
    v_cvt_pk_bf16_f32 v190, v156, v157
    v_cvt_pk_bf16_f32 v191, v158, v159
    v_mfma_f32_32x32x16_bf16 v[144:159], v[96:99], v[20:23], v[112:127]
    v_exp_f32 v160, v160
    s_mov_b64 exec, s[96:97]
    ds_read_b128 v[56:59], v109 offset:6144
    ds_read_b128 v[60:63], v109 offset:6656
    s_mov_b64 exec, -1
    v_exp_f32 v161, v161
    v_exp_f32 v162, v162
    v_exp_f32 v163, v163
    v_exp_f32 v164, v164
    v_exp_f32 v165, v165
    s_waitcnt lgkmcnt(2)
    v_mfma_f32_32x32x16_bf16 v[32:47], v[48:51], v[184:187], v[32:47]
    v_exp_f32 v166, v166
    v_exp_f32 v167, v167
    v_exp_f32 v168, v168
    v_exp_f32 v169, v169
    v_exp_f32 v170, v170
    v_exp_f32 v171, v171
    v_mfma_f32_32x32x16_bf16 v[32:47], v[52:55], v[188:191], v[32:47]
    v_exp_f32 v172, v172
    v_exp_f32 v173, v173
    v_exp_f32 v174, v174
    v_exp_f32 v175, v175
    v_cvt_pk_bf16_f32 v176, v160, v161
    v_cvt_pk_bf16_f32 v177, v162, v163
    v_cvt_pk_bf16_f32 v178, v164, v165
    v_cvt_pk_bf16_f32 v179, v166, v167
    v_cvt_pk_bf16_f32 v180, v168, v169
    v_cvt_pk_bf16_f32 v181, v170, v171
    v_cvt_pk_bf16_f32 v182, v172, v173
    v_cvt_pk_bf16_f32 v183, v174, v175
    s_barrier
    s_cmp_lg_u32 s49, 3
    s_cbranch_scc0 L_nox1_100011
    s_lshl_b32 s58, s52, 2
    s_add_u32 s58, s58, s45
    s_lshl_b32 s61, s58, 15
    s_add_u32 s61, s61, 25165824
    s_andn2_b32 s59, s61, 0x1fff
    s_add_u32 s61, s61, s59
    s_andn2_b32 s59, s61, 0x1fffff
    s_add_u32 s61, s61, s59
    s_add_u32 s61, s61, s25
    buffer_load_dwordx4 v[208:211], v2, s[28:31], s61 offen offset:0 sc1
    buffer_load_dwordx4 v[212:215], v2, s[28:31], s61 offen offset:1024 sc1
    buffer_load_dwordx4 v[216:219], v2, s[28:31], s61 offen offset:2048 sc1
    buffer_load_dwordx4 v[220:223], v2, s[28:31], s61 offen offset:3072 sc1
    s_add_u32 s61, s61, 4096
L_nox1_100011:
    v_exp_f32 v144, v144
    s_mov_b64 exec, s[96:97]
    ds_read_b128 v[128:131], v109 offset:7168
    ds_read_b128 v[132:135], v109 offset:7680
    s_mov_b64 exec, -1
    v_exp_f32 v145, v145
    v_exp_f32 v146, v146
    v_exp_f32 v147, v147
    v_exp_f32 v148, v148
    v_exp_f32 v149, v149
    s_waitcnt lgkmcnt(2)
    v_mfma_f32_32x32x16_bf16 v[32:47], v[56:59], v[176:179], v[32:47]
    v_exp_f32 v150, v150
    s_branch L_pgo3
L_pg3:
    s_setpc_b64 s[58:59]
L_pgo3:
    v_exp_f32 v151, v151
    v_exp_f32 v152, v152
    v_exp_f32 v153, v153
    v_exp_f32 v154, v154
    v_exp_f32 v155, v155
    v_mfma_f32_32x32x16_bf16 v[32:47], v[60:63], v[180:183], v[32:47]
    v_exp_f32 v156, v156
    v_exp_f32 v157, v157
    v_exp_f32 v158, v158
    v_exp_f32 v159, v159
    v_cvt_pk_bf16_f32 v184, v144, v145
    v_cvt_pk_bf16_f32 v185, v146, v147
    v_cvt_pk_bf16_f32 v186, v148, v149
    v_cvt_pk_bf16_f32 v187, v150, v151
    v_cvt_pk_bf16_f32 v188, v152, v153
    v_cvt_pk_bf16_f32 v189, v154, v155
    v_cvt_pk_bf16_f32 v190, v156, v157
    v_cvt_pk_bf16_f32 v191, v158, v159
    s_waitcnt lgkmcnt(0)
    v_mfma_f32_32x32x16_bf16 v[32:47], v[128:131], v[184:187], v[32:47]
    s_lshl_b32 s56, s51, 3
    s_add_u32 s56, s56, s44
    s_lshl_b32 s56, s56, 5
    s_add_u32 s56, s56, s50
    v_mfma_f32_32x32x16_bf16 v[32:47], v[132:135], v[188:191], v[32:47]
    s_lshl_b32 s56, s56, 10
    s_add_u32 s56, s56, 27262976
    s_andn2_b32 s59, s56, 0x1fff
    s_add_u32 s56, s56, s59
    s_andn2_b32 s59, s56, 0x1fffff
    s_add_u32 s56, s56, s59
    s_add_u32 s56, s56, s25
    s_nop 4
    v_mov_b32 v41, 0x67800000
L_attj_100009:
    v_cmp_nle_f32 vcc, v40, v41
    s_cbranch_vccnz L_redo_101021
L_attr_100010:
    v_rcp_f32 v40, v40
    s_nop 0
    v_mul_f32 v32, v32, v40
    v_mul_f32 v33, v33, v40
    v_mul_f32 v34, v34, v40
    v_mul_f32 v35, v35, v40
    v_mul_f32 v36, v36, v40
    v_mul_f32 v37, v37, v40
    v_mul_f32 v38, v38, v40
    v_mul_f32 v39, v39, v40
    v_cvt_pk_bf16_f32 v24, v32, v33
    v_cvt_pk_bf16_f32 v25, v34, v35
    v_cvt_pk_bf16_f32 v26, v36, v37
    v_cvt_pk_bf16_f32 v27, v38, v39
    buffer_store_dwordx4 v[24:27], v2, s[28:31], s56 offen sc1
    s_cmp_lg_u32 s49, 3
    s_cbranch_scc0 L_g3idle_101022
    buffer_load_dwordx4 v[224:227], v2, s[28:31], s61 offen offset:0 sc1
    buffer_load_dwordx4 v[228:231], v2, s[28:31], s61 offen offset:1024 sc1
    buffer_load_dwordx4 v[232:235], v2, s[28:31], s61 offen offset:2048 sc1
    buffer_load_dwordx4 v[236:239], v2, s[28:31], s61 offen offset:3072 sc1
    s_add_u32 s61, s61, 12288
    v_lshrrev_b32 v22, 5, v1
    v_bfe_u32 v23, v1, 2, 2
    v_lshl_add_u32 v23, v22, 2, v23
    v_lshlrev_b32 v20, 7, v23
    v_bfe_u32 v23, v1, 3, 1
    v_xor_b32 v23, 0, v23
    v_lshl_add_u32 v20, v23, 6, v20
    v_bfe_u32 v23, v1, 4, 1
    v_lshl_add_u32 v20, v23, 5, v20
    v_and_b32 v23, 3, v1
    v_lshl_add_u32 v20, v23, 3, v20
    v_xor_b32 v21, 64, v20
    v_lshrrev_b32 v23, 5, v1
    v_lshlrev_b32 v22, 3, v1
    v_lshlrev_b32 v23, 4, v23
    v_add_u32 v23, 133120, v23
    s_lshl_b32 s56, s58, 12
    s_add_u32 s56, s56, 29360128
    s_andn2_b32 s59, s56, 0x1fff
    s_add_u32 s56, s56, s59
    s_andn2_b32 s59, s56, 0x1fffff
    s_add_u32 s56, s56, s59
    s_add_u32 s56, s56, s25
    s_barrier
    ds_read_b64_tr_b16 v[40:41], v20 offset:0
    ds_read_b64_tr_b16 v[42:43], v20 offset:1024
    ds_read_b64_tr_b16 v[44:45], v21 offset:0
    ds_read_b64_tr_b16 v[46:47], v21 offset:1024
    ds_read_b64_tr_b16 v[48:49], v20 offset:2048
    ds_read_b64_tr_b16 v[50:51], v20 offset:3072
    ds_read_b64_tr_b16 v[52:53], v21 offset:2048
    ds_read_b64_tr_b16 v[54:55], v21 offset:3072
    buffer_load_dwordx4 v[240:243], v2, s[28:31], s61 offen offset:0 sc1
    buffer_load_dwordx4 v[244:247], v2, s[28:31], s61 offen offset:1024 sc1
    buffer_load_dwordx4 v[248:251], v2, s[28:31], s61 offen offset:2048 sc1
    buffer_load_dwordx4 v[252:255], v2, s[28:31], s61 offen offset:3072 sc1
    s_add_u32 s61, s61, 4096
    s_waitcnt vmcnt(12) lgkmcnt(4)
    v_mfma_f32_32x32x16_bf16 v[96:111], v[40:43], v[208:211], 0
    ds_read_b64_tr_b16 v[56:57], v20 offset:4096
    ds_read_b64_tr_b16 v[58:59], v20 offset:5120
    ds_read_b64_tr_b16 v[60:61], v21 offset:4096
    ds_read_b64_tr_b16 v[62:63], v21 offset:5120
    v_mfma_f32_32x32x16_bf16 v[112:127], v[44:47], v[208:211], 0
    buffer_load_dwordx4 v[128:131], v2, s[28:31], s61 offen offset:0 sc1
    buffer_load_dwordx2 v[64:65], v22, s[28:31], s56 offen offset:0 sc1
    s_waitcnt vmcnt(13) lgkmcnt(4)
    v_mfma_f32_32x32x16_bf16 v[96:111], v[48:51], v[212:215], v[96:111]
    ds_read_b64_tr_b16 v[40:41], v20 offset:6144
    ds_read_b64_tr_b16 v[42:43], v20 offset:7168
    ds_read_b64_tr_b16 v[44:45], v21 offset:6144
    ds_read_b64_tr_b16 v[46:47], v21 offset:7168
    v_mfma_f32_32x32x16_bf16 v[112:127], v[52:55], v[212:215], v[112:127]
    buffer_load_dwordx4 v[132:135], v2, s[28:31], s61 offen offset:1024 sc1
    buffer_load_dwordx2 v[66:67], v22, s[28:31], s56 offen offset:512 sc1
    s_lshl_b32 s64, s58, 17
    s_waitcnt vmcnt(14) lgkmcnt(4)
    v_mfma_f32_32x32x16_bf16 v[96:111], v[56:59], v[216:219], v[96:111]
    ds_read_b64_tr_b16 v[48:49], v20 offset:8192
    ds_read_b64_tr_b16 v[50:51], v20 offset:9216
    ds_read_b64_tr_b16 v[52:53], v21 offset:8192
    ds_read_b64_tr_b16 v[54:55], v21 offset:9216
    v_mfma_f32_32x32x16_bf16 v[112:127], v[60:63], v[216:219], v[112:127]
    buffer_load_dwordx4 v[136:139], v2, s[28:31], s61 offen offset:2048 sc1
    buffer_load_dwordx2 v[68:69], v22, s[28:31], s56 offen offset:1024 sc1
    s_lshl_b32 s57, s53, 13
    s_add_u32 s64, s64, s57
    s_add_u32 s64, s64, 41943040
    s_andn2_b32 s59, s64, 0x1fff
    s_add_u32 s64, s64, s59
    s_andn2_b32 s59, s64, 0x1fffff
    s_add_u32 s64, s64, s59
    s_add_u32 s64, s64, s25
    s_waitcnt vmcnt(15) lgkmcnt(4)
    v_mfma_f32_32x32x16_bf16 v[96:111], v[40:43], v[220:223], v[96:111]
    ds_read_b64_tr_b16 v[56:57], v20 offset:10240
    ds_read_b64_tr_b16 v[58:59], v20 offset:11264
    ds_read_b64_tr_b16 v[60:61], v21 offset:10240
    ds_read_b64_tr_b16 v[62:63], v21 offset:11264
    v_mfma_f32_32x32x16_bf16 v[112:127], v[44:47], v[220:223], v[112:127]
    buffer_load_dwordx4 v[140:143], v2, s[28:31], s61 offen offset:3072 sc1
    s_add_u32 s61, s61, 12288
    buffer_load_dwordx2 v[70:71], v22, s[28:31], s56 offen offset:1536 sc1
    s_lshr_b32 s59, s48, 1
    s_and_b32 s59, s59, 3
    s_lshl_b32 s68, s59, 16
    s_waitcnt vmcnt(15) lgkmcnt(4)
    v_mfma_f32_32x32x16_bf16 v[96:111], v[48:51], v[224:227], v[96:111]
    ds_read_b64_tr_b16 v[40:41], v20 offset:12288
    ds_read_b64_tr_b16 v[42:43], v20 offset:13312
    ds_read_b64_tr_b16 v[44:45], v21 offset:12288
    ds_read_b64_tr_b16 v[46:47], v21 offset:13312
    v_mfma_f32_32x32x16_bf16 v[112:127], v[52:55], v[224:227], v[112:127]
    buffer_load_dwordx4 v[144:147], v2, s[28:31], s61 offen offset:0 sc1
    buffer_load_dwordx2 v[72:73], v22, s[28:31], s56 offen offset:2048 sc1
    s_add_u32 s69, s68, 32768
    s_cmp_eq_u32 s69, 229376
    s_cselect_b32 s69, 0, s69
    s_waitcnt vmcnt(16) lgkmcnt(4)
    v_mfma_f32_32x32x16_bf16 v[96:111], v[56:59], v[228:231], v[96:111]
    ds_read_b64_tr_b16 v[48:49], v20 offset:14336
    ds_read_b64_tr_b16 v[50:51], v20 offset:15360
    ds_read_b64_tr_b16 v[52:53], v21 offset:14336
    ds_read_b64_tr_b16 v[54:55], v21 offset:15360
    v_mfma_f32_32x32x16_bf16 v[112:127], v[60:63], v[228:231], v[112:127]
    buffer_load_dwordx4 v[148:151], v2, s[28:31], s61 offen offset:1024 sc1
    buffer_load_dwordx2 v[74:75], v22, s[28:31], s56 offen offset:2560 sc1
    s_add_u32 s70, s69, 32768
    s_cmp_eq_u32 s70, 229376
    s_cselect_b32 s70, 0, s70
    s_waitcnt vmcnt(17) lgkmcnt(4)
    v_mfma_f32_32x32x16_bf16 v[96:111], v[40:43], v[232:235], v[96:111]
    ds_read_b64_tr_b16 v[56:57], v20 offset:16384
    ds_read_b64_tr_b16 v[58:59], v20 offset:17408
    ds_read_b64_tr_b16 v[60:61], v21 offset:16384
    ds_read_b64_tr_b16 v[62:63], v21 offset:17408
    v_mfma_f32_32x32x16_bf16 v[112:127], v[44:47], v[232:235], v[112:127]
    buffer_load_dwordx4 v[152:155], v2, s[28:31], s61 offen offset:2048 sc1
    buffer_load_dwordx2 v[76:77], v22, s[28:31], s56 offen offset:3072 sc1
    s_add_u32 s71, s70, 32768
    s_cmp_eq_u32 s71, 229376
    s_cselect_b32 s71, 0, s71
    s_waitcnt vmcnt(18) lgkmcnt(4)
    v_mfma_f32_32x32x16_bf16 v[96:111], v[48:51], v[236:239], v[96:111]
    ds_read_b64_tr_b16 v[40:41], v20 offset:18432
    ds_read_b64_tr_b16 v[42:43], v20 offset:19456
    ds_read_b64_tr_b16 v[44:45], v21 offset:18432
    ds_read_b64_tr_b16 v[46:47], v21 offset:19456
    v_mfma_f32_32x32x16_bf16 v[112:127], v[52:55], v[236:239], v[112:127]
    buffer_load_dwordx4 v[156:159], v2, s[28:31], s61 offen offset:3072 sc1
    s_add_u32 s61, s61, 4096
    buffer_load_dwordx2 v[78:79], v22, s[28:31], s56 offen offset:3584 sc1
    s_add_u32 s72, s71, 32768
    s_cmp_eq_u32 s72, 229376
    s_cselect_b32 s72, 0, s72
    s_waitcnt vmcnt(19) lgkmcnt(4)
    v_mfma_f32_32x32x16_bf16 v[96:111], v[56:59], v[240:243], v[96:111]
    ds_read_b64_tr_b16 v[48:49], v20 offset:20480
    ds_read_b64_tr_b16 v[50:51], v20 offset:21504
    ds_read_b64_tr_b16 v[52:53], v21 offset:20480
    ds_read_b64_tr_b16 v[54:55], v21 offset:21504
    v_mfma_f32_32x32x16_bf16 v[112:127], v[60:63], v[240:243], v[112:127]
    buffer_load_dwordx4 v[160:163], v2, s[28:31], s61 offen offset:0 sc1
    s_add_u32 s73, s72, 32768
    s_cmp_eq_u32 s73, 229376
    s_cselect_b32 s73, 0, s73
    s_waitcnt vmcnt(19) lgkmcnt(4)
    v_mfma_f32_32x32x16_bf16 v[96:111], v[40:43], v[244:247], v[96:111]
    ds_read_b64_tr_b16 v[56:57], v20 offset:22528
    ds_read_b64_tr_b16 v[58:59], v20 offset:23552
    ds_read_b64_tr_b16 v[60:61], v21 offset:22528
    ds_read_b64_tr_b16 v[62:63], v21 offset:23552
    v_mfma_f32_32x32x16_bf16 v[112:127], v[44:47], v[244:247], v[112:127]
    buffer_load_dwordx4 v[164:167], v2, s[28:31], s61 offen offset:1024 sc1
    s_add_u32 s74, s73, 32768
    s_cmp_eq_u32 s74, 229376
    s_cselect_b32 s74, 0, s74
    s_waitcnt vmcnt(19) lgkmcnt(4)
    v_mfma_f32_32x32x16_bf16 v[96:111], v[48:51], v[248:251], v[96:111]
    ds_read_b64_tr_b16 v[40:41], v20 offset:24576
    ds_read_b64_tr_b16 v[42:43], v20 offset:25600
    ds_read_b64_tr_b16 v[44:45], v21 offset:24576
    ds_read_b64_tr_b16 v[46:47], v21 offset:25600
    v_mfma_f32_32x32x16_bf16 v[112:127], v[52:55], v[248:251], v[112:127]
    buffer_load_dwordx4 v[168:171], v2, s[28:31], s61 offen offset:2048 sc1
    s_xor_b32 s59, s48, 0
    s_lshl_b32 s59, s59, 1
    s_add_u32 s59, s59, s46
    s_lshl_b32 s75, s59, 17
    s_waitcnt vmcnt(19) lgkmcnt(4)
    v_mfma_f32_32x32x16_bf16 v[96:111], v[56:59], v[252:255], v[96:111]
    ds_read_b64_tr_b16 v[48:49], v20 offset:26624
    ds_read_b64_tr_b16 v[50:51], v20 offset:27648
    ds_read_b64_tr_b16 v[52:53], v21 offset:26624
    ds_read_b64_tr_b16 v[54:55], v21 offset:27648
    v_mfma_f32_32x32x16_bf16 v[112:127], v[60:63], v[252:255], v[112:127]
    buffer_load_dwordx4 v[172:175], v2, s[28:31], s61 offen offset:3072 sc1
    s_add_u32 s61, s61, 12288
    s_and_b32 s57, s48, 1
    s_lshl_b32 s57, s57, 3
    s_add_u32 s57, s57, s47
    s_lshl_b32 s57, s57, 10
    s_add_u32 s75, s75, s57
    s_add_u32 s75, s75, 41943040
    s_waitcnt vmcnt(19) lgkmcnt(4)
    v_mfma_f32_32x32x16_bf16 v[96:111], v[40:43], v[128:131], v[96:111]
    ds_read_b64_tr_b16 v[56:57], v20 offset:28672
    ds_read_b64_tr_b16 v[58:59], v20 offset:29696
    ds_read_b64_tr_b16 v[60:61], v21 offset:28672
    ds_read_b64_tr_b16 v[62:63], v21 offset:29696
    v_mfma_f32_32x32x16_bf16 v[112:127], v[44:47], v[128:131], v[112:127]
    buffer_load_dwordx4 v[176:179], v2, s[28:31], s61 offen offset:0 sc1
    s_andn2_b32 s59, s75, 0x1fff
    s_add_u32 s75, s75, s59
    s_andn2_b32 s59, s75, 0x1fffff
    s_add_u32 s75, s75, s59
    s_add_u32 s75, s75, s25
    s_add_u32 s76, s75, 4096
    s_xor_b32 s59, s75, 16384
    s_add_u32 s77, s59, 6144
    s_barrier
    s_waitcnt vmcnt(18) lgkmcnt(4)
    v_mfma_f32_32x32x16_bf16 v[96:111], v[48:51], v[132:135], v[96:111]
    ds_read_b64_tr_b16 v[40:41], v20 offset:30720
    ds_read_b64_tr_b16 v[42:43], v20 offset:31744
    ds_read_b64_tr_b16 v[44:45], v21 offset:30720
    ds_read_b64_tr_b16 v[46:47], v21 offset:31744
    v_mfma_f32_32x32x16_bf16 v[112:127], v[52:55], v[132:135], v[112:127]
    buffer_load_dwordx4 v[180:183], v2, s[28:31], s61 offen offset:1024 sc1
    s_xor_b32 s59, s48, 0
    s_lshl_b32 s59, s59, 1
    s_add_u32 s59, s59, s46
    s_lshl_b32 s59, s59, 1
    s_and_b32 s57, s48, 1
    s_add_u32 s59, s59, s57
    s_lshl_b32 s78, s59, 1
    s_waitcnt vmcnt(17) lgkmcnt(4)
    v_mfma_f32_32x32x16_bf16 v[96:111], v[56:59], v[136:139], v[96:111]
    ds_read_b64_tr_b16 v[48:49], v20 offset:32768
    ds_read_b64_tr_b16 v[50:51], v20 offset:33792
    ds_read_b64_tr_b16 v[52:53], v21 offset:32768
    ds_read_b64_tr_b16 v[54:55], v21 offset:33792
    v_mfma_f32_32x32x16_bf16 v[112:127], v[60:63], v[136:139], v[112:127]
    buffer_load_dwordx4 v[184:187], v2, s[28:31], s61 offen offset:2048 sc1
    s_bfe_u32 s57, s48, 0x10001
    s_add_u32 s59, s78, s57
    s_lshl_b32 s59, s59, 3
    s_add_u32 s59, s59, s47
    s_lshl_b32 s59, s59, 10
    s_add_u32 s78, s59, 27262976
    s_waitcnt vmcnt(16) lgkmcnt(4)
    v_mfma_f32_32x32x16_bf16 v[96:111], v[40:43], v[140:143], v[96:111]
    ds_read_b64_tr_b16 v[56:57], v20 offset:34816
    ds_read_b64_tr_b16 v[58:59], v20 offset:35840
    ds_read_b64_tr_b16 v[60:61], v21 offset:34816
    ds_read_b64_tr_b16 v[62:63], v21 offset:35840
    v_mfma_f32_32x32x16_bf16 v[112:127], v[44:47], v[140:143], v[112:127]
    buffer_load_dwordx4 v[188:191], v2, s[28:31], s61 offen offset:3072 sc1
    s_add_u32 s61, s61, 4096
    s_andn2_b32 s59, s78, 0x1fff
    s_add_u32 s78, s78, s59
    s_andn2_b32 s59, s78, 0x1fffff
    s_add_u32 s78, s78, s59
    s_add_u32 s78, s78, s25
    s_xor_b32 s79, s78, 16384
    s_waitcnt vmcnt(15) lgkmcnt(4)
    v_mfma_f32_32x32x16_bf16 v[96:111], v[48:51], v[144:147], v[96:111]
    ds_read_b64_tr_b16 v[40:41], v20 offset:36864
    ds_read_b64_tr_b16 v[42:43], v20 offset:37888
    ds_read_b64_tr_b16 v[44:45], v21 offset:36864
    ds_read_b64_tr_b16 v[46:47], v21 offset:37888
    v_mfma_f32_32x32x16_bf16 v[112:127], v[52:55], v[144:147], v[112:127]
    buffer_load_dwordx4 v[192:195], v2, s[28:31], s61 offen offset:0 sc1
    s_xor_b32 s59, s48, 0
    s_lshl_b32 s59, s59, 1
    s_add_u32 s59, s59, s46
    s_and_b32 s80, s59, 3
    s_waitcnt vmcnt(14) lgkmcnt(4)
    v_mfma_f32_32x32x16_bf16 v[96:111], v[56:59], v[148:151], v[96:111]
    ds_read_b64_tr_b16 v[48:49], v20 offset:38912
    ds_read_b64_tr_b16 v[50:51], v20 offset:39936
    ds_read_b64_tr_b16 v[52:53], v21 offset:38912
    ds_read_b64_tr_b16 v[54:55], v21 offset:39936
    v_mfma_f32_32x32x16_bf16 v[112:127], v[60:63], v[148:151], v[112:127]
    buffer_load_dwordx4 v[196:199], v2, s[28:31], s61 offen offset:1024 sc1
    s_lshr_b32 s59, s48, 1
    s_lshl_b32 s59, s59, 3
    s_add_u32 s59, s59, s49
    s_lshl_b32 s59, s59, 2
    s_add_u32 s59, s59, s80
    s_lshl_b32 s59, s59, 7
    s_add_u32 s80, s59, 13238272
    s_waitcnt vmcnt(13) lgkmcnt(4)
    v_mfma_f32_32x32x16_bf16 v[96:111], v[40:43], v[152:155], v[96:111]
    ds_read_b64_tr_b16 v[56:57], v20 offset:40960
    ds_read_b64_tr_b16 v[58:59], v20 offset:41984
    ds_read_b64_tr_b16 v[60:61], v21 offset:40960
    ds_read_b64_tr_b16 v[62:63], v21 offset:41984
    v_mfma_f32_32x32x16_bf16 v[112:127], v[44:47], v[152:155], v[112:127]
    buffer_load_dwordx4 v[200:203], v2, s[28:31], s61 offen offset:2048 sc1
    s_waitcnt vmcnt(12) lgkmcnt(4)
    v_mfma_f32_32x32x16_bf16 v[96:111], v[48:51], v[156:159], v[96:111]
    ds_read_b64_tr_b16 v[40:41], v20 offset:43008
    ds_read_b64_tr_b16 v[42:43], v20 offset:44032
    ds_read_b64_tr_b16 v[44:45], v21 offset:43008
    ds_read_b64_tr_b16 v[46:47], v21 offset:44032
    v_mfma_f32_32x32x16_bf16 v[112:127], v[52:55], v[156:159], v[112:127]
    buffer_load_dwordx4 v[204:207], v2, s[28:31], s61 offen offset:3072 sc1
    s_add_u32 s61, s61, 12288
    s_waitcnt vmcnt(11) lgkmcnt(4)
    v_mfma_f32_32x32x16_bf16 v[96:111], v[56:59], v[160:163], v[96:111]
    ds_read_b64_tr_b16 v[48:49], v20 offset:45056
    ds_read_b64_tr_b16 v[50:51], v20 offset:46080
    ds_read_b64_tr_b16 v[52:53], v21 offset:45056
    ds_read_b64_tr_b16 v[54:55], v21 offset:46080
    v_mfma_f32_32x32x16_bf16 v[112:127], v[60:63], v[160:163], v[112:127]
    v_lshlrev_b32 v19, 7, v1
    buffer_load_dword v16, v19, s[36:39], s15 offen
    v_add_f32 v64, v64, v66
    v_add_f32 v65, v65, v67
    v_add_f32 v64, v64, v68
    v_add_f32 v65, v65, v69
    v_add_f32 v64, v64, v70
    s_waitcnt vmcnt(11) lgkmcnt(4)
    v_mfma_f32_32x32x16_bf16 v[96:111], v[40:43], v[164:167], v[96:111]
    ds_read_b64_tr_b16 v[56:57], v20 offset:47104
    ds_read_b64_tr_b16 v[58:59], v20 offset:48128
    ds_read_b64_tr_b16 v[60:61], v21 offset:47104
    ds_read_b64_tr_b16 v[62:63], v21 offset:48128
    v_mfma_f32_32x32x16_bf16 v[112:127], v[44:47], v[164:167], v[112:127]
    v_add_f32 v65, v65, v71
    v_add_f32 v64, v64, v72
    v_add_f32 v65, v65, v73
    v_add_f32 v64, v64, v74
    v_add_f32 v65, v65, v75
    s_waitcnt vmcnt(10) lgkmcnt(4)
    v_mfma_f32_32x32x16_bf16 v[96:111], v[48:51], v[168:171], v[96:111]
    ds_read_b64_tr_b16 v[40:41], v20 offset:49152
    ds_read_b64_tr_b16 v[42:43], v20 offset:50176
    ds_read_b64_tr_b16 v[44:45], v21 offset:49152
    ds_read_b64_tr_b16 v[46:47], v21 offset:50176
    v_mfma_f32_32x32x16_bf16 v[112:127], v[52:55], v[168:171], v[112:127]
    v_add_f32 v64, v64, v76
    v_add_f32 v65, v65, v77
    v_add_f32 v64, v64, v78
    v_add_f32 v65, v65, v79
    v_mov_b32 v66, v64
    s_waitcnt vmcnt(9) lgkmcnt(4)
    v_mfma_f32_32x32x16_bf16 v[96:111], v[56:59], v[172:175], v[96:111]
    ds_read_b64_tr_b16 v[48:49], v20 offset:51200
    ds_read_b64_tr_b16 v[50:51], v20 offset:52224
    ds_read_b64_tr_b16 v[52:53], v21 offset:51200
    ds_read_b64_tr_b16 v[54:55], v21 offset:52224
    v_mfma_f32_32x32x16_bf16 v[112:127], v[60:63], v[172:175], v[112:127]
    v_mov_b32 v67, v65
    s_nop 1
    v_permlane32_swap_b32 v64, v66
    v_permlane32_swap_b32 v65, v67
    s_nop 0
    s_waitcnt vmcnt(8) lgkmcnt(4)
    v_mfma_f32_32x32x16_bf16 v[96:111], v[40:43], v[176:179], v[96:111]
    ds_read_b64_tr_b16 v[56:57], v20 offset:53248
    ds_read_b64_tr_b16 v[58:59], v20 offset:54272
    ds_read_b64_tr_b16 v[60:61], v21 offset:53248
    ds_read_b64_tr_b16 v[62:63], v21 offset:54272
    v_mfma_f32_32x32x16_bf16 v[112:127], v[44:47], v[176:179], v[112:127]
    v_add_f32 v64, v64, v66
    v_add_f32 v65, v65, v67
    v_mul_f32 v36, 0xbb000000, v64
    v_mul_f32 v68, 0x3b000000, v65
    v_fma_f32 v68, -v36, v36, v68
    s_waitcnt vmcnt(7) lgkmcnt(4)
    v_mfma_f32_32x32x16_bf16 v[96:111], v[48:51], v[180:183], v[96:111]
    ds_read_b64_tr_b16 v[40:41], v20 offset:55296
    ds_read_b64_tr_b16 v[42:43], v20 offset:56320
    ds_read_b64_tr_b16 v[44:45], v21 offset:55296
    ds_read_b64_tr_b16 v[46:47], v21 offset:56320
    v_mfma_f32_32x32x16_bf16 v[112:127], v[52:55], v[180:183], v[112:127]
    s_barrier
    v_max_f32 v68, 0, v68
    v_add_f32 v68, 0x3727c5ac, v68
    v_rsq_f32 v38, v68
    v_sqrt_f32 v14, v68
    v_mul_f32 v39, 0xc0135761, v38
    s_waitcnt vmcnt(6) lgkmcnt(4)
    v_mfma_f32_32x32x16_bf16 v[96:111], v[56:59], v[184:187], v[96:111]
    ds_read_b64_tr_b16 v[48:49], v20 offset:57344
    ds_read_b64_tr_b16 v[50:51], v20 offset:58368
    ds_read_b64_tr_b16 v[52:53], v21 offset:57344
    ds_read_b64_tr_b16 v[54:55], v21 offset:58368
    v_mfma_f32_32x32x16_bf16 v[112:127], v[60:63], v[184:187], v[112:127]
    v_mul_f32 v68, v38, v38
    v_mul_f32 v68, 0x3d372713, v68
    v_mul_f32 v38, v68, v39
    s_waitcnt vmcnt(5) lgkmcnt(4)
    v_mfma_f32_32x32x16_bf16 v[96:111], v[40:43], v[188:191], v[96:111]
    ds_read_b64_tr_b16 v[56:57], v20 offset:59392
    ds_read_b64_tr_b16 v[58:59], v20 offset:60416
    ds_read_b64_tr_b16 v[60:61], v21 offset:59392
    ds_read_b64_tr_b16 v[62:63], v21 offset:60416
    v_mfma_f32_32x32x16_bf16 v[112:127], v[44:47], v[188:191], v[112:127]
    s_waitcnt vmcnt(4) lgkmcnt(4)
    v_mfma_f32_32x32x16_bf16 v[96:111], v[48:51], v[192:195], v[96:111]
    ds_read_b64_tr_b16 v[40:41], v20 offset:61440
    ds_read_b64_tr_b16 v[42:43], v20 offset:62464
    ds_read_b64_tr_b16 v[44:45], v21 offset:61440
    ds_read_b64_tr_b16 v[46:47], v21 offset:62464
    v_mfma_f32_32x32x16_bf16 v[112:127], v[52:55], v[192:195], v[112:127]
    s_waitcnt vmcnt(3) lgkmcnt(4)
    v_mfma_f32_32x32x16_bf16 v[96:111], v[56:59], v[196:199], v[96:111]
    ds_read_b64_tr_b16 v[48:49], v20 offset:63488
    ds_read_b64_tr_b16 v[50:51], v20 offset:64512
    ds_read_b64_tr_b16 v[52:53], v21 offset:63488
    ds_read_b64_tr_b16 v[54:55], v21 offset:64512
    v_mfma_f32_32x32x16_bf16 v[112:127], v[60:63], v[196:199], v[112:127]
    s_waitcnt vmcnt(2) lgkmcnt(4)
    v_mfma_f32_32x32x16_bf16 v[96:111], v[40:43], v[200:203], v[96:111]
    v_add_u32 v20, 0x10000, v20
    v_add_u32 v21, 0x10000, v21
    ds_read_b64_tr_b16 v[56:57], v20 offset:0
    ds_read_b64_tr_b16 v[58:59], v20 offset:1024
    ds_read_b64_tr_b16 v[60:61], v21 offset:0
    ds_read_b64_tr_b16 v[62:63], v21 offset:1024
    v_mfma_f32_32x32x16_bf16 v[112:127], v[44:47], v[200:203], v[112:127]
    s_waitcnt vmcnt(1) lgkmcnt(4)
    v_mfma_f32_32x32x16_bf16 v[96:111], v[48:51], v[204:207], v[96:111]
    ds_read_b64_tr_b16 v[40:41], v20 offset:2048
    ds_read_b64_tr_b16 v[42:43], v20 offset:3072
    ds_read_b64_tr_b16 v[44:45], v21 offset:2048
    ds_read_b64_tr_b16 v[46:47], v21 offset:3072
    v_mfma_f32_32x32x16_bf16 v[112:127], v[52:55], v[204:207], v[112:127]
    s_barrier
    s_waitcnt lgkmcnt(4)
    v_mfma_f32_32x32x16_bf16 v[64:79], v[56:59], v[208:211], 0
    ds_read_b64_tr_b16 v[48:49], v20 offset:4096
    ds_read_b64_tr_b16 v[50:51], v20 offset:5120
    ds_read_b64_tr_b16 v[52:53], v21 offset:4096
    ds_read_b64_tr_b16 v[54:55], v21 offset:5120
    v_mfma_f32_32x32x16_bf16 v[80:95], v[60:63], v[208:211], 0
    s_waitcnt lgkmcnt(4)
    v_mfma_f32_32x32x16_bf16 v[64:79], v[40:43], v[212:215], v[64:79]
    ds_read_b64_tr_b16 v[56:57], v20 offset:6144
    ds_read_b64_tr_b16 v[58:59], v20 offset:7168
    ds_read_b64_tr_b16 v[60:61], v21 offset:6144
    ds_read_b64_tr_b16 v[62:63], v21 offset:7168
    v_mfma_f32_32x32x16_bf16 v[80:95], v[44:47], v[212:215], v[80:95]
    s_waitcnt lgkmcnt(4)
    v_mfma_f32_32x32x16_bf16 v[64:79], v[48:51], v[216:219], v[64:79]
    ds_read_b64_tr_b16 v[40:41], v20 offset:8192
    ds_read_b64_tr_b16 v[42:43], v20 offset:9216
    ds_read_b64_tr_b16 v[44:45], v21 offset:8192
    ds_read_b64_tr_b16 v[46:47], v21 offset:9216
    v_mfma_f32_32x32x16_bf16 v[80:95], v[52:55], v[216:219], v[80:95]
    s_barrier
    ds_read_b128 v[208:211], v23 offset:0
    s_waitcnt lgkmcnt(5)
    v_mfma_f32_32x32x16_bf16 v[64:79], v[56:59], v[220:223], v[64:79]
    ds_read_b64_tr_b16 v[48:49], v20 offset:10240
    ds_read_b64_tr_b16 v[50:51], v20 offset:11264
    ds_read_b64_tr_b16 v[52:53], v21 offset:10240
    ds_read_b64_tr_b16 v[54:55], v21 offset:11264
    v_mfma_f32_32x32x16_bf16 v[80:95], v[60:63], v[220:223], v[80:95]
    ds_read_b128 v[212:215], v23 offset:32
    s_waitcnt lgkmcnt(6)
    v_mfma_f32_32x32x16_bf16 v[64:79], v[40:43], v[224:227], v[64:79]
    ds_read_b64_tr_b16 v[56:57], v20 offset:12288
    ds_read_b64_tr_b16 v[58:59], v20 offset:13312
    ds_read_b64_tr_b16 v[60:61], v21 offset:12288
    ds_read_b64_tr_b16 v[62:63], v21 offset:13312
    v_mfma_f32_32x32x16_bf16 v[80:95], v[44:47], v[224:227], v[80:95]
    ds_read_b128 v[216:219], v23 offset:64
    s_waitcnt lgkmcnt(6)
    v_mfma_f32_32x32x16_bf16 v[64:79], v[48:51], v[228:231], v[64:79]
    ds_read_b64_tr_b16 v[40:41], v20 offset:14336
    ds_read_b64_tr_b16 v[42:43], v20 offset:15360
    ds_read_b64_tr_b16 v[44:45], v21 offset:14336
    ds_read_b64_tr_b16 v[46:47], v21 offset:15360
    v_fma_f32 v96, v36, v208, v96
    v_fma_f32 v97, v36, v209, v97
    v_fma_f32 v98, v36, v210, v98
    v_mfma_f32_32x32x16_bf16 v[80:95], v[52:55], v[228:231], v[80:95]
    ds_read_b128 v[220:223], v23 offset:96
    v_fma_f32 v99, v36, v211, v99
    v_mul_f32 v208, v96, v96
    v_mul_f32 v209, v97, v97
    v_mul_f32 v210, v98, v98
    v_mul_f32 v211, v99, v99
    v_fma_f32 v208, v208, v38, v39
    v_fma_f32 v209, v209, v38, v39
    v_fma_f32 v210, v210, v38, v39
    v_fma_f32 v211, v211, v38, v39
    s_waitcnt lgkmcnt(6)
    v_mfma_f32_32x32x16_bf16 v[64:79], v[56:59], v[232:235], v[64:79]
    ds_read_b64_tr_b16 v[48:49], v20 offset:16384
    ds_read_b64_tr_b16 v[50:51], v20 offset:17408
    ds_read_b64_tr_b16 v[52:53], v21 offset:16384
    ds_read_b64_tr_b16 v[54:55], v21 offset:17408
    v_mul_f32 v208, v208, v96
    v_mul_f32 v209, v209, v97
    v_mul_f32 v210, v210, v98
    v_mfma_f32_32x32x16_bf16 v[80:95], v[60:63], v[232:235], v[80:95]
    ds_read_b128 v[224:227], v23 offset:128
    v_mul_f32 v211, v211, v99
    v_exp_f32 v208, v208
    v_exp_f32 v209, v209
    v_exp_f32 v210, v210
    v_exp_f32 v211, v211
    v_fma_f32 v208, v208, v14, v14
    v_fma_f32 v209, v209, v14, v14
    v_fma_f32 v210, v210, v14, v14
    v_fma_f32 v211, v211, v14, v14
    s_waitcnt lgkmcnt(6)
    v_mfma_f32_32x32x16_bf16 v[64:79], v[40:43], v[236:239], v[64:79]
    ds_read_b64_tr_b16 v[56:57], v20 offset:18432
    ds_read_b64_tr_b16 v[58:59], v20 offset:19456
    ds_read_b64_tr_b16 v[60:61], v21 offset:18432
    ds_read_b64_tr_b16 v[62:63], v21 offset:19456
    v_rcp_f32 v208, v208
    v_rcp_f32 v209, v209
    v_rcp_f32 v210, v210
    v_mfma_f32_32x32x16_bf16 v[80:95], v[44:47], v[236:239], v[80:95]
    ds_read_b128 v[228:231], v23 offset:160
    v_rcp_f32 v211, v211
    v_mul_f32 v208, v208, v96
    v_mul_f32 v209, v209, v97
    v_mul_f32 v210, v210, v98
    v_mul_f32 v211, v211, v99
    v_cvt_pk_bf16_f32 v28, v208, v209
    v_cvt_pk_bf16_f32 v29, v210, v211
    v_fma_f32 v100, v36, v212, v100
    v_fma_f32 v101, v36, v213, v101
    s_waitcnt lgkmcnt(6)
    v_mfma_f32_32x32x16_bf16 v[64:79], v[48:51], v[240:243], v[64:79]
    ds_read_b64_tr_b16 v[40:41], v20 offset:20480
    ds_read_b64_tr_b16 v[42:43], v20 offset:21504
    ds_read_b64_tr_b16 v[44:45], v21 offset:20480
    ds_read_b64_tr_b16 v[46:47], v21 offset:21504
    v_fma_f32 v102, v36, v214, v102
    v_fma_f32 v103, v36, v215, v103
    v_mul_f32 v212, v100, v100
    v_mfma_f32_32x32x16_bf16 v[80:95], v[52:55], v[240:243], v[80:95]
    ds_read_b128 v[232:235], v23 offset:192
    v_mul_f32 v213, v101, v101
    v_mul_f32 v214, v102, v102
    v_mul_f32 v215, v103, v103
    v_fma_f32 v212, v212, v38, v39
    v_fma_f32 v213, v213, v38, v39
    v_fma_f32 v214, v214, v38, v39
    v_fma_f32 v215, v215, v38, v39
    v_mul_f32 v212, v212, v100
    v_mul_f32 v213, v213, v101
    s_waitcnt lgkmcnt(6)
    v_mfma_f32_32x32x16_bf16 v[64:79], v[56:59], v[244:247], v[64:79]
    ds_read_b64_tr_b16 v[48:49], v20 offset:22528
    ds_read_b64_tr_b16 v[50:51], v20 offset:23552
    ds_read_b64_tr_b16 v[52:53], v21 offset:22528
    ds_read_b64_tr_b16 v[54:55], v21 offset:23552
    v_mul_f32 v214, v214, v102
    v_mul_f32 v215, v215, v103
    v_exp_f32 v212, v212
    v_mfma_f32_32x32x16_bf16 v[80:95], v[60:63], v[244:247], v[80:95]
    ds_read_b128 v[236:239], v23 offset:224
    v_exp_f32 v213, v213
    v_exp_f32 v214, v214
    v_exp_f32 v215, v215
    v_fma_f32 v212, v212, v14, v14
    v_fma_f32 v213, v213, v14, v14
    v_fma_f32 v214, v214, v14, v14
    v_fma_f32 v215, v215, v14, v14
    v_rcp_f32 v212, v212
    v_rcp_f32 v213, v213
    s_waitcnt lgkmcnt(6)
    v_mfma_f32_32x32x16_bf16 v[64:79], v[40:43], v[248:251], v[64:79]
    ds_read_b64_tr_b16 v[56:57], v20 offset:24576
    ds_read_b64_tr_b16 v[58:59], v20 offset:25600
    ds_read_b64_tr_b16 v[60:61], v21 offset:24576
    s_branch L_pgo4
L_pg4:
    s_setpc_b64 s[58:59]
L_pgo4:
    ds_read_b64_tr_b16 v[62:63], v21 offset:25600
    v_rcp_f32 v214, v214
    v_rcp_f32 v215, v215
    v_mul_f32 v212, v212, v100
    v_mfma_f32_32x32x16_bf16 v[80:95], v[44:47], v[248:251], v[80:95]
    v_mul_f32 v213, v213, v101
    v_mul_f32 v214, v214, v102
    v_mul_f32 v215, v215, v103
    v_cvt_pk_bf16_f32 v30, v212, v213
    v_cvt_pk_bf16_f32 v31, v214, v215
    buffer_store_dwordx4 v[28:31], v2, s[28:31], s64 offen offset:0 sc1
    v_fma_f32 v104, v36, v216, v104
    v_fma_f32 v105, v36, v217, v105
    v_fma_f32 v106, v36, v218, v106
    s_waitcnt lgkmcnt(5)
    v_mfma_f32_32x32x16_bf16 v[64:79], v[48:51], v[252:255], v[64:79]
    ds_read_b64_tr_b16 v[40:41], v20 offset:26624
    ds_read_b64_tr_b16 v[42:43], v20 offset:27648
    ds_read_b64_tr_b16 v[44:45], v21 offset:26624
    ds_read_b64_tr_b16 v[46:47], v21 offset:27648
    v_fma_f32 v107, v36, v219, v107
    v_mul_f32 v216, v104, v104
    v_mul_f32 v217, v105, v105
    v_mfma_f32_32x32x16_bf16 v[80:95], v[52:55], v[252:255], v[80:95]
    v_mul_f32 v218, v106, v106
    v_mul_f32 v219, v107, v107
    v_fma_f32 v216, v216, v38, v39
    v_fma_f32 v217, v217, v38, v39
    v_fma_f32 v218, v218, v38, v39
    v_fma_f32 v219, v219, v38, v39
    v_mul_f32 v216, v216, v104
    v_mul_f32 v217, v217, v105
    v_mul_f32 v218, v218, v106
    s_waitcnt lgkmcnt(4)
    v_mfma_f32_32x32x16_bf16 v[64:79], v[56:59], v[128:131], v[64:79]
    ds_read_b64_tr_b16 v[48:49], v20 offset:28672
    ds_read_b64_tr_b16 v[50:51], v20 offset:29696
    ds_read_b64_tr_b16 v[52:53], v21 offset:28672
    ds_read_b64_tr_b16 v[54:55], v21 offset:29696
    v_mul_f32 v219, v219, v107
    v_exp_f32 v216, v216
    v_exp_f32 v217, v217
    v_mfma_f32_32x32x16_bf16 v[80:95], v[60:63], v[128:131], v[80:95]
    v_exp_f32 v218, v218
    v_exp_f32 v219, v219
    v_fma_f32 v216, v216, v14, v14
    v_fma_f32 v217, v217, v14, v14
    v_fma_f32 v218, v218, v14, v14
    v_fma_f32 v219, v219, v14, v14
    v_rcp_f32 v216, v216
    v_rcp_f32 v217, v217
    v_rcp_f32 v218, v218
    s_waitcnt lgkmcnt(4)
    v_mfma_f32_32x32x16_bf16 v[64:79], v[40:43], v[132:135], v[64:79]
    ds_read_b64_tr_b16 v[56:57], v20 offset:30720
    ds_read_b64_tr_b16 v[58:59], v20 offset:31744
    ds_read_b64_tr_b16 v[60:61], v21 offset:30720
    ds_read_b64_tr_b16 v[62:63], v21 offset:31744
    v_rcp_f32 v219, v219
    v_mul_f32 v216, v216, v104
    v_mul_f32 v217, v217, v105
    v_mfma_f32_32x32x16_bf16 v[80:95], v[44:47], v[132:135], v[80:95]
    ds_read_b128 v[128:131], v23 offset:256
    v_mul_f32 v218, v218, v106
    v_mul_f32 v219, v219, v107
    v_cvt_pk_bf16_f32 v32, v216, v217
    v_cvt_pk_bf16_f32 v33, v218, v219
    v_fma_f32 v108, v36, v220, v108
    v_fma_f32 v109, v36, v221, v109
    v_fma_f32 v110, v36, v222, v110
    v_fma_f32 v111, v36, v223, v111
    v_mul_f32 v220, v108, v108
    s_waitcnt lgkmcnt(5)
    v_mfma_f32_32x32x16_bf16 v[64:79], v[48:51], v[136:139], v[64:79]
    ds_read_b64_tr_b16 v[40:41], v20 offset:32768
    ds_read_b64_tr_b16 v[42:43], v20 offset:33792
    ds_read_b64_tr_b16 v[44:45], v21 offset:32768
    ds_read_b64_tr_b16 v[46:47], v21 offset:33792
    v_mul_f32 v221, v109, v109
    v_mul_f32 v222, v110, v110
    v_mul_f32 v223, v111, v111
    v_mfma_f32_32x32x16_bf16 v[80:95], v[52:55], v[136:139], v[80:95]
    ds_read_b128 v[132:135], v23 offset:288
    v_fma_f32 v220, v220, v38, v39
    v_fma_f32 v221, v221, v38, v39
    v_fma_f32 v222, v222, v38, v39
    v_fma_f32 v223, v223, v38, v39
    v_mul_f32 v220, v220, v108
    v_mul_f32 v221, v221, v109
    v_mul_f32 v222, v222, v110
    v_mul_f32 v223, v223, v111
    v_exp_f32 v220, v220
    s_waitcnt lgkmcnt(6)
    v_mfma_f32_32x32x16_bf16 v[64:79], v[56:59], v[140:143], v[64:79]
    ds_read_b64_tr_b16 v[48:49], v20 offset:34816
    ds_read_b64_tr_b16 v[50:51], v20 offset:35840
    ds_read_b64_tr_b16 v[52:53], v21 offset:34816
    ds_read_b64_tr_b16 v[54:55], v21 offset:35840
    v_exp_f32 v221, v221
    v_exp_f32 v222, v222
    v_exp_f32 v223, v223
    v_mfma_f32_32x32x16_bf16 v[80:95], v[60:63], v[140:143], v[80:95]
    ds_read_b128 v[136:139], v23 offset:320
    v_fma_f32 v220, v220, v14, v14
    v_fma_f32 v221, v221, v14, v14
    v_fma_f32 v222, v222, v14, v14
    v_fma_f32 v223, v223, v14, v14
    v_rcp_f32 v220, v220
    v_rcp_f32 v221, v221
    v_rcp_f32 v222, v222
    v_rcp_f32 v223, v223
    v_mul_f32 v220, v220, v108
    s_waitcnt lgkmcnt(6)
    v_mfma_f32_32x32x16_bf16 v[64:79], v[40:43], v[144:147], v[64:79]
    ds_read_b64_tr_b16 v[56:57], v20 offset:36864
    ds_read_b64_tr_b16 v[58:59], v20 offset:37888
    ds_read_b64_tr_b16 v[60:61], v21 offset:36864
    ds_read_b64_tr_b16 v[62:63], v21 offset:37888
    v_mul_f32 v221, v221, v109
    v_mul_f32 v222, v222, v110
    v_mul_f32 v223, v223, v111
    v_mfma_f32_32x32x16_bf16 v[80:95], v[44:47], v[144:147], v[80:95]
    ds_read_b128 v[140:143], v23 offset:352
    v_cvt_pk_bf16_f32 v34, v220, v221
    v_cvt_pk_bf16_f32 v35, v222, v223
    buffer_store_dwordx4 v[32:35], v2, s[28:31], s64 offen offset:1024 sc1
    v_fma_f32 v112, v36, v224, v112
    v_fma_f32 v113, v36, v225, v113
    v_fma_f32 v114, v36, v226, v114
    v_fma_f32 v115, v36, v227, v115
    v_mul_f32 v224, v112, v112
    v_mul_f32 v225, v113, v113
    s_waitcnt lgkmcnt(6)
    v_mfma_f32_32x32x16_bf16 v[64:79], v[48:51], v[148:151], v[64:79]
    ds_read_b64_tr_b16 v[40:41], v20 offset:38912
    ds_read_b64_tr_b16 v[42:43], v20 offset:39936
    ds_read_b64_tr_b16 v[44:45], v21 offset:38912
    ds_read_b64_tr_b16 v[46:47], v21 offset:39936
    v_mul_f32 v226, v114, v114
    v_mul_f32 v227, v115, v115
    v_fma_f32 v224, v224, v38, v39
    v_mfma_f32_32x32x16_bf16 v[80:95], v[52:55], v[148:151], v[80:95]
    ds_read_b128 v[144:147], v23 offset:384
    s_barrier
    v_fma_f32 v225, v225, v38, v39
    v_fma_f32 v226, v226, v38, v39
    v_fma_f32 v227, v227, v38, v39
    v_mul_f32 v224, v224, v112
    v_mul_f32 v225, v225, v113
    v_mul_f32 v226, v226, v114
    v_mul_f32 v227, v227, v115
    v_exp_f32 v224, v224
    v_exp_f32 v225, v225
    s_waitcnt lgkmcnt(6)
    v_mfma_f32_32x32x16_bf16 v[64:79], v[56:59], v[152:155], v[64:79]
    ds_read_b64_tr_b16 v[48:49], v20 offset:40960
    ds_read_b64_tr_b16 v[50:51], v20 offset:41984
    ds_read_b64_tr_b16 v[52:53], v21 offset:40960
    ds_read_b64_tr_b16 v[54:55], v21 offset:41984
    v_exp_f32 v226, v226
    v_exp_f32 v227, v227
    v_fma_f32 v224, v224, v14, v14
    v_mfma_f32_32x32x16_bf16 v[80:95], v[60:63], v[152:155], v[80:95]
    ds_read_b128 v[148:151], v23 offset:416
    v_fma_f32 v225, v225, v14, v14
    v_fma_f32 v226, v226, v14, v14
    v_fma_f32 v227, v227, v14, v14
    v_rcp_f32 v224, v224
    v_rcp_f32 v225, v225
    v_rcp_f32 v226, v226
    v_rcp_f32 v227, v227
    v_mul_f32 v224, v224, v112
    v_mul_f32 v225, v225, v113
    s_waitcnt lgkmcnt(6)
    v_mfma_f32_32x32x16_bf16 v[64:79], v[40:43], v[156:159], v[64:79]
    ds_read_b64_tr_b16 v[56:57], v20 offset:43008
    ds_read_b64_tr_b16 v[58:59], v20 offset:44032
    ds_read_b64_tr_b16 v[60:61], v21 offset:43008
    ds_read_b64_tr_b16 v[62:63], v21 offset:44032
    v_mul_f32 v226, v226, v114
    v_mul_f32 v227, v227, v115
    v_cvt_pk_bf16_f32 v240, v224, v225
    v_mfma_f32_32x32x16_bf16 v[80:95], v[44:47], v[156:159], v[80:95]
    ds_read_b128 v[152:155], v23 offset:448
    v_cvt_pk_bf16_f32 v241, v226, v227
    v_fma_f32 v116, v36, v228, v116
    v_fma_f32 v117, v36, v229, v117
    v_fma_f32 v118, v36, v230, v118
    v_fma_f32 v119, v36, v231, v119
    v_mul_f32 v228, v116, v116
    v_mul_f32 v229, v117, v117
    v_mul_f32 v230, v118, v118
    v_mul_f32 v231, v119, v119
    s_waitcnt lgkmcnt(6)
    v_mfma_f32_32x32x16_bf16 v[64:79], v[48:51], v[160:163], v[64:79]
    ds_read_b64_tr_b16 v[40:41], v20 offset:45056
    ds_read_b64_tr_b16 v[42:43], v20 offset:46080
    ds_read_b64_tr_b16 v[44:45], v21 offset:45056
    ds_read_b64_tr_b16 v[46:47], v21 offset:46080
    v_fma_f32 v228, v228, v38, v39
    v_fma_f32 v229, v229, v38, v39
    v_fma_f32 v230, v230, v38, v39
    v_mfma_f32_32x32x16_bf16 v[80:95], v[52:55], v[160:163], v[80:95]
    ds_read_b128 v[156:159], v23 offset:480
    v_fma_f32 v231, v231, v38, v39
    v_mul_f32 v228, v228, v116
    v_mul_f32 v229, v229, v117
    v_mul_f32 v230, v230, v118
    v_mul_f32 v231, v231, v119
    v_exp_f32 v228, v228
    v_exp_f32 v229, v229
    v_exp_f32 v230, v230
    v_exp_f32 v231, v231
    s_waitcnt lgkmcnt(6)
    v_mfma_f32_32x32x16_bf16 v[64:79], v[56:59], v[164:167], v[64:79]
    ds_read_b64_tr_b16 v[48:49], v20 offset:47104
    ds_read_b64_tr_b16 v[50:51], v20 offset:48128
    ds_read_b64_tr_b16 v[52:53], v21 offset:47104
    ds_read_b64_tr_b16 v[54:55], v21 offset:48128
    v_fma_f32 v228, v228, v14, v14
    v_fma_f32 v229, v229, v14, v14
    v_fma_f32 v230, v230, v14, v14
    v_mfma_f32_32x32x16_bf16 v[80:95], v[60:63], v[164:167], v[80:95]
    v_fma_f32 v231, v231, v14, v14
    v_rcp_f32 v228, v228
    v_rcp_f32 v229, v229
    v_rcp_f32 v230, v230
    v_rcp_f32 v231, v231
    v_mul_f32 v228, v228, v116
    v_mul_f32 v229, v229, v117
    v_mul_f32 v230, v230, v118
    v_mul_f32 v231, v231, v119
    s_waitcnt lgkmcnt(5)
    v_mfma_f32_32x32x16_bf16 v[64:79], v[40:43], v[168:171], v[64:79]
    ds_read_b64_tr_b16 v[56:57], v20 offset:49152
    ds_read_b64_tr_b16 v[58:59], v20 offset:50176
    ds_read_b64_tr_b16 v[60:61], v21 offset:49152
    ds_read_b64_tr_b16 v[62:63], v21 offset:50176
    v_cvt_pk_bf16_f32 v242, v228, v229
    v_cvt_pk_bf16_f32 v243, v230, v231
    buffer_store_dwordx4 v[240:243], v2, s[28:31], s64 offen offset:2048 sc1
    v_mfma_f32_32x32x16_bf16 v[80:95], v[44:47], v[168:171], v[80:95]
    v_fma_f32 v120, v36, v232, v120
    v_fma_f32 v121, v36, v233, v121
    v_fma_f32 v122, v36, v234, v122
    v_fma_f32 v123, v36, v235, v123
    v_mul_f32 v232, v120, v120
    v_mul_f32 v233, v121, v121
    v_mul_f32 v234, v122, v122
    v_mul_f32 v235, v123, v123
    v_fma_f32 v232, v232, v38, v39
    s_waitcnt lgkmcnt(4)
    v_mfma_f32_32x32x16_bf16 v[64:79], v[48:51], v[172:175], v[64:79]
    ds_read_b64_tr_b16 v[40:41], v20 offset:51200
    ds_read_b64_tr_b16 v[42:43], v20 offset:52224
    ds_read_b64_tr_b16 v[44:45], v21 offset:51200
    ds_read_b64_tr_b16 v[46:47], v21 offset:52224
    v_fma_f32 v233, v233, v38, v39
    v_fma_f32 v234, v234, v38, v39
    v_fma_f32 v235, v235, v38, v39
    v_mfma_f32_32x32x16_bf16 v[80:95], v[52:55], v[172:175], v[80:95]
    v_mul_f32 v232, v232, v120
    v_mul_f32 v233, v233, v121
    v_mul_f32 v234, v234, v122
    v_mul_f32 v235, v235, v123
    v_exp_f32 v232, v232
    v_exp_f32 v233, v233
    v_exp_f32 v234, v234
    v_exp_f32 v235, v235
    v_fma_f32 v232, v232, v14, v14
    s_waitcnt lgkmcnt(4)
    v_mfma_f32_32x32x16_bf16 v[64:79], v[56:59], v[176:179], v[64:79]
    ds_read_b64_tr_b16 v[48:49], v20 offset:53248
    ds_read_b64_tr_b16 v[50:51], v20 offset:54272
    ds_read_b64_tr_b16 v[52:53], v21 offset:53248
    ds_read_b64_tr_b16 v[54:55], v21 offset:54272
    v_fma_f32 v233, v233, v14, v14
    v_fma_f32 v234, v234, v14, v14
    v_fma_f32 v235, v235, v14, v14
    v_mfma_f32_32x32x16_bf16 v[80:95], v[60:63], v[176:179], v[80:95]
    v_rcp_f32 v232, v232
    v_rcp_f32 v233, v233
    v_rcp_f32 v234, v234
    v_rcp_f32 v235, v235
    v_mul_f32 v232, v232, v120
    v_mul_f32 v233, v233, v121
    v_mul_f32 v234, v234, v122
    v_mul_f32 v235, v235, v123
    v_cvt_pk_bf16_f32 v244, v232, v233
    s_waitcnt lgkmcnt(4)
    v_mfma_f32_32x32x16_bf16 v[64:79], v[40:43], v[180:183], v[64:79]
    ds_read_b64_tr_b16 v[56:57], v20 offset:55296
    ds_read_b64_tr_b16 v[58:59], v20 offset:56320
    ds_read_b64_tr_b16 v[60:61], v21 offset:55296
    ds_read_b64_tr_b16 v[62:63], v21 offset:56320
    v_cvt_pk_bf16_f32 v245, v234, v235
    v_fma_f32 v124, v36, v236, v124
    v_fma_f32 v125, v36, v237, v125
    v_mfma_f32_32x32x16_bf16 v[80:95], v[44:47], v[180:183], v[80:95]
    v_fma_f32 v126, v36, v238, v126
    v_fma_f32 v127, v36, v239, v127
    v_mul_f32 v236, v124, v124
    v_mul_f32 v237, v125, v125
    v_mul_f32 v238, v126, v126
    v_mul_f32 v239, v127, v127
    v_fma_f32 v236, v236, v38, v39
    v_fma_f32 v237, v237, v38, v39
    v_fma_f32 v238, v238, v38, v39
    s_waitcnt lgkmcnt(4)
    v_mfma_f32_32x32x16_bf16 v[64:79], v[48:51], v[184:187], v[64:79]
    ds_read_b64_tr_b16 v[40:41], v20 offset:57344
    ds_read_b64_tr_b16 v[42:43], v20 offset:58368
    ds_read_b64_tr_b16 v[44:45], v21 offset:57344
    ds_read_b64_tr_b16 v[46:47], v21 offset:58368
    v_mfma_f32_32x32x16_bf16 v[80:95], v[52:55], v[184:187], v[80:95]
    s_waitcnt vmcnt(1)
    s_barrier
    v_fma_f32 v239, v239, v38, v39
    v_mul_f32 v236, v236, v124
    v_mul_f32 v237, v237, v125
    v_mul_f32 v238, v238, v126
    v_mul_f32 v239, v239, v127
    v_exp_f32 v236, v236
    v_exp_f32 v237, v237
    v_exp_f32 v238, v238
    v_exp_f32 v239, v239
    v_fma_f32 v236, v236, v14, v14
    v_fma_f32 v237, v237, v14, v14
    v_fma_f32 v238, v238, v14, v14
    s_waitcnt lgkmcnt(4)
    v_mfma_f32_32x32x16_bf16 v[64:79], v[56:59], v[188:191], v[64:79]
    ds_read_b64_tr_b16 v[48:49], v20 offset:59392
    ds_read_b64_tr_b16 v[50:51], v20 offset:60416
    ds_read_b64_tr_b16 v[52:53], v21 offset:59392
    ds_read_b64_tr_b16 v[54:55], v21 offset:60416
    v_fma_f32 v239, v239, v14, v14
    v_rcp_f32 v236, v236
    v_rcp_f32 v237, v237
    v_mfma_f32_32x32x16_bf16 v[80:95], v[60:63], v[188:191], v[80:95]
    v_rcp_f32 v238, v238
    v_rcp_f32 v239, v239
    v_mul_f32 v236, v236, v124
    v_mul_f32 v237, v237, v125
    v_mul_f32 v238, v238, v126
    v_mul_f32 v239, v239, v127
    v_cvt_pk_bf16_f32 v246, v236, v237
    v_cvt_pk_bf16_f32 v247, v238, v239
    buffer_store_dwordx4 v[244:247], v2, s[28:31], s64 offen offset:3072 sc1
    s_waitcnt lgkmcnt(4)
    v_mfma_f32_32x32x16_bf16 v[64:79], v[40:43], v[192:195], v[64:79]
    ds_read_b64_tr_b16 v[56:57], v20 offset:61440
    ds_read_b64_tr_b16 v[58:59], v20 offset:62464
    ds_read_b64_tr_b16 v[60:61], v21 offset:61440
    ds_read_b64_tr_b16 v[62:63], v21 offset:62464
    v_mfma_f32_32x32x16_bf16 v[80:95], v[44:47], v[192:195], v[80:95]
    s_waitcnt lgkmcnt(4)
    v_mfma_f32_32x32x16_bf16 v[64:79], v[48:51], v[196:199], v[64:79]
    ds_read_b64_tr_b16 v[40:41], v20 offset:63488
    ds_read_b64_tr_b16 v[42:43], v20 offset:64512
    ds_read_b64_tr_b16 v[44:45], v21 offset:63488
    ds_read_b64_tr_b16 v[46:47], v21 offset:64512
    v_mfma_f32_32x32x16_bf16 v[80:95], v[52:55], v[196:199], v[80:95]
    s_waitcnt lgkmcnt(4)
    v_mfma_f32_32x32x16_bf16 v[64:79], v[56:59], v[200:203], v[64:79]
    v_mfma_f32_32x32x16_bf16 v[80:95], v[60:63], v[200:203], v[80:95]
    s_waitcnt lgkmcnt(0)
    v_mfma_f32_32x32x16_bf16 v[64:79], v[40:43], v[204:207], v[64:79]
    v_mfma_f32_32x32x16_bf16 v[80:95], v[44:47], v[204:207], v[80:95]
    s_barrier
    s_add_u32 s64, s64, 4096
    v_lshrrev_b32 v40, 5, v1
    v_bfe_u32 v41, v1, 2, 2
    v_lshl_add_u32 v41, v40, 2, v41
    v_lshlrev_b32 v20, 7, v41
    v_bfe_u32 v41, v1, 3, 1
    v_xor_b32 v41, s47, v41
    v_lshl_add_u32 v20, v41, 6, v20
    v_bfe_u32 v41, v1, 4, 1
    v_lshl_add_u32 v20, v41, 5, v20
    v_and_b32 v41, 3, v1
    v_lshl_add_u32 v20, v41, 3, v20
    s_lshl_b32 s56, s47, 11
    v_add_u32 v20, s56, v20
    v_xor_b32 v21, 64, v20
    v_add_u32 v22, 0x20000, v20
    v_add_u32 v23, 0x20000, v21
    v_pk_fma_f32 v[160:161], v[36:37], v[128:129], v[64:65] op_sel_hi:[0,1,1]
    v_pk_fma_f32 v[162:163], v[36:37], v[130:131], v[66:67] op_sel_hi:[0,1,1]
    v_pk_fma_f32 v[164:165], v[36:37], v[132:133], v[68:69] op_sel_hi:[0,1,1]
    v_pk_fma_f32 v[166:167], v[36:37], v[134:135], v[70:71] op_sel_hi:[0,1,1]
    s_add_u32 s81, s78, 0
    buffer_load_dwordx4 v[208:211], v2, s[28:31], s81 offen offset:0 sc1
    v_pk_fma_f32 v[168:169], v[36:37], v[136:137], v[72:73] op_sel_hi:[0,1,1]
    v_pk_fma_f32 v[170:171], v[36:37], v[138:139], v[74:75] op_sel_hi:[0,1,1]
    v_pk_fma_f32 v[172:173], v[36:37], v[140:141], v[76:77] op_sel_hi:[0,1,1]
    v_pk_fma_f32 v[174:175], v[36:37], v[142:143], v[78:79] op_sel_hi:[0,1,1]
    v_pk_mul_f32 v[176:177], v[160:161], v[160:161]
    v_pk_mul_f32 v[178:179], v[162:163], v[162:163]
    v_pk_mul_f32 v[180:181], v[164:165], v[164:165]
    v_pk_mul_f32 v[182:183], v[166:167], v[166:167]
    v_pk_mul_f32 v[184:185], v[168:169], v[168:169]
    v_pk_mul_f32 v[186:187], v[170:171], v[170:171]
    v_pk_mul_f32 v[188:189], v[172:173], v[172:173]
    v_pk_mul_f32 v[190:191], v[174:175], v[174:175]
    s_add_u32 s81, s78, 0
    buffer_load_dwordx4 v[212:215], v2, s[28:31], s81 offen offset:2048 sc1
    v_pk_fma_f32 v[176:177], v[176:177], v[38:39], v[38:39] op_sel:[0,0,1] op_sel_hi:[1,0,1]
    v_pk_fma_f32 v[178:179], v[178:179], v[38:39], v[38:39] op_sel:[0,0,1] op_sel_hi:[1,0,1]
    v_pk_fma_f32 v[180:181], v[180:181], v[38:39], v[38:39] op_sel:[0,0,1] op_sel_hi:[1,0,1]
    v_pk_fma_f32 v[182:183], v[182:183], v[38:39], v[38:39] op_sel:[0,0,1] op_sel_hi:[1,0,1]
    v_pk_fma_f32 v[184:185], v[184:185], v[38:39], v[38:39] op_sel:[0,0,1] op_sel_hi:[1,0,1]
    v_pk_fma_f32 v[186:187], v[186:187], v[38:39], v[38:39] op_sel:[0,0,1] op_sel_hi:[1,0,1]
    v_pk_fma_f32 v[188:189], v[188:189], v[38:39], v[38:39] op_sel:[0,0,1] op_sel_hi:[1,0,1]
    v_pk_fma_f32 v[190:191], v[190:191], v[38:39], v[38:39] op_sel:[0,0,1] op_sel_hi:[1,0,1]
    v_pk_mul_f32 v[176:177], v[176:177], v[160:161]
    v_pk_mul_f32 v[178:179], v[178:179], v[162:163]
    v_pk_mul_f32 v[180:181], v[180:181], v[164:165]
    v_pk_mul_f32 v[182:183], v[182:183], v[166:167]
    s_add_u32 s81, s78, 4096
    buffer_load_dwordx4 v[216:219], v2, s[28:31], s81 offen offset:0 sc1
    v_pk_mul_f32 v[184:185], v[184:185], v[168:169]
    v_pk_mul_f32 v[186:187], v[186:187], v[170:171]
    v_pk_mul_f32 v[188:189], v[188:189], v[172:173]
    v_pk_mul_f32 v[190:191], v[190:191], v[174:175]
    v_exp_f32 v176, v176
    v_exp_f32 v177, v177
    v_exp_f32 v178, v178
    v_exp_f32 v179, v179
    v_exp_f32 v180, v180
    v_exp_f32 v181, v181
    v_exp_f32 v182, v182
    v_exp_f32 v183, v183
    s_add_u32 s81, s78, 4096
    buffer_load_dwordx4 v[220:223], v2, s[28:31], s81 offen offset:2048 sc1
    v_exp_f32 v184, v184
    v_exp_f32 v185, v185
    v_exp_f32 v186, v186
    v_exp_f32 v187, v187
    v_exp_f32 v188, v188
    v_exp_f32 v189, v189
    v_exp_f32 v190, v190
    v_exp_f32 v191, v191
    v_pk_fma_f32 v[176:177], v[176:177], v[14:15], v[14:15] op_sel_hi:[1,0,0]
    v_pk_fma_f32 v[178:179], v[178:179], v[14:15], v[14:15] op_sel_hi:[1,0,0]
    v_pk_fma_f32 v[180:181], v[180:181], v[14:15], v[14:15] op_sel_hi:[1,0,0]
    v_pk_fma_f32 v[182:183], v[182:183], v[14:15], v[14:15] op_sel_hi:[1,0,0]
    v_pk_fma_f32 v[184:185], v[184:185], v[14:15], v[14:15] op_sel_hi:[1,0,0]
    v_pk_fma_f32 v[186:187], v[186:187], v[14:15], v[14:15] op_sel_hi:[1,0,0]
    v_pk_fma_f32 v[188:189], v[188:189], v[14:15], v[14:15] op_sel_hi:[1,0,0]
    v_pk_fma_f32 v[190:191], v[190:191], v[14:15], v[14:15] op_sel_hi:[1,0,0]
    v_rcp_f32 v176, v176
    v_rcp_f32 v177, v177
    v_rcp_f32 v178, v178
    v_rcp_f32 v179, v179
    v_rcp_f32 v180, v180
    v_rcp_f32 v181, v181
    v_rcp_f32 v182, v182
    v_rcp_f32 v183, v183
    v_rcp_f32 v184, v184
    v_rcp_f32 v185, v185
    v_rcp_f32 v186, v186
    v_rcp_f32 v187, v187
    v_rcp_f32 v188, v188
    v_rcp_f32 v189, v189
    v_rcp_f32 v190, v190
    v_rcp_f32 v191, v191
    v_pk_mul_f32 v[176:177], v[176:177], v[160:161]
    v_pk_mul_f32 v[178:179], v[178:179], v[162:163]
    v_pk_mul_f32 v[180:181], v[180:181], v[164:165]
    v_pk_mul_f32 v[182:183], v[182:183], v[166:167]
    v_pk_mul_f32 v[184:185], v[184:185], v[168:169]
    v_pk_mul_f32 v[186:187], v[186:187], v[170:171]
    v_pk_mul_f32 v[188:189], v[188:189], v[172:173]
    v_pk_mul_f32 v[190:191], v[190:191], v[174:175]
    v_cvt_pk_bf16_f32 v192, v176, v177
    v_cvt_pk_bf16_f32 v193, v178, v179
    v_cvt_pk_bf16_f32 v194, v180, v181
    v_cvt_pk_bf16_f32 v195, v182, v183
    v_cvt_pk_bf16_f32 v196, v184, v185
    v_cvt_pk_bf16_f32 v197, v186, v187
    v_cvt_pk_bf16_f32 v198, v188, v189
    v_cvt_pk_bf16_f32 v199, v190, v191
    s_waitcnt vmcnt(4)
    s_barrier
    buffer_store_dwordx4 v[192:195], v2, s[28:31], s64 offen offset:0 sc1
    buffer_store_dwordx4 v[196:199], v2, s[28:31], s64 offen offset:1024 sc1
    v_pk_fma_f32 v[160:161], v[36:37], v[144:145], v[80:81] op_sel_hi:[0,1,1]
    v_pk_fma_f32 v[162:163], v[36:37], v[146:147], v[82:83] op_sel_hi:[0,1,1]
    v_pk_fma_f32 v[164:165], v[36:37], v[148:149], v[84:85] op_sel_hi:[0,1,1]
    v_pk_fma_f32 v[166:167], v[36:37], v[150:151], v[86:87] op_sel_hi:[0,1,1]
    s_add_u32 s81, s79, 0
    buffer_load_dwordx4 v[224:227], v2, s[28:31], s81 offen offset:0 sc1
    v_pk_fma_f32 v[168:169], v[36:37], v[152:153], v[88:89] op_sel_hi:[0,1,1]
    v_pk_fma_f32 v[170:171], v[36:37], v[154:155], v[90:91] op_sel_hi:[0,1,1]
    v_pk_fma_f32 v[172:173], v[36:37], v[156:157], v[92:93] op_sel_hi:[0,1,1]
    v_pk_fma_f32 v[174:175], v[36:37], v[158:159], v[94:95] op_sel_hi:[0,1,1]
    v_pk_mul_f32 v[176:177], v[160:161], v[160:161]
    v_pk_mul_f32 v[178:179], v[162:163], v[162:163]
    v_pk_mul_f32 v[180:181], v[164:165], v[164:165]
    v_pk_mul_f32 v[182:183], v[166:167], v[166:167]
    v_pk_mul_f32 v[184:185], v[168:169], v[168:169]
    v_pk_mul_f32 v[186:187], v[170:171], v[170:171]
    v_pk_mul_f32 v[188:189], v[172:173], v[172:173]
    v_pk_mul_f32 v[190:191], v[174:175], v[174:175]
    s_add_u32 s81, s79, 0
    buffer_load_dwordx4 v[228:231], v2, s[28:31], s81 offen offset:2048 sc1
    v_pk_fma_f32 v[176:177], v[176:177], v[38:39], v[38:39] op_sel:[0,0,1] op_sel_hi:[1,0,1]
    v_pk_fma_f32 v[178:179], v[178:179], v[38:39], v[38:39] op_sel:[0,0,1] op_sel_hi:[1,0,1]
    v_pk_fma_f32 v[180:181], v[180:181], v[38:39], v[38:39] op_sel:[0,0,1] op_sel_hi:[1,0,1]
    v_pk_fma_f32 v[182:183], v[182:183], v[38:39], v[38:39] op_sel:[0,0,1] op_sel_hi:[1,0,1]
    v_pk_fma_f32 v[184:185], v[184:185], v[38:39], v[38:39] op_sel:[0,0,1] op_sel_hi:[1,0,1]
    v_pk_fma_f32 v[186:187], v[186:187], v[38:39], v[38:39] op_sel:[0,0,1] op_sel_hi:[1,0,1]
    v_pk_fma_f32 v[188:189], v[188:189], v[38:39], v[38:39] op_sel:[0,0,1] op_sel_hi:[1,0,1]
    v_pk_fma_f32 v[190:191], v[190:191], v[38:39], v[38:39] op_sel:[0,0,1] op_sel_hi:[1,0,1]
    v_pk_mul_f32 v[176:177], v[176:177], v[160:161]
    v_pk_mul_f32 v[178:179], v[178:179], v[162:163]
    v_pk_mul_f32 v[180:181], v[180:181], v[164:165]
    v_pk_mul_f32 v[182:183], v[182:183], v[166:167]
    s_add_u32 s81, s79, 4096
    buffer_load_dwordx4 v[232:235], v2, s[28:31], s81 offen offset:0 sc1
    v_pk_mul_f32 v[184:185], v[184:185], v[168:169]
    v_pk_mul_f32 v[186:187], v[186:187], v[170:171]
    v_pk_mul_f32 v[188:189], v[188:189], v[172:173]
    v_pk_mul_f32 v[190:191], v[190:191], v[174:175]
    v_exp_f32 v176, v176
    v_exp_f32 v177, v177
    v_exp_f32 v178, v178
    v_exp_f32 v179, v179
    v_exp_f32 v180, v180
    v_exp_f32 v181, v181
    v_exp_f32 v182, v182
    v_exp_f32 v183, v183
    s_add_u32 s81, s79, 4096
    buffer_load_dwordx4 v[236:239], v2, s[28:31], s81 offen offset:2048 sc1
    v_exp_f32 v184, v184
    v_exp_f32 v185, v185
    v_exp_f32 v186, v186
    v_exp_f32 v187, v187
    v_exp_f32 v188, v188
    v_exp_f32 v189, v189
    v_exp_f32 v190, v190
    v_exp_f32 v191, v191
    v_pk_fma_f32 v[176:177], v[176:177], v[14:15], v[14:15] op_sel_hi:[1,0,0]
    v_pk_fma_f32 v[178:179], v[178:179], v[14:15], v[14:15] op_sel_hi:[1,0,0]
    v_pk_fma_f32 v[180:181], v[180:181], v[14:15], v[14:15] op_sel_hi:[1,0,0]
    v_pk_fma_f32 v[182:183], v[182:183], v[14:15], v[14:15] op_sel_hi:[1,0,0]
    v_pk_fma_f32 v[184:185], v[184:185], v[14:15], v[14:15] op_sel_hi:[1,0,0]
    v_pk_fma_f32 v[186:187], v[186:187], v[14:15], v[14:15] op_sel_hi:[1,0,0]
    v_pk_fma_f32 v[188:189], v[188:189], v[14:15], v[14:15] op_sel_hi:[1,0,0]
    v_pk_fma_f32 v[190:191], v[190:191], v[14:15], v[14:15] op_sel_hi:[1,0,0]
    v_rcp_f32 v176, v176
    v_rcp_f32 v177, v177
    v_rcp_f32 v178, v178
    v_rcp_f32 v179, v179
    v_rcp_f32 v180, v180
    v_rcp_f32 v181, v181
    v_rcp_f32 v182, v182
    v_rcp_f32 v183, v183
    v_rcp_f32 v184, v184
    v_rcp_f32 v185, v185
    v_rcp_f32 v186, v186
    v_rcp_f32 v187, v187
    v_rcp_f32 v188, v188
    v_rcp_f32 v189, v189
    v_rcp_f32 v190, v190
    v_rcp_f32 v191, v191
    v_pk_mul_f32 v[176:177], v[176:177], v[160:161]
    v_pk_mul_f32 v[178:179], v[178:179], v[162:163]
    v_pk_mul_f32 v[180:181], v[180:181], v[164:165]
    v_pk_mul_f32 v[182:183], v[182:183], v[166:167]
    v_pk_mul_f32 v[184:185], v[184:185], v[168:169]
    v_pk_mul_f32 v[186:187], v[186:187], v[170:171]
    v_pk_mul_f32 v[188:189], v[188:189], v[172:173]
    v_pk_mul_f32 v[190:191], v[190:191], v[174:175]
    v_cvt_pk_bf16_f32 v200, v176, v177
    v_cvt_pk_bf16_f32 v201, v178, v179
    v_cvt_pk_bf16_f32 v202, v180, v181
    v_cvt_pk_bf16_f32 v203, v182, v183
    v_cvt_pk_bf16_f32 v204, v184, v185
    v_cvt_pk_bf16_f32 v205, v186, v187
    v_cvt_pk_bf16_f32 v206, v188, v189
    v_cvt_pk_bf16_f32 v207, v190, v191
    buffer_store_dwordx4 v[200:203], v2, s[28:31], s64 offen offset:2048 sc1
    buffer_store_dwordx4 v[204:207], v2, s[28:31], s64 offen offset:3072 sc1
L_g3join_101023:
    s_waitcnt vmcnt(6)
    s_barrier
    v_and_b32 v19, 31, v1
    v_lshlrev_b32 v19, 2, v19
    buffer_load_dword v12, v19, s[28:31], s80 offen sc1
    ds_read_b64_tr_b16 v[24:25], v22 offset:16384
    ds_read_b64_tr_b16 v[26:27], v22 offset:17408
    ds_read_b64_tr_b16 v[28:29], v23 offset:16384
    ds_read_b64_tr_b16 v[30:31], v23 offset:17408
    ds_read_b64_tr_b16 v[32:33], v22 offset:20480
    ds_read_b64_tr_b16 v[34:35], v22 offset:21504
    ds_read_b64_tr_b16 v[36:37], v23 offset:20480
    ds_read_b64_tr_b16 v[38:39], v23 offset:21504
    s_waitcnt vmcnt(12) lgkmcnt(4)
    v_mfma_f32_32x32x16_bf16 v[48:63], v[24:27], v[208:211], 0
    ds_read_b64_tr_b16 v[40:41], v22 offset:24576
    ds_read_b64_tr_b16 v[42:43], v22 offset:25600
    ds_read_b64_tr_b16 v[44:45], v23 offset:24576
    ds_read_b64_tr_b16 v[46:47], v23 offset:25600
    v_lshlrev_b32 v80, 16, v4
    v_and_b32 v81, 0xffff0000, v4
    v_lshlrev_b32 v82, 16, v5
    v_and_b32 v83, 0xffff0000, v5
    v_mfma_f32_32x32x16_bf16 v[64:79], v[28:31], v[208:211], 0
    s_add_u32 s81, s75, s68
    buffer_load_dwordx4 v[240:243], v2, s[28:31], s81 offen offset:0 sc1
    s_waitcnt vmcnt(12) lgkmcnt(4)
    v_mfma_f32_32x32x16_bf16 v[48:63], v[32:35], v[212:215], v[48:63]
    ds_read_b64_tr_b16 v[24:25], v22 offset:28672
    ds_read_b64_tr_b16 v[26:27], v22 offset:29696
    ds_read_b64_tr_b16 v[28:29], v23 offset:28672
    ds_read_b64_tr_b16 v[30:31], v23 offset:29696
    v_lshlrev_b32 v84, 16, v6
    v_and_b32 v85, 0xffff0000, v6
    v_lshlrev_b32 v86, 16, v7
    v_and_b32 v87, 0xffff0000, v7
    v_mfma_f32_32x32x16_bf16 v[64:79], v[36:39], v[212:215], v[64:79]
    s_add_u32 s81, s75, s69
    buffer_load_dwordx4 v[244:247], v2, s[28:31], s81 offen offset:0 sc1
    s_waitcnt vmcnt(12) lgkmcnt(4)
    v_mfma_f32_32x32x16_bf16 v[48:63], v[40:43], v[216:219], v[48:63]
    ds_read_b64_tr_b16 v[32:33], v20 offset:0
    ds_read_b64_tr_b16 v[34:35], v20 offset:1024
    ds_read_b64_tr_b16 v[36:37], v21 offset:0
    ds_read_b64_tr_b16 v[38:39], v21 offset:1024
    v_lshlrev_b32 v88, 16, v8
    v_and_b32 v89, 0xffff0000, v8
    v_lshlrev_b32 v90, 16, v9
    v_and_b32 v91, 0xffff0000, v9
    s_branch L_pgo5
L_pg5:
    s_setpc_b64 s[58:59]
L_pgo5:
    v_mfma_f32_32x32x16_bf16 v[64:79], v[44:47], v[216:219], v[64:79]
    s_add_u32 s81, s75, s70
    buffer_load_dwordx4 v[248:251], v2, s[28:31], s81 offen offset:0 sc1
    s_waitcnt vmcnt(12) lgkmcnt(4)
    v_mfma_f32_32x32x16_bf16 v[48:63], v[24:27], v[220:223], v[48:63]
    v_subrev_u32 v22, 0x10000, v22
    v_subrev_u32 v23, 0x10000, v23
    ds_read_b64_tr_b16 v[40:41], v20 offset:4096
    ds_read_b64_tr_b16 v[42:43], v20 offset:5120
    ds_read_b64_tr_b16 v[44:45], v21 offset:4096
    ds_read_b64_tr_b16 v[46:47], v21 offset:5120
    v_lshlrev_b32 v92, 16, v10
    v_and_b32 v93, 0xffff0000, v10
    v_lshlrev_b32 v94, 16, v11
    v_and_b32 v95, 0xffff0000, v11
    v_mfma_f32_32x32x16_bf16 v[64:79], v[28:31], v[220:223], v[64:79]
    s_add_u32 s81, s75, s71
    buffer_load_dwordx4 v[252:255], v2, s[28:31], s81 offen offset:0 sc1
    s_waitcnt vmcnt(5)
    s_barrier
    s_barrier
    s_add_u32 s81, s75, s68
    buffer_load_dwordx4 v[124:127], v2, s[28:31], s81 offen offset:2048 sc1
    s_waitcnt vmcnt(11) lgkmcnt(4)
    v_mfma_f32_32x32x16_bf16 v[48:63], v[32:35], v[224:227], v[48:63]
    ds_read_b64_tr_b16 v[24:25], v20 offset:8192
    ds_read_b64_tr_b16 v[26:27], v20 offset:9216
    ds_read_b64_tr_b16 v[28:29], v21 offset:8192
    ds_read_b64_tr_b16 v[30:31], v21 offset:9216
    v_mfma_f32_32x32x16_bf16 v[64:79], v[36:39], v[224:227], v[64:79]
    s_add_u32 s81, s75, s72
    buffer_load_dwordx4 v[112:115], v2, s[28:31], s81 offen offset:0 sc1
    s_add_u32 s81, s75, s69
    buffer_load_dwordx4 v[128:131], v2, s[28:31], s81 offen offset:2048 sc1
    s_waitcnt vmcnt(12) lgkmcnt(4)
    v_mfma_f32_32x32x16_bf16 v[48:63], v[40:43], v[228:231], v[48:63]
    ds_read_b64_tr_b16 v[32:33], v20 offset:12288
    ds_read_b64_tr_b16 v[34:35], v20 offset:13312
    ds_read_b64_tr_b16 v[36:37], v21 offset:12288
    ds_read_b64_tr_b16 v[38:39], v21 offset:13312
    v_mfma_f32_32x32x16_bf16 v[64:79], v[44:47], v[228:231], v[64:79]
    s_add_u32 s81, s75, s73
    buffer_load_dwordx4 v[116:119], v2, s[28:31], s81 offen offset:0 sc1
    s_add_u32 s81, s75, s70
    buffer_load_dwordx4 v[132:135], v2, s[28:31], s81 offen offset:2048 sc1
    s_waitcnt vmcnt(13) lgkmcnt(4)
    v_mfma_f32_32x32x16_bf16 v[48:63], v[24:27], v[232:235], v[48:63]
    ds_read_b64_tr_b16 v[40:41], v20 offset:16384
    ds_read_b64_tr_b16 v[42:43], v20 offset:17408
    ds_read_b64_tr_b16 v[44:45], v21 offset:16384
    ds_read_b64_tr_b16 v[46:47], v21 offset:17408
    v_mfma_f32_32x32x16_bf16 v[64:79], v[28:31], v[232:235], v[64:79]
    s_add_u32 s81, s75, s74
    buffer_load_dwordx4 v[120:123], v2, s[28:31], s81 offen offset:0 sc1
    s_add_u32 s81, s75, s71
    buffer_load_dwordx4 v[136:139], v2, s[28:31], s81 offen offset:2048 sc1
    s_waitcnt vmcnt(14) lgkmcnt(4)
    v_mfma_f32_32x32x16_bf16 v[48:63], v[32:35], v[236:239], v[48:63]
    ds_read_b64_tr_b16 v[24:25], v20 offset:32768
    ds_read_b64_tr_b16 v[26:27], v20 offset:33792
    ds_read_b64_tr_b16 v[28:29], v21 offset:32768
    ds_read_b64_tr_b16 v[30:31], v21 offset:33792
    v_mfma_f32_32x32x16_bf16 v[64:79], v[36:39], v[236:239], v[64:79]
    s_add_u32 s81, s75, s72
    buffer_load_dwordx4 v[140:143], v2, s[28:31], s81 offen offset:2048 sc1
    s_waitcnt vmcnt(11) lgkmcnt(4)
    v_mfma_f32_32x32x16_bf16 v[80:95], v[40:43], v[240:243], v[80:95]
    ds_read_b64_tr_b16 v[32:33], v20 offset:49152
    ds_read_b64_tr_b16 v[34:35], v20 offset:50176
    ds_read_b64_tr_b16 v[36:37], v21 offset:49152
    ds_read_b64_tr_b16 v[38:39], v21 offset:50176
    v_mfma_f32_32x32x16_bf16 v[96:111], v[44:47], v[240:243], 0
    s_add_u32 s81, s75, s73
    buffer_load_dwordx4 v[144:147], v2, s[28:31], s81 offen offset:2048 sc1
    s_waitcnt vmcnt(11) lgkmcnt(4)
    v_mfma_f32_32x32x16_bf16 v[80:95], v[24:27], v[244:247], v[80:95]
    ds_read_b64_tr_b16 v[40:41], v22 offset:0
    ds_read_b64_tr_b16 v[42:43], v22 offset:1024
    ds_read_b64_tr_b16 v[44:45], v23 offset:0
    ds_read_b64_tr_b16 v[46:47], v23 offset:1024
    v_mfma_f32_32x32x16_bf16 v[96:111], v[28:31], v[244:247], v[96:111]
    s_add_u32 s81, s75, s74
    buffer_load_dwordx4 v[148:151], v2, s[28:31], s81 offen offset:2048 sc1
    s_mov_b32 s32, s22
    s_and_b32 s33, s23, 0xffff
    s_mov_b32 s34, 2097152
    s_mov_b32 s35, 0x20000
    s_waitcnt vmcnt(11) lgkmcnt(4)
    v_mfma_f32_32x32x16_bf16 v[80:95], v[32:35], v[248:251], v[80:95]
    ds_read_b64_tr_b16 v[24:25], v22 offset:16384
    ds_read_b64_tr_b16 v[26:27], v22 offset:17408
    ds_read_b64_tr_b16 v[28:29], v23 offset:16384
    ds_read_b64_tr_b16 v[30:31], v23 offset:17408
    v_mfma_f32_32x32x16_bf16 v[96:111], v[36:39], v[248:251], v[96:111]
    s_barrier
    s_add_u32 s81, s76, s68
    buffer_load_dwordx4 v[152:155], v2, s[28:31], s81 offen offset:0 sc1
    v_and_b32 v208, 31, v1
    v_lshlrev_b32 v208, 10, v208
    v_lshrrev_b32 v209, 5, v1
    v_lshl_add_u32 v208, v209, 4, v208
    s_waitcnt vmcnt(11) lgkmcnt(4)
    v_mfma_f32_32x32x16_bf16 v[80:95], v[40:43], v[252:255], v[80:95]
    ds_read_b64_tr_b16 v[32:33], v22 offset:32768
    ds_read_b64_tr_b16 v[34:35], v22 offset:33792
    ds_read_b64_tr_b16 v[36:37], v23 offset:32768
    ds_read_b64_tr_b16 v[38:39], v23 offset:33792
    v_mfma_f32_32x32x16_bf16 v[96:111], v[44:47], v[252:255], v[96:111]
    s_add_u32 s81, s76, s69
    buffer_load_dwordx4 v[156:159], v2, s[28:31], s81 offen offset:0 sc1
    s_lshl_b32 s58, s62, 6
    s_lshl_b32 s57, s63, 15
    s_add_u32 s58, s58, s57
    v_sub_f32 v13, 1.0, v12
    s_waitcnt vmcnt(10) lgkmcnt(4)
    v_mfma_f32_32x32x16_bf16 v[80:95], v[24:27], v[112:115], v[80:95]
    ds_read_b64_tr_b16 v[40:41], v22 offset:49152
    ds_read_b64_tr_b16 v[42:43], v22 offset:50176
    ds_read_b64_tr_b16 v[44:45], v23 offset:49152
    ds_read_b64_tr_b16 v[46:47], v23 offset:50176
    v_mfma_f32_32x32x16_bf16 v[96:111], v[28:31], v[112:115], v[96:111]
    s_add_u32 s81, s76, s70
    buffer_load_dwordx4 v[160:163], v2, s[28:31], s81 offen offset:0 sc1
    s_lshl_b32 s57, s45, 14
    s_add_u32 s57, s57, 65536
    v_add_u32 v210, s57, v2
    v_xor_b32 v211, 16384, v210
    s_waitcnt vmcnt(9) lgkmcnt(4)
    v_mfma_f32_32x32x16_bf16 v[80:95], v[32:35], v[116:119], v[80:95]
    ds_read_b64_tr_b16 v[24:25], v20 offset:20480
    ds_read_b64_tr_b16 v[26:27], v20 offset:21504
    ds_read_b64_tr_b16 v[28:29], v21 offset:20480
    ds_read_b64_tr_b16 v[30:31], v21 offset:21504
    v_mfma_f32_32x32x16_bf16 v[96:111], v[36:39], v[116:119], v[96:111]
    s_add_u32 s81, s76, s71
    buffer_load_dwordx4 v[164:167], v2, s[28:31], s81 offen offset:0 sc1
    s_lshl_b32 s57, s45, 12
    s_add_u32 s57, s57, 0
    v_add_u32 v212, s57, v2
    s_nop 0
    s_waitcnt vmcnt(8) lgkmcnt(4)
    v_mfma_f32_32x32x16_bf16 v[80:95], v[40:43], v[120:123], v[80:95]
    ds_read_b64_tr_b16 v[32:33], v20 offset:36864
    ds_read_b64_tr_b16 v[34:35], v20 offset:37888
    ds_read_b64_tr_b16 v[36:37], v21 offset:36864
    ds_read_b64_tr_b16 v[38:39], v21 offset:37888
    v_mfma_f32_32x32x16_bf16 v[96:111], v[44:47], v[120:123], v[96:111]
    s_add_u32 s81, s76, s72
    buffer_load_dwordx4 v[168:171], v2, s[28:31], s81 offen offset:0 sc1
    v_mul_f32 v48, v48, v12
    v_mul_f32 v49, v49, v12
    v_mul_f32 v50, v50, v12
    v_mul_f32 v51, v51, v12
    s_waitcnt vmcnt(14) lgkmcnt(4)
    v_mfma_f32_32x32x16_bf16 v[80:95], v[24:27], v[124:127], v[80:95]
    ds_read_b64_tr_b16 v[40:41], v20 offset:53248
    ds_read_b64_tr_b16 v[42:43], v20 offset:54272
    ds_read_b64_tr_b16 v[44:45], v21 offset:53248
    ds_read_b64_tr_b16 v[46:47], v21 offset:54272
    v_mfma_f32_32x32x16_bf16 v[96:111], v[28:31], v[124:127], v[96:111]
    s_add_u32 s81, s76, s73
    buffer_load_dwordx4 v[172:175], v2, s[28:31], s81 offen offset:0 sc1
    v_mul_f32 v52, v52, v12
    v_mul_f32 v53, v53, v12
    v_mul_f32 v54, v54, v12
    v_mul_f32 v55, v55, v12
    s_waitcnt vmcnt(13) lgkmcnt(4)
    v_mfma_f32_32x32x16_bf16 v[80:95], v[32:35], v[128:131], v[80:95]
    ds_read_b64_tr_b16 v[24:25], v22 offset:4096
    ds_read_b64_tr_b16 v[26:27], v22 offset:5120
    ds_read_b64_tr_b16 v[28:29], v23 offset:4096
    ds_read_b64_tr_b16 v[30:31], v23 offset:5120
    v_mfma_f32_32x32x16_bf16 v[96:111], v[36:39], v[128:131], v[96:111]
    s_add_u32 s81, s76, s74
    buffer_load_dwordx4 v[176:179], v2, s[28:31], s81 offen offset:0 sc1
    v_mul_f32 v56, v56, v12
    v_mul_f32 v57, v57, v12
    v_mul_f32 v58, v58, v12
    v_mul_f32 v59, v59, v12
    s_waitcnt vmcnt(12) lgkmcnt(4)
    v_mfma_f32_32x32x16_bf16 v[80:95], v[40:43], v[132:135], v[80:95]
    ds_read_b64_tr_b16 v[32:33], v22 offset:20480
    ds_read_b64_tr_b16 v[34:35], v22 offset:21504
    ds_read_b64_tr_b16 v[36:37], v23 offset:20480
    ds_read_b64_tr_b16 v[38:39], v23 offset:21504
    v_mfma_f32_32x32x16_bf16 v[96:111], v[44:47], v[132:135], v[96:111]
    s_barrier
    s_add_u32 s81, s76, s68
    buffer_load_dwordx4 v[180:183], v2, s[28:31], s81 offen offset:2048 sc1
    v_mul_f32 v60, v60, v12
    v_mul_f32 v61, v61, v12
    v_mul_f32 v62, v62, v12
    v_mul_f32 v63, v63, v12
    s_waitcnt vmcnt(11) lgkmcnt(4)
    v_mfma_f32_32x32x16_bf16 v[80:95], v[24:27], v[136:139], v[80:95]
    ds_read_b64_tr_b16 v[40:41], v22 offset:36864
    ds_read_b64_tr_b16 v[42:43], v22 offset:37888
    ds_read_b64_tr_b16 v[44:45], v23 offset:36864
    ds_read_b64_tr_b16 v[46:47], v23 offset:37888
    v_mfma_f32_32x32x16_bf16 v[96:111], v[28:31], v[136:139], v[96:111]
    s_add_u32 s81, s76, s69
    buffer_load_dwordx4 v[184:187], v2, s[28:31], s81 offen offset:2048 sc1
    v_mul_f32 v64, v64, v12
    v_mul_f32 v65, v65, v12
    v_mul_f32 v66, v66, v12
    v_mul_f32 v67, v67, v12
    s_waitcnt vmcnt(11) lgkmcnt(4)
    v_mfma_f32_32x32x16_bf16 v[80:95], v[32:35], v[140:143], v[80:95]
    ds_read_b64_tr_b16 v[24:25], v22 offset:53248
    ds_read_b64_tr_b16 v[26:27], v22 offset:54272
    ds_read_b64_tr_b16 v[28:29], v23 offset:53248
    ds_read_b64_tr_b16 v[30:31], v23 offset:54272
    v_mfma_f32_32x32x16_bf16 v[96:111], v[36:39], v[140:143], v[96:111]
    s_add_u32 s81, s76, s70
    buffer_load_dwordx4 v[188:191], v2, s[28:31], s81 offen offset:2048 sc1
    v_mul_f32 v68, v68, v12
    v_mul_f32 v69, v69, v12
    v_mul_f32 v70, v70, v12
    v_mul_f32 v71, v71, v12
    s_waitcnt vmcnt(11) lgkmcnt(4)
    v_mfma_f32_32x32x16_bf16 v[80:95], v[40:43], v[144:147], v[80:95]
    ds_read_b64_tr_b16 v[32:33], v20 offset:24576
    ds_read_b64_tr_b16 v[34:35], v20 offset:25600
    ds_read_b64_tr_b16 v[36:37], v21 offset:24576
    ds_read_b64_tr_b16 v[38:39], v21 offset:25600
    v_mfma_f32_32x32x16_bf16 v[96:111], v[44:47], v[144:147], v[96:111]
    s_add_u32 s81, s76, s71
    buffer_load_dwordx4 v[192:195], v2, s[28:31], s81 offen offset:2048 sc1
    v_mul_f32 v72, v72, v12
    v_mul_f32 v73, v73, v12
    v_mul_f32 v74, v74, v12
    v_mul_f32 v75, v75, v12
    s_waitcnt vmcnt(11) lgkmcnt(4)
    v_mfma_f32_32x32x16_bf16 v[80:95], v[24:27], v[148:151], v[80:95]
    ds_read_b64_tr_b16 v[40:41], v20 offset:40960
    ds_read_b64_tr_b16 v[42:43], v20 offset:41984
    ds_read_b64_tr_b16 v[44:45], v21 offset:40960
    ds_read_b64_tr_b16 v[46:47], v21 offset:41984
    v_mfma_f32_32x32x16_bf16 v[96:111], v[28:31], v[148:151], v[96:111]
    s_add_u32 s81, s76, s72
    buffer_load_dwordx4 v[196:199], v2, s[28:31], s81 offen offset:2048 sc1
    v_mul_f32 v76, v76, v12
    v_mul_f32 v77, v77, v12
    v_mul_f32 v78, v78, v12
    v_mul_f32 v79, v79, v12
    s_waitcnt vmcnt(11) lgkmcnt(4)
    v_mfma_f32_32x32x16_bf16 v[80:95], v[32:35], v[152:155], v[80:95]
    ds_read_b64_tr_b16 v[24:25], v20 offset:57344
    ds_read_b64_tr_b16 v[26:27], v20 offset:58368
    ds_read_b64_tr_b16 v[28:29], v21 offset:57344
    ds_read_b64_tr_b16 v[30:31], v21 offset:58368
    v_mfma_f32_32x32x16_bf16 v[96:111], v[36:39], v[152:155], v[96:111]
    s_add_u32 s81, s76, s73
    buffer_load_dwordx4 v[200:203], v2, s[28:31], s81 offen offset:2048 sc1
    s_waitcnt vmcnt(11) lgkmcnt(4)
    v_mfma_f32_32x32x16_bf16 v[80:95], v[40:43], v[156:159], v[80:95]
    ds_read_b64_tr_b16 v[32:33], v22 offset:8192
    ds_read_b64_tr_b16 v[34:35], v22 offset:9216
    ds_read_b64_tr_b16 v[36:37], v23 offset:8192
    ds_read_b64_tr_b16 v[38:39], v23 offset:9216
    v_mfma_f32_32x32x16_bf16 v[96:111], v[44:47], v[156:159], v[96:111]
    s_add_u32 s81, s76, s74
    buffer_load_dwordx4 v[204:207], v2, s[28:31], s81 offen offset:2048 sc1
    s_waitcnt vmcnt(11) lgkmcnt(4)
    v_mfma_f32_32x32x16_bf16 v[80:95], v[24:27], v[160:163], v[80:95]
    ds_read_b64_tr_b16 v[40:41], v22 offset:24576
    ds_read_b64_tr_b16 v[42:43], v22 offset:25600
    ds_read_b64_tr_b16 v[44:45], v23 offset:24576
    ds_read_b64_tr_b16 v[46:47], v23 offset:25600
    v_mfma_f32_32x32x16_bf16 v[96:111], v[28:31], v[160:163], v[96:111]
    s_add_u32 s81, s77, s68
    buffer_load_dwordx4 v[216:219], v2, s[28:31], s81 offen offset:0 sc1
    s_waitcnt vmcnt(11) lgkmcnt(4)
    v_mfma_f32_32x32x16_bf16 v[80:95], v[32:35], v[164:167], v[80:95]
    ds_read_b64_tr_b16 v[24:25], v22 offset:40960
    ds_read_b64_tr_b16 v[26:27], v22 offset:41984
    ds_read_b64_tr_b16 v[28:29], v23 offset:40960
    ds_read_b64_tr_b16 v[30:31], v23 offset:41984
    v_mfma_f32_32x32x16_bf16 v[96:111], v[36:39], v[164:167], v[96:111]
    s_add_u32 s81, s77, s69
    buffer_load_dwordx4 v[220:223], v2, s[28:31], s81 offen offset:0 sc1
    s_waitcnt vmcnt(11) lgkmcnt(4)
    v_mfma_f32_32x32x16_bf16 v[80:95], v[40:43], v[168:171], v[80:95]
    ds_read_b64_tr_b16 v[32:33], v22 offset:57344
    ds_read_b64_tr_b16 v[34:35], v22 offset:58368
    ds_read_b64_tr_b16 v[36:37], v23 offset:57344
    ds_read_b64_tr_b16 v[38:39], v23 offset:58368
    v_mfma_f32_32x32x16_bf16 v[96:111], v[44:47], v[168:171], v[96:111]
    s_add_u32 s81, s77, s70
    buffer_load_dwordx4 v[224:227], v2, s[28:31], s81 offen offset:0 sc1
    s_waitcnt vmcnt(11) lgkmcnt(4)
    v_mfma_f32_32x32x16_bf16 v[80:95], v[24:27], v[172:175], v[80:95]
    ds_read_b64_tr_b16 v[40:41], v20 offset:28672
    ds_read_b64_tr_b16 v[42:43], v20 offset:29696
    ds_read_b64_tr_b16 v[44:45], v21 offset:28672
    ds_read_b64_tr_b16 v[46:47], v21 offset:29696
    v_mfma_f32_32x32x16_bf16 v[96:111], v[28:31], v[172:175], v[96:111]
    s_add_u32 s81, s77, s71
    buffer_load_dwordx4 v[228:231], v2, s[28:31], s81 offen offset:0 sc1
    s_waitcnt vmcnt(11) lgkmcnt(4)
    v_mfma_f32_32x32x16_bf16 v[80:95], v[32:35], v[176:179], v[80:95]
    ds_read_b64_tr_b16 v[24:25], v20 offset:45056
    ds_read_b64_tr_b16 v[26:27], v20 offset:46080
    ds_read_b64_tr_b16 v[28:29], v21 offset:45056
    ds_read_b64_tr_b16 v[30:31], v21 offset:46080
    v_mfma_f32_32x32x16_bf16 v[96:111], v[36:39], v[176:179], v[96:111]
    s_add_u32 s81, s77, s72
    buffer_load_dwordx4 v[232:235], v2, s[28:31], s81 offen offset:0 sc1
    s_barrier
    s_waitcnt vmcnt(11) lgkmcnt(4)
    v_mfma_f32_32x32x16_bf16 v[80:95], v[40:43], v[180:183], v[80:95]
    ds_read_b64_tr_b16 v[32:33], v20 offset:61440
    ds_read_b64_tr_b16 v[34:35], v20 offset:62464
    ds_read_b64_tr_b16 v[36:37], v21 offset:61440
    ds_read_b64_tr_b16 v[38:39], v21 offset:62464
    v_mfma_f32_32x32x16_bf16 v[96:111], v[44:47], v[180:183], v[96:111]
    s_add_u32 s81, s77, s73
    buffer_load_dwordx4 v[236:239], v2, s[28:31], s81 offen offset:0 sc1
    s_waitcnt vmcnt(11) lgkmcnt(4)
    v_mfma_f32_32x32x16_bf16 v[80:95], v[24:27], v[184:187], v[80:95]
    ds_read_b64_tr_b16 v[40:41], v22 offset:12288
    ds_read_b64_tr_b16 v[42:43], v22 offset:13312
    ds_read_b64_tr_b16 v[44:45], v23 offset:12288
    ds_read_b64_tr_b16 v[46:47], v23 offset:13312
    v_mfma_f32_32x32x16_bf16 v[96:111], v[28:31], v[184:187], v[96:111]
    s_add_u32 s81, s77, s74
    buffer_load_dwordx4 v[240:243], v2, s[28:31], s81 offen offset:0 sc1
    s_waitcnt vmcnt(11) lgkmcnt(4)
    v_mfma_f32_32x32x16_bf16 v[80:95], v[32:35], v[188:191], v[80:95]
    ds_read_b64_tr_b16 v[24:25], v22 offset:28672
    ds_read_b64_tr_b16 v[26:27], v22 offset:29696
    ds_read_b64_tr_b16 v[28:29], v23 offset:28672
    ds_read_b64_tr_b16 v[30:31], v23 offset:29696
    v_mfma_f32_32x32x16_bf16 v[96:111], v[36:39], v[188:191], v[96:111]
    s_waitcnt vmcnt(10) lgkmcnt(4)
    v_mfma_f32_32x32x16_bf16 v[80:95], v[40:43], v[192:195], v[80:95]
    ds_read_b64_tr_b16 v[32:33], v22 offset:45056
    ds_read_b64_tr_b16 v[34:35], v22 offset:46080
    ds_read_b64_tr_b16 v[36:37], v23 offset:45056
    ds_read_b64_tr_b16 v[38:39], v23 offset:46080
    v_mfma_f32_32x32x16_bf16 v[96:111], v[44:47], v[192:195], v[96:111]
    s_waitcnt vmcnt(9) lgkmcnt(4)
    v_mfma_f32_32x32x16_bf16 v[80:95], v[24:27], v[196:199], v[80:95]
    ds_read_b64_tr_b16 v[40:41], v22 offset:61440
    ds_read_b64_tr_b16 v[42:43], v22 offset:62464
    ds_read_b64_tr_b16 v[44:45], v23 offset:61440
    ds_read_b64_tr_b16 v[46:47], v23 offset:62464
    v_mfma_f32_32x32x16_bf16 v[96:111], v[28:31], v[196:199], v[96:111]
    s_waitcnt vmcnt(8) lgkmcnt(4)
    v_mfma_f32_32x32x16_bf16 v[80:95], v[32:35], v[200:203], v[80:95]
    v_add_u32 v22, 0x10000, v22
    v_add_u32 v23, 0x10000, v23
    ds_read_b64_tr_b16 v[24:25], v22 offset:0
    ds_read_b64_tr_b16 v[26:27], v22 offset:1024
    ds_read_b64_tr_b16 v[28:29], v23 offset:0
    ds_read_b64_tr_b16 v[30:31], v23 offset:1024
    v_mfma_f32_32x32x16_bf16 v[96:111], v[36:39], v[200:203], v[96:111]
    s_waitcnt vmcnt(7) lgkmcnt(4)
    v_mfma_f32_32x32x16_bf16 v[80:95], v[40:43], v[204:207], v[80:95]
    ds_read_b64_tr_b16 v[32:33], v22 offset:4096
    ds_read_b64_tr_b16 v[34:35], v22 offset:5120
    ds_read_b64_tr_b16 v[36:37], v23 offset:4096
    ds_read_b64_tr_b16 v[38:39], v23 offset:5120
    v_mfma_f32_32x32x16_bf16 v[96:111], v[44:47], v[204:207], v[96:111]
    s_waitcnt vmcnt(6) lgkmcnt(4)
    v_mfma_f32_32x32x16_bf16 v[80:95], v[24:27], v[216:219], v[80:95]
    ds_read_b64_tr_b16 v[40:41], v22 offset:8192
    ds_read_b64_tr_b16 v[42:43], v22 offset:9216
    ds_read_b64_tr_b16 v[44:45], v23 offset:8192
    ds_read_b64_tr_b16 v[46:47], v23 offset:9216
    v_mfma_f32_32x32x16_bf16 v[96:111], v[28:31], v[216:219], v[96:111]
    s_waitcnt vmcnt(5) lgkmcnt(4)
    v_mfma_f32_32x32x16_bf16 v[80:95], v[32:35], v[220:223], v[80:95]
    ds_read_b64_tr_b16 v[24:25], v22 offset:12288
    ds_read_b64_tr_b16 v[26:27], v22 offset:13312
    ds_read_b64_tr_b16 v[28:29], v23 offset:12288
    ds_read_b64_tr_b16 v[30:31], v23 offset:13312
    v_mfma_f32_32x32x16_bf16 v[96:111], v[36:39], v[220:223], v[96:111]
    s_waitcnt vmcnt(4) lgkmcnt(4)
    v_mfma_f32_32x32x16_bf16 v[80:95], v[40:43], v[224:227], v[80:95]
    ds_read_b64_tr_b16 v[32:33], v22 offset:16384
    ds_read_b64_tr_b16 v[34:35], v22 offset:17408
    ds_read_b64_tr_b16 v[36:37], v23 offset:16384
    ds_read_b64_tr_b16 v[38:39], v23 offset:17408
    v_mfma_f32_32x32x16_bf16 v[96:111], v[44:47], v[224:227], v[96:111]
    s_waitcnt vmcnt(3) lgkmcnt(4)
    v_mfma_f32_32x32x16_bf16 v[80:95], v[24:27], v[228:231], v[80:95]
    ds_read_b64_tr_b16 v[40:41], v22 offset:20480
    ds_read_b64_tr_b16 v[42:43], v22 offset:21504
    ds_read_b64_tr_b16 v[44:45], v23 offset:20480
    ds_read_b64_tr_b16 v[46:47], v23 offset:21504
    v_mfma_f32_32x32x16_bf16 v[96:111], v[28:31], v[228:231], v[96:111]
    s_waitcnt vmcnt(2) lgkmcnt(4)
    v_mfma_f32_32x32x16_bf16 v[80:95], v[32:35], v[232:235], v[80:95]
    ds_read_b64_tr_b16 v[24:25], v22 offset:24576
    ds_read_b64_tr_b16 v[26:27], v22 offset:25600
    ds_read_b64_tr_b16 v[28:29], v23 offset:24576
    ds_read_b64_tr_b16 v[30:31], v23 offset:25600
    v_mfma_f32_32x32x16_bf16 v[96:111], v[36:39], v[232:235], v[96:111]
    s_waitcnt vmcnt(1) lgkmcnt(4)
    v_mfma_f32_32x32x16_bf16 v[80:95], v[40:43], v[236:239], v[80:95]
    v_mfma_f32_32x32x16_bf16 v[96:111], v[44:47], v[236:239], v[96:111]
    s_waitcnt vmcnt(0) lgkmcnt(0)
    v_mfma_f32_32x32x16_bf16 v[80:95], v[24:27], v[240:243], v[80:95]
    v_mfma_f32_32x32x16_bf16 v[96:111], v[28:31], v[240:243], v[96:111]
    s_nop 11
    v_pk_fma_f32 v[64:65], v[96:97], v[12:13], v[64:65] op_sel:[0,1,0] op_sel_hi:[1,1,1]
    v_pk_fma_f32 v[66:67], v[98:99], v[12:13], v[66:67] op_sel:[0,1,0] op_sel_hi:[1,1,1]
    v_pk_fma_f32 v[68:69], v[100:101], v[12:13], v[68:69] op_sel:[0,1,0] op_sel_hi:[1,1,1]
    v_pk_fma_f32 v[70:71], v[102:103], v[12:13], v[70:71] op_sel:[0,1,0] op_sel_hi:[1,1,1]
    v_pk_fma_f32 v[72:73], v[104:105], v[12:13], v[72:73] op_sel:[0,1,0] op_sel_hi:[1,1,1]
    v_pk_fma_f32 v[74:75], v[106:107], v[12:13], v[74:75] op_sel:[0,1,0] op_sel_hi:[1,1,1]
    v_pk_fma_f32 v[76:77], v[108:109], v[12:13], v[76:77] op_sel:[0,1,0] op_sel_hi:[1,1,1]
    v_pk_fma_f32 v[78:79], v[110:111], v[12:13], v[78:79] op_sel:[0,1,0] op_sel_hi:[1,1,1]
    ds_write_b128 v210, v[64:67] offset:0
    ds_write_b128 v210, v[68:71] offset:1024
    ds_write_b128 v210, v[72:75] offset:2048
    ds_write_b128 v210, v[76:79] offset:3072
    v_pk_fma_f32 v[48:49], v[80:81], v[12:13], v[48:49] op_sel:[0,1,0] op_sel_hi:[1,1,1]
    v_pk_fma_f32 v[50:51], v[82:83], v[12:13], v[50:51] op_sel:[0,1,0] op_sel_hi:[1,1,1]
    v_pk_fma_f32 v[52:53], v[84:85], v[12:13], v[52:53] op_sel:[0,1,0] op_sel_hi:[1,1,1]
    v_pk_fma_f32 v[54:55], v[86:87], v[12:13], v[54:55] op_sel:[0,1,0] op_sel_hi:[1,1,1]
    v_pk_fma_f32 v[56:57], v[88:89], v[12:13], v[56:57] op_sel:[0,1,0] op_sel_hi:[1,1,1]
    v_pk_fma_f32 v[58:59], v[90:91], v[12:13], v[58:59] op_sel:[0,1,0] op_sel_hi:[1,1,1]
    v_pk_fma_f32 v[60:61], v[92:93], v[12:13], v[60:61] op_sel:[0,1,0] op_sel_hi:[1,1,1]
    v_pk_fma_f32 v[62:63], v[94:95], v[12:13], v[62:63] op_sel:[0,1,0] op_sel_hi:[1,1,1]
    s_waitcnt lgkmcnt(0)
    s_barrier
    ds_read_b128 v[80:83], v211 offset:0
    ds_read_b128 v[96:99], v212 offset:0
    ds_read_b128 v[84:87], v211 offset:1024
    ds_read_b128 v[100:103], v212 offset:1024
    ds_read_b128 v[88:91], v211 offset:2048
    ds_read_b128 v[104:107], v212 offset:2048
    ds_read_b128 v[92:95], v211 offset:3072
    ds_read_b128 v[108:111], v212 offset:3072
    s_waitcnt lgkmcnt(6)
    v_pk_add_f32 v[48:49], v[48:49], v[80:81]
    v_pk_add_f32 v[50:51], v[50:51], v[82:83]
    v_pk_add_f32 v[48:49], v[48:49], v[96:97]
    v_pk_add_f32 v[50:51], v[50:51], v[98:99]
    s_waitcnt lgkmcnt(4)
    v_pk_add_f32 v[52:53], v[52:53], v[84:85]
    v_pk_add_f32 v[54:55], v[54:55], v[86:87]
    v_pk_add_f32 v[52:53], v[52:53], v[100:101]
    v_pk_add_f32 v[54:55], v[54:55], v[102:103]
    s_waitcnt lgkmcnt(2)
    v_pk_add_f32 v[56:57], v[56:57], v[88:89]
    v_pk_add_f32 v[58:59], v[58:59], v[90:91]
    v_pk_add_f32 v[56:57], v[56:57], v[104:105]
    v_pk_add_f32 v[58:59], v[58:59], v[106:107]
    s_waitcnt lgkmcnt(0)
    v_pk_add_f32 v[60:61], v[60:61], v[92:93]
    v_pk_add_f32 v[62:63], v[62:63], v[94:95]
    v_pk_add_f32 v[60:61], v[60:61], v[108:109]
    v_pk_add_f32 v[62:63], v[62:63], v[110:111]
    v_cvt_pk_bf16_f32 v4, v48, v49
    v_cvt_pk_bf16_f32 v5, v50, v51
    v_cvt_pk_bf16_f32 v6, v52, v53
    v_cvt_pk_bf16_f32 v7, v54, v55
    v_cvt_pk_bf16_f32 v8, v56, v57
    v_cvt_pk_bf16_f32 v9, v58, v59
    v_cvt_pk_bf16_f32 v10, v60, v61
    v_cvt_pk_bf16_f32 v11, v62, v63
    s_nop 1
    v_permlane32_swap_b32 v4, v6
    v_permlane32_swap_b32 v5, v7
    v_permlane32_swap_b32 v8, v10
    v_permlane32_swap_b32 v9, v11
    buffer_store_dwordx4 v[4:7], v208, s[32:35], s58 offen
    buffer_store_dwordx4 v[8:11], v208, s[32:35], s58 offen offset:32
    s_branch L_fin_4
L_lfar_5:
    s_add_u32 s28, s26, 0
    s_addc_u32 s29, s27, 0
    s_and_b32 s29, s29, 0xffff
    s_mov_b32 s30, 268435456
    s_mov_b32 s31, 0x20000
    s_add_u32 s26, s26, 13107200
    s_addc_u32 s27, s27, 0
    v_lshrrev_b32 v32, 3, v1
    v_mul_u32_u24 v28, 3072, v32
    v_bfe_u32 v32, v1, 4, 1
    v_lshlrev_b32 v32, 2, v32
    v_and_b32 v33, 7, v1
    v_xor_b32 v32, v32, v33
    v_lshl_add_u32 v28, v32, 4, v28
    v_add_u32 v29, 23552, v28
    v_add_u32 v30, 47104, v28
    v_add_u32 v31, 70656, v28
    s_bfe_u32 s20, s48, 0x10002
    s_lshl_b32 s20, s20, 11
    s_add_u32 s20, s20, s63
    v_lshrrev_b32 v32, 3, v1
    v_mul_u32_u24 v4, 1024, v32
    v_bfe_u32 v32, v1, 4, 1
    v_lshlrev_b32 v32, 2, v32
    v_and_b32 v33, 7, v1
    v_xor_b32 v32, v32, v33
    v_lshl_add_u32 v4, v32, 4, v4
    v_add_u32 v5, 7168, v4
    s_bfe_u32 s57, s20, 0x1000b
    s_mul_i32 s57, s57, 16384
    s_sub_u32 s58, 16384, s57
    v_add_u32 v6, s58, v4
    v_add_u32 v7, s58, v5
    v_add_u32 v4, s57, v4
    v_add_u32 v5, s57, v5
    s_lshl_b32 s57, s49, 7
    s_lshl_b32 s69, s45, 15
    s_add_u32 s69, s69, s57
    s_mul_i32 s66, s45, 98304
    s_add_u32 s66, s66, s57
    s_bitcmp1_b32 s48, 0
    s_cselect_b32 s57, 1, 2
    s_lshl_b32 s57, s57, 10
    s_add_u32 s66, s66, s57
    s_lshr_b32 s70, s48, 1
    s_lshl_b32 s70, s70, 3
    s_add_u32 s70, s70, s49
    s_mov_b32 s60, 1
    s_mov_b32 s40, s24
    s_and_b32 s41, s25, 0xffff
    s_mov_b32 s42, 256
    s_mov_b32 s43, 0x20000
    v_mov_b32 v18, 0
    v_mov_b32 v17, 1
    v_add_u32 v60, s63, v2
    v_mov_b32 v56, 0
    v_mov_b32 v57, 0
    v_mov_b32 v58, 0
    v_mov_b32 v59, 0
    s_bitcmp1_b32 s48, 0
    s_cbranch_scc1 L_mid1_6
    s_waitcnt vmcnt(4)
    s_barrier
    ds_read_b128 v[64:67], v60 offset:0
    ds_read_b128 v[68:71], v60 offset:1024
    ds_read_b128 v[72:75], v60 offset:2048
    ds_read_b128 v[76:79], v60 offset:3072
    s_add_u32 m0, s63, 49152
    s_add_u32 s57, s54, 1
    s_and_b32 s57, s57, 3
    s_lshl_b32 s56, s57, 8
    s_add_u32 s56, s56, s64
    buffer_load_dwordx4 v24, s[32:35], s56 offen offset:0  lds
    s_waitcnt lgkmcnt(0)
    v_lshlrev_b32 v36, 16, v64
    v_and_b32 v64, 0xffff0000, v64
    v_lshlrev_b32 v37, 16, v68
    v_and_b32 v68, 0xffff0000, v68
    v_lshlrev_b32 v38, 16, v72
    buffer_load_dwordx4 v25, s[32:35], s56 offen offset:1024  lds
    v_and_b32 v72, 0xffff0000, v72
    v_lshlrev_b32 v39, 16, v76
    v_and_b32 v76, 0xffff0000, v76
    v_fmac_f32 v56, v36, v36
    v_fmac_f32 v57, v37, v37
    v_fmac_f32 v58, v38, v38
    buffer_load_dwordx4 v26, s[32:35], s56 offen offset:2048  lds
    v_fmac_f32 v59, v39, v39
    v_fmac_f32 v56, v64, v64
    v_fmac_f32 v57, v68, v68
    v_fmac_f32 v58, v72, v72
    v_fmac_f32 v59, v76, v76
    v_lshlrev_b32 v36, 16, v65
    buffer_load_dwordx4 v27, s[32:35], s56 offen offset:3072  lds
    v_and_b32 v65, 0xffff0000, v65
    v_lshlrev_b32 v37, 16, v69
    v_and_b32 v69, 0xffff0000, v69
    v_lshlrev_b32 v38, 16, v73
    v_and_b32 v73, 0xffff0000, v73
    v_lshlrev_b32 v39, 16, v77
    s_add_u32 m0, s63, 81920
    s_add_u32 s57, s54, 1
    s_and_b32 s57, s57, 3
    s_mul_i32 s56, s57, s67
    s_add_u32 s56, s56, s65
    buffer_load_dwordx4 v40, s[36:39], s56 offen offset:0  lds
    v_and_b32 v77, 0xffff0000, v77
    v_fmac_f32 v56, v36, v36
    v_fmac_f32 v57, v37, v37
    v_fmac_f32 v58, v38, v38
    v_fmac_f32 v59, v39, v39
    v_fmac_f32 v56, v65, v65
    buffer_load_dwordx4 v41, s[36:39], s56 offen offset:1024  lds
    v_fmac_f32 v57, v69, v69
    v_fmac_f32 v58, v73, v73
    v_fmac_f32 v59, v77, v77
    s_waitcnt vmcnt(6)
    s_barrier
    buffer_load_dwordx4 v42, s[36:39], s56 offen offset:2048  lds
    v_lshlrev_b32 v36, 16, v66
    v_and_b32 v66, 0xffff0000, v66
    v_lshlrev_b32 v37, 16, v70
    v_and_b32 v70, 0xffff0000, v70
    buffer_load_dwordx4 v43, s[36:39], s56 offen offset:3072  lds
    v_lshlrev_b32 v38, 16, v74
    v_and_b32 v74, 0xffff0000, v74
    v_lshlrev_b32 v39, 16, v78
    v_and_b32 v78, 0xffff0000, v78
    s_add_u32 m0, s63, 65536
    s_add_u32 s57, s54, 1
    s_and_b32 s57, s57, 3
    s_lshl_b32 s56, s57, 8
    s_add_u32 s56, s56, s64
    s_xor_b32 s56, s56, 128
    buffer_load_dwordx4 v24, s[32:35], s56 offen offset:0  lds
    v_fmac_f32 v56, v36, v36
    v_fmac_f32 v57, v37, v37
    v_fmac_f32 v58, v38, v38
    v_fmac_f32 v59, v39, v39
    buffer_load_dwordx4 v25, s[32:35], s56 offen offset:1024  lds
    v_fmac_f32 v56, v66, v66
    v_fmac_f32 v57, v70, v70
    v_fmac_f32 v58, v74, v74
    v_fmac_f32 v59, v78, v78
    buffer_load_dwordx4 v26, s[32:35], s56 offen offset:2048  lds
    v_lshlrev_b32 v36, 16, v67
    v_and_b32 v67, 0xffff0000, v67
    v_lshlrev_b32 v37, 16, v71
    v_and_b32 v71, 0xffff0000, v71
    buffer_load_dwordx4 v27, s[32:35], s56 offen offset:3072  lds
    v_lshlrev_b32 v38, 16, v75
    v_and_b32 v75, 0xffff0000, v75
    v_lshlrev_b32 v39, 16, v79
    v_and_b32 v79, 0xffff0000, v79
    s_add_u32 m0, s63, 98304
    s_add_u32 s57, s54, 2
    s_and_b32 s57, s57, 3
    s_lshl_b32 s56, s57, 8
    s_branch L_pgo6
L_pg6:
    s_setpc_b64 s[58:59]
L_pgo6:
    s_add_u32 s56, s56, s64
    buffer_load_dwordx4 v24, s[32:35], s56 offen offset:0  lds
    v_fmac_f32 v56, v36, v36
    v_fmac_f32 v57, v37, v37
    v_fmac_f32 v58, v38, v38
    v_fmac_f32 v59, v39, v39
    buffer_load_dwordx4 v25, s[32:35], s56 offen offset:1024  lds
    v_fmac_f32 v56, v67, v67
    v_fmac_f32 v57, v71, v71
    v_fmac_f32 v58, v75, v75
    v_fmac_f32 v59, v79, v79
    s_waitcnt vmcnt(6)
    s_barrier
    v_add_u32 v60, 49152, v60
    ds_read_b128 v[64:67], v60 offset:0
    ds_read_b128 v[68:71], v60 offset:1024
    ds_read_b128 v[72:75], v60 offset:2048
    ds_read_b128 v[76:79], v60 offset:3072
    buffer_load_dwordx4 v26, s[32:35], s56 offen offset:2048  lds
    s_waitcnt lgkmcnt(0)
    v_lshlrev_b32 v36, 16, v64
    v_and_b32 v64, 0xffff0000, v64
    v_lshlrev_b32 v37, 16, v68
    v_and_b32 v68, 0xffff0000, v68
    v_lshlrev_b32 v38, 16, v72
    v_and_b32 v72, 0xffff0000, v72
    v_lshlrev_b32 v39, 16, v76
    v_and_b32 v76, 0xffff0000, v76
    buffer_load_dwordx4 v27, s[32:35], s56 offen offset:3072  lds
    v_fmac_f32 v56, v36, v36
    v_fmac_f32 v57, v37, v37
    v_fmac_f32 v58, v38, v38
    v_fmac_f32 v59, v39, v39
    v_fmac_f32 v56, v64, v64
    v_fmac_f32 v57, v68, v68
    v_fmac_f32 v58, v72, v72
    v_fmac_f32 v59, v76, v76
    v_lshlrev_b32 v36, 16, v65
    s_add_u32 m0, s63, 131072
    s_add_u32 s57, s54, 2
    s_and_b32 s57, s57, 3
    s_mul_i32 s56, s57, s67
    s_add_u32 s56, s56, s65
    buffer_load_dwordx4 v40, s[36:39], s56 offen offset:0  lds
    v_and_b32 v65, 0xffff0000, v65
    v_lshlrev_b32 v37, 16, v69
    v_and_b32 v69, 0xffff0000, v69
    v_lshlrev_b32 v38, 16, v73
    v_and_b32 v73, 0xffff0000, v73
    v_lshlrev_b32 v39, 16, v77
    v_and_b32 v77, 0xffff0000, v77
    v_fmac_f32 v56, v36, v36
    v_fmac_f32 v57, v37, v37
    buffer_load_dwordx4 v41, s[36:39], s56 offen offset:1024  lds
    v_fmac_f32 v58, v38, v38
    v_fmac_f32 v59, v39, v39
    v_fmac_f32 v56, v65, v65
    v_fmac_f32 v57, v69, v69
    v_fmac_f32 v58, v73, v73
    v_fmac_f32 v59, v77, v77
    s_waitcnt vmcnt(6)
    s_barrier
    buffer_load_dwordx4 v42, s[36:39], s56 offen offset:2048  lds
    v_lshlrev_b32 v36, 16, v66
    v_and_b32 v66, 0xffff0000, v66
    v_lshlrev_b32 v37, 16, v70
    v_and_b32 v70, 0xffff0000, v70
    buffer_load_dwordx4 v43, s[36:39], s56 offen offset:3072  lds
    v_lshlrev_b32 v38, 16, v74
    v_and_b32 v74, 0xffff0000, v74
    v_lshlrev_b32 v39, 16, v78
    v_and_b32 v78, 0xffff0000, v78
    s_add_u32 m0, s63, 114688
    s_add_u32 s57, s54, 2
    s_and_b32 s57, s57, 3
    s_lshl_b32 s56, s57, 8
    s_add_u32 s56, s56, s64
    s_xor_b32 s56, s56, 128
    buffer_load_dwordx4 v24, s[32:35], s56 offen offset:0  lds
    v_fmac_f32 v56, v36, v36
    v_fmac_f32 v57, v37, v37
    v_fmac_f32 v58, v38, v38
    v_fmac_f32 v59, v39, v39
    buffer_load_dwordx4 v25, s[32:35], s56 offen offset:1024  lds
    v_fmac_f32 v56, v66, v66
    v_fmac_f32 v57, v70, v70
    v_fmac_f32 v58, v74, v74
    v_fmac_f32 v59, v78, v78
    buffer_load_dwordx4 v26, s[32:35], s56 offen offset:2048  lds
    v_lshlrev_b32 v36, 16, v67
    v_and_b32 v67, 0xffff0000, v67
    v_lshlrev_b32 v37, 16, v71
    v_and_b32 v71, 0xffff0000, v71
    buffer_load_dwordx4 v27, s[32:35], s56 offen offset:3072  lds
    v_lshlrev_b32 v38, 16, v75
    v_and_b32 v75, 0xffff0000, v75
    v_lshlrev_b32 v39, 16, v79
    v_and_b32 v79, 0xffff0000, v79
    s_add_u32 m0, s63, 0
    s_add_u32 s57, s54, 3
    s_and_b32 s57, s57, 3
    s_lshl_b32 s56, s57, 8
    s_add_u32 s56, s56, s64
    buffer_load_dwordx4 v24, s[32:35], s56 offen offset:0  lds
    v_fmac_f32 v56, v36, v36
    v_fmac_f32 v57, v37, v37
    v_fmac_f32 v58, v38, v38
    v_fmac_f32 v59, v39, v39
    buffer_load_dwordx4 v25, s[32:35], s56 offen offset:1024  lds
    v_fmac_f32 v56, v67, v67
    v_fmac_f32 v57, v71, v71
    v_fmac_f32 v58, v75, v75
    v_fmac_f32 v59, v79, v79
    s_waitcnt vmcnt(6)
    s_barrier
    v_add_u32 v60, 49152, v60
    ds_read_b128 v[64:67], v60 offset:0
    ds_read_b128 v[68:71], v60 offset:1024
    ds_read_b128 v[72:75], v60 offset:2048
    ds_read_b128 v[76:79], v60 offset:3072
    buffer_load_dwordx4 v26, s[32:35], s56 offen offset:2048  lds
    s_waitcnt lgkmcnt(0)
    v_lshlrev_b32 v36, 16, v64
    v_and_b32 v64, 0xffff0000, v64
    v_lshlrev_b32 v37, 16, v68
    v_and_b32 v68, 0xffff0000, v68
    v_lshlrev_b32 v38, 16, v72
    v_and_b32 v72, 0xffff0000, v72
    v_lshlrev_b32 v39, 16, v76
    v_and_b32 v76, 0xffff0000, v76
    buffer_load_dwordx4 v27, s[32:35], s56 offen offset:3072  lds
    v_fmac_f32 v56, v36, v36
    v_fmac_f32 v57, v37, v37
    v_fmac_f32 v58, v38, v38
    v_fmac_f32 v59, v39, v39
    v_fmac_f32 v56, v64, v64
    v_fmac_f32 v57, v68, v68
    v_fmac_f32 v58, v72, v72
    v_fmac_f32 v59, v76, v76
    v_lshlrev_b32 v36, 16, v65
    s_add_u32 m0, s63, 32768
    s_add_u32 s57, s54, 3
    s_and_b32 s57, s57, 3
    s_mul_i32 s56, s57, s67
    s_add_u32 s56, s56, s65
    buffer_load_dwordx4 v40, s[36:39], s56 offen offset:0  lds
    v_and_b32 v65, 0xffff0000, v65
    v_lshlrev_b32 v37, 16, v69
    v_and_b32 v69, 0xffff0000, v69
    v_lshlrev_b32 v38, 16, v73
    v_and_b32 v73, 0xffff0000, v73
    v_lshlrev_b32 v39, 16, v77
    v_and_b32 v77, 0xffff0000, v77
    v_fmac_f32 v56, v36, v36
    v_fmac_f32 v57, v37, v37
    buffer_load_dwordx4 v41, s[36:39], s56 offen offset:1024  lds
    v_fmac_f32 v58, v38, v38
    v_fmac_f32 v59, v39, v39
    v_fmac_f32 v56, v65, v65
    v_fmac_f32 v57, v69, v69
    v_fmac_f32 v58, v73, v73
    v_fmac_f32 v59, v77, v77
    s_waitcnt vmcnt(6)
    s_barrier
    s_cmp_eq_u32 s44, 4
    s_cbranch_scc0 L_ow_8
    s_mov_b64 exec, 1
    buffer_load_dword v17, v18, s[40:43], 0 offen sc1
    s_mov_b64 exec, -1
L_ow_8:
    buffer_load_dwordx4 v42, s[36:39], s56 offen offset:2048  lds
    v_lshlrev_b32 v36, 16, v66
    v_and_b32 v66, 0xffff0000, v66
    v_lshlrev_b32 v37, 16, v70
    v_and_b32 v70, 0xffff0000, v70
    buffer_load_dwordx4 v43, s[36:39], s56 offen offset:3072  lds
    v_lshlrev_b32 v38, 16, v74
    v_and_b32 v74, 0xffff0000, v74
    v_lshlrev_b32 v39, 16, v78
    v_and_b32 v78, 0xffff0000, v78
    s_add_u32 m0, s63, 16384
    s_add_u32 s57, s54, 3
    s_and_b32 s57, s57, 3
    s_lshl_b32 s56, s57, 8
    s_add_u32 s56, s56, s64
    s_xor_b32 s56, s56, 128
    buffer_load_dwordx4 v24, s[32:35], s56 offen offset:0  lds
    v_fmac_f32 v56, v36, v36
    v_fmac_f32 v57, v37, v37
    v_fmac_f32 v58, v38, v38
    v_fmac_f32 v59, v39, v39
    buffer_load_dwordx4 v25, s[32:35], s56 offen offset:1024  lds
    v_fmac_f32 v56, v66, v66
    v_fmac_f32 v57, v70, v70
    v_fmac_f32 v58, v74, v74
    v_fmac_f32 v59, v78, v78
    buffer_load_dwordx4 v26, s[32:35], s56 offen offset:2048  lds
    v_lshlrev_b32 v36, 16, v67
    v_and_b32 v67, 0xffff0000, v67
    v_lshlrev_b32 v37, 16, v71
    v_and_b32 v71, 0xffff0000, v71
    buffer_load_dwordx4 v27, s[32:35], s56 offen offset:3072  lds
    v_lshlrev_b32 v38, 16, v75
    v_and_b32 v75, 0xffff0000, v75
    v_lshlrev_b32 v39, 16, v79
    v_and_b32 v79, 0xffff0000, v79
    s_mov_b32 s32, s6
    s_and_b32 s33, s7, 0xffff
    s_mov_b32 s34, 1572864
    s_mov_b32 s35, 0x20000
    s_add_u32 m0, s63, 81920
    s_add_u32 s57, s54, 0
    s_and_b32 s57, s57, 3
    s_mul_i32 s56, s57, 393216
    s_add_u32 s56, s56, s66
    buffer_load_dwordx4 v28, s[32:35], s56 offen offset:0  lds
    v_fmac_f32 v56, v36, v36
    v_fmac_f32 v57, v37, v37
    v_fmac_f32 v58, v38, v38
    v_fmac_f32 v59, v39, v39
    buffer_load_dwordx4 v29, s[32:35], s56 offen offset:1024  lds
    v_fmac_f32 v56, v67, v67
    v_fmac_f32 v57, v71, v71
    v_fmac_f32 v58, v75, v75
    v_fmac_f32 v59, v79, v79
    s_waitcnt vmcnt(6)
    s_barrier
    v_subrev_u32 v60, 98304, v60
    ds_read_b128 v[64:67], v60 offset:0
    ds_read_b128 v[68:71], v60 offset:1024
    ds_read_b128 v[72:75], v60 offset:2048
    ds_read_b128 v[76:79], v60 offset:3072
    buffer_load_dwordx4 v30, s[32:35], s56 offen offset:2048  lds
    s_waitcnt lgkmcnt(0)
    v_lshlrev_b32 v36, 16, v64
    v_and_b32 v64, 0xffff0000, v64
    v_lshlrev_b32 v37, 16, v68
    v_and_b32 v68, 0xffff0000, v68
    v_lshlrev_b32 v38, 16, v72
    v_and_b32 v72, 0xffff0000, v72
    v_lshlrev_b32 v39, 16, v76
    v_and_b32 v76, 0xffff0000, v76
    buffer_load_dwordx4 v31, s[32:35], s56 offen offset:3072  lds
    v_fmac_f32 v56, v36, v36
    v_fmac_f32 v57, v37, v37
    v_fmac_f32 v58, v38, v38
    v_fmac_f32 v59, v39, v39
    v_fmac_f32 v56, v64, v64
    v_fmac_f32 v57, v68, v68
    v_fmac_f32 v58, v72, v72
    v_fmac_f32 v59, v76, v76
    v_lshlrev_b32 v36, 16, v65
    s_add_u32 m0, s63, 98304
    s_add_u32 s57, s54, 1
    s_and_b32 s57, s57, 3
    s_mul_i32 s56, s57, 393216
    s_add_u32 s56, s56, s66
    buffer_load_dwordx4 v28, s[32:35], s56 offen offset:0  lds
    v_and_b32 v65, 0xffff0000, v65
    v_lshlrev_b32 v37, 16, v69
    v_and_b32 v69, 0xffff0000, v69
    v_lshlrev_b32 v38, 16, v73
    v_and_b32 v73, 0xffff0000, v73
    v_lshlrev_b32 v39, 16, v77
    v_and_b32 v77, 0xffff0000, v77
    v_fmac_f32 v56, v36, v36
    v_fmac_f32 v57, v37, v37
    buffer_load_dwordx4 v29, s[32:35], s56 offen offset:1024  lds
    v_fmac_f32 v58, v38, v38
    v_fmac_f32 v59, v39, v39
    v_fmac_f32 v56, v65, v65
    v_fmac_f32 v57, v69, v69
    v_fmac_f32 v58, v73, v73
    v_fmac_f32 v59, v77, v77
    s_waitcnt vmcnt(6)
    s_barrier
    buffer_load_dwordx4 v30, s[32:35], s56 offen offset:2048  lds
    v_lshlrev_b32 v36, 16, v66
    v_and_b32 v66, 0xffff0000, v66
    v_lshlrev_b32 v37, 16, v70
    v_and_b32 v70, 0xffff0000, v70
    v_lshlrev_b32 v38, 16, v74
    v_and_b32 v74, 0xffff0000, v74
    v_lshlrev_b32 v39, 16, v78
    v_and_b32 v78, 0xffff0000, v78
    v_fmac_f32 v56, v36, v36
    buffer_load_dwordx4 v31, s[32:35], s56 offen offset:3072  lds
    v_fmac_f32 v57, v37, v37
    v_fmac_f32 v58, v38, v38
    v_fmac_f32 v59, v39, v39
    v_fmac_f32 v56, v66, v66
    v_fmac_f32 v57, v70, v70
    v_fmac_f32 v58, v74, v74
    v_fmac_f32 v59, v78, v78
    v_lshlrev_b32 v36, 16, v67
    v_and_b32 v67, 0xffff0000, v67
    s_add_u32 m0, s63, 114688
    s_add_u32 s57, s54, 2
    s_and_b32 s57, s57, 3
    s_mul_i32 s56, s57, 393216
    s_add_u32 s56, s56, s66
    buffer_load_dwordx4 v28, s[32:35], s56 offen offset:0  lds
    v_lshlrev_b32 v37, 16, v71
    v_and_b32 v71, 0xffff0000, v71
    v_lshlrev_b32 v38, 16, v75
    v_and_b32 v75, 0xffff0000, v75
    v_lshlrev_b32 v39, 16, v79
    v_and_b32 v79, 0xffff0000, v79
    v_fmac_f32 v56, v36, v36
    v_fmac_f32 v57, v37, v37
    v_fmac_f32 v58, v38, v38
    buffer_load_dwordx4 v29, s[32:35], s56 offen offset:1024  lds
    v_fmac_f32 v59, v39, v39
    v_fmac_f32 v56, v67, v67
    v_fmac_f32 v57, v71, v71
    v_fmac_f32 v58, v75, v75
    v_fmac_f32 v59, v79, v79
    v_add_f32_dpp v56, v56, v56 quad_perm:[1,0,3,2] row_mask:0xf bank_mask:0xf
    v_add_f32_dpp v57, v57, v57 quad_perm:[1,0,3,2] row_mask:0xf bank_mask:0xf
    v_add_f32_dpp v58, v58, v58 quad_perm:[1,0,3,2] row_mask:0xf bank_mask:0xf
    v_add_f32_dpp v59, v59, v59 quad_perm:[1,0,3,2] row_mask:0xf bank_mask:0xf
    buffer_load_dwordx4 v30, s[32:35], s56 offen offset:2048  lds
    v_add_f32_dpp v56, v56, v56 quad_perm:[2,3,0,1] row_mask:0xf bank_mask:0xf
    v_add_f32_dpp v57, v57, v57 quad_perm:[2,3,0,1] row_mask:0xf bank_mask:0xf
    v_add_f32_dpp v58, v58, v58 quad_perm:[2,3,0,1] row_mask:0xf bank_mask:0xf
    v_add_f32_dpp v59, v59, v59 quad_perm:[2,3,0,1] row_mask:0xf bank_mask:0xf
    v_add_f32_dpp v56, v56, v56 row_half_mirror row_mask:0xf bank_mask:0xf
    v_add_f32_dpp v57, v57, v57 row_half_mirror row_mask:0xf bank_mask:0xf
    v_add_f32_dpp v58, v58, v58 row_half_mirror row_mask:0xf bank_mask:0xf
    v_add_f32_dpp v59, v59, v59 row_half_mirror row_mask:0xf bank_mask:0xf
    v_lshrrev_b32 v32, 3, v1
    buffer_load_dwordx4 v31, s[32:35], s56 offen offset:3072  lds
    s_lshl_b32 s58, s45, 7
    s_add_u32 s58, s58, 153600
    v_lshl_add_u32 v32, v32, 2, s58
    ds_write_b32 v32, v56 offset:0
    ds_write_b32 v32, v57 offset:32
    ds_write_b32 v32, v58 offset:64
    ds_write_b32 v32, v59 offset:96
    s_waitcnt lgkmcnt(0)
    s_cmp_eq_u32 s44, 4
    s_cbranch_scc0 L_rok_9
    s_mov_b32 s59, 0x20000
    s_waitcnt vmcnt(18)
L_rsp_10:
    v_readfirstlane_b32 s57, v17
    s_and_b32 s57, s57, 255
    s_cmp_ge_u32 s57, 32
    s_cbranch_scc1 L_rok_9
    s_sleep 32
    s_mov_b64 exec, 1
    buffer_load_dword v17, v18, s[40:43], 0 offen sc1
    s_mov_b64 exec, -1
    s_waitcnt vmcnt(0)
    s_sub_u32 s59, s59, 1
    s_cbranch_scc0 L_rsp_10
L_rok_9:
    s_barrier
    s_load_dword s59, s[24:25], 0
    s_add_u32 m0, s63, 131072
    s_add_u32 s57, s54, 3
    s_and_b32 s57, s57, 3
    s_mul_i32 s56, s57, 393216
    s_add_u32 s56, s56, s66
    buffer_load_dwordx4 v28, s[32:35], s56 offen offset:0  lds
    buffer_load_dwordx4 v29, s[32:35], s56 offen offset:1024  lds
    buffer_load_dwordx4 v30, s[32:35], s56 offen offset:2048  lds
    buffer_load_dwordx4 v31, s[32:35], s56 offen offset:3072  lds
    s_mov_b32 s36, s14
    s_and_b32 s37, s15, 0xffff
    s_mov_b32 s38, 524288
    s_mov_b32 s39, 0x20000
    s_add_u32 m0, s20, 49152
    s_add_u32 s57, s48, 2
    s_and_b32 s57, s57, 3
    s_lshl_b32 s56, s57, 17
    s_add_u32 s56, s56, s69
    buffer_load_dwordx4 v4, s[36:39], s56 offen offset:0  lds
    buffer_load_dwordx4 v5, s[36:39], s56 offen offset:1024  lds
    s_waitcnt vmcnt(14)
    s_waitcnt lgkmcnt(0)
    s_bfe_u32 s57, s59, 0xc0008
    s_cmp_gt_u32 s57, 32
    s_cselect_b32 s24, 15, 0
    s_bfe_u32 s57, s59, 0x10014
    s_lshl_b32 s57, s57, 0
    s_xor_b32 s24, s24, s57
    s_bfe_u32 s57, s59, 0x10016
    s_lshl_b32 s57, s57, 1
    s_xor_b32 s24, s24, s57
    s_bfe_u32 s57, s59, 0x10018
    s_lshl_b32 s57, s57, 2
    s_xor_b32 s24, s24, s57
    s_bfe_u32 s57, s59, 0x1001a
    s_lshl_b32 s57, s57, 3
    s_xor_b32 s24, s24, s57
    s_lshr_b32 s57, s48, 3
    s_lshr_b32 s57, s24, s57
    s_and_b32 s57, s57, 1
    s_lshl_b32 s25, s57, 13
    s_lshl_b32 s68, s48, 16
    s_lshl_b32 s58, s46, 15
    s_add_u32 s68, s68, s58
    s_lshl_b32 s58, s47, 12
    s_add_u32 s68, s68, s58
    s_add_u32 s68, s68, 23068672
    s_andn2_b32 s59, s68, 0x1fff
    s_add_u32 s68, s68, s59
    s_andn2_b32 s59, s68, 0x1fffff
    s_add_u32 s68, s68, s59
    s_add_u32 s68, s68, s25
    v_bfe_u32 v32, v1, 2, 1
    v_mul_u32_u24 v32, 66, v32
    v_and_b32 v33, 1, v1
    s_lshl_b32 s58, s48, 6
    s_sub_u32 s58, s58, 2
    v_add3_u32 v32, v32, v33, s58
    v_cmp_gt_u32 vcc, 2048, v32
    v_and_b32 v61, 31, v32
    v_lshlrev_b32 v61, 4, v61
    v_bfe_u32 v33, v32, 5, 5
    v_lshl_add_u32 v61, v33, 16, v61
    v_bfe_u32 v33, v32, 10, 1
    v_lshl_add_u32 v61, v33, 22, v61
    v_bfe_u32 v33, v32, 9, 2
    v_lshrrev_b32 v33, v33, s24
    v_and_b32 v33, 1, v33
    v_lshl_add_u32 v61, v33, 13, v61
    v_bfe_u32 v33, v1, 1, 1
    v_lshl_add_u32 v61, v33, 9, v61
    v_bfe_u32 v33, v1, 2, 2
    v_lshl_add_u32 v61, v33, 14, v61
    v_bfrev_b32 v33, 1
    v_cndmask_b32 v61, v33, v61, vcc
    s_lshl_b32 s62, s50, 3
    s_add_u32 s62, s62, s51
    s_lshl_b32 s62, s62, 13
    s_add_u32 s62, s62, s63
    s_add_u32 s62, s62, 18866176
    s_andn2_b32 s59, s62, 0x1fff
    s_add_u32 s62, s62, s59
    s_andn2_b32 s59, s62, 0x1fffff
    s_add_u32 s62, s62, s59
    s_add_u32 s58, s51, s46
    s_sub_u32 s58, s58, 1
    s_bfe_u32 s58, s58, 0x20001
    s_lshr_b32 s58, s24, s58
    s_and_b32 s58, s58, 1
    s_lshl_b32 s58, s58, 13
    s_add_u32 s62, s62, s58
    s_lshl_b32 s10, s48, 3
    s_add_u32 s10, s10, s49
    s_lshr_b32 s57, s10, 6
    s_lshr_b32 s59, s24, s57
    s_and_b32 s59, s59, 1
    s_add_u32 s57, s57, s59
    s_lshl_b32 s57, s57, 6
    s_add_u32 s10, s10, s57
    s_lshl_b32 s10, s10, 7
    s_add_u32 s10, s10, 0
    s_barrier
    s_waitcnt vmcnt(10)
    s_barrier
    s_barrier
    s_lshl_b32 s58, s48, 3
    s_add_u32 s58, s58, s45
    s_lshr_b32 s57, s58, 6
    s_lshr_b32 s59, s24, s57
    s_and_b32 s59, s59, 1
    s_add_u32 s57, s57, s59
    s_lshl_b32 s57, s57, 6
    s_add_u32 s58, s58, s57
    s_lshl_b32 s58, s58, 7
    s_atomic_add s60, s[26:27], s58 offset:0
    s_atomic_add s60, s[26:27], s58 offset:512
    s_atomic_add s60, s[26:27], s58 offset:1024
    s_atomic_add s60, s[26:27], s58 offset:1536
    s_bitcmp1_b32 s49, 1
    s_cselect_b32 s58, 31, 2
    s_add_u32 s58, s58, s48
    s_and_b32 s58, s58, 31
    s_lshl_b32 s58, s58, 3
    s_add_u32 s58, s58, s45
    s_lshr_b32 s57, s58, 6
    s_lshr_b32 s59, s24, s57
    s_and_b32 s59, s59, 1
    s_add_u32 s57, s57, s59
    s_lshl_b32 s57, s57, 6
    s_add_u32 s58, s58, s57
    s_lshl_b32 s58, s58, 7
    s_atomic_add s60, s[26:27], s58 offset:0
    s_atomic_add s60, s[26:27], s58 offset:512
    s_xor_b32 m0, m0, 2048
    s_nop 0
    buffer_load_dwordx4 v6, s[36:39], s56 offen offset:0  lds
    buffer_load_dwordx4 v7, s[36:39], s56 offen offset:1024  lds
    s_add_u32 m0, s20, 65536
    s_add_u32 s57, s48, 3
    s_and_b32 s57, s57, 3
    s_lshl_b32 s56, s57, 17
    s_add_u32 s56, s56, s69
    buffer_load_dwordx4 v4, s[36:39], s56 offen offset:0  lds
    buffer_load_dwordx4 v5, s[36:39], s56 offen offset:1024  lds
    s_xor_b32 m0, m0, 2048
    s_nop 0
    buffer_load_dwordx4 v6, s[36:39], s56 offen offset:0  lds
    buffer_load_dwordx4 v7, s[36:39], s56 offen offset:1024  lds
    s_add_u32 m0, s20, 16384
    s_add_u32 s57, s48, 0
    s_and_b32 s57, s57, 3
    s_lshl_b32 s56, s57, 17
    s_add_u32 s56, s56, s69
    buffer_load_dwordx4 v4, s[36:39], s56 offen offset:0  lds
    buffer_load_dwordx4 v5, s[36:39], s56 offen offset:1024  lds
    s_xor_b32 m0, m0, 2048
    s_nop 0
    buffer_load_dwordx4 v6, s[36:39], s56 offen offset:0  lds
    buffer_load_dwordx4 v7, s[36:39], s56 offen offset:1024  lds
    s_waitcnt vmcnt(16)
    s_barrier
    s_add_u32 m0, s20, 32768
    s_add_u32 s57, s48, 1
    s_and_b32 s57, s57, 3
    s_lshl_b32 s56, s57, 17
    s_add_u32 s56, s56, s69
    buffer_load_dwordx4 v4, s[36:39], s56 offen offset:0  lds
    buffer_load_dwordx4 v5, s[36:39], s56 offen offset:1024  lds
    s_xor_b32 m0, m0, 2048
    s_nop 0
    buffer_load_dwordx4 v6, s[36:39], s56 offen offset:0  lds
    buffer_load_dwordx4 v7, s[36:39], s56 offen offset:1024  lds
    s_waitcnt vmcnt(16)
    s_barrier
    s_load_dword s61, s[26:27], s10 glc
    s_mov_b32 s59, 0x40000
L_psp_12:
    s_waitcnt lgkmcnt(0)
    s_cmp_ge_u32 s61, 12
    s_cbranch_scc1 L_pok_11
    s_load_dword s61, s[26:27], s10 glc
    s_sub_u32 s59, s59, 1
    s_cbranch_scc0 L_psp_12
    s_waitcnt lgkmcnt(0)
L_pok_11:
    s_lshl_b32 s58, s45, 11
    s_mov_b32 m0, s58
    s_add_u32 s58, s58, 92274688
    s_mov_b64 exec, 0xffff
    buffer_load_dwordx4 v61, s[28:31], s58 offen offset:0 sc1 lds
    buffer_load_dwordx4 v61, s[28:31], s58 offen offset:1024 sc1 lds
    s_mov_b64 exec, -1
    s_add_u32 m0, s63, 147456
    s_add_u32 s57, s48, 0
    s_and_b32 s57, s57, 3
    s_lshl_b32 s56, s57, 14
    s_add_u32 s56, s56, s68
    buffer_load_dwordx4 v2, s[28:31], s56 offen offset:0 sc1 lds
    buffer_load_dwordx4 v2, s[28:31], s56 offen offset:1024 sc1 lds
    buffer_load_dwordx4 v2, s[28:31], s56 offen offset:2048 sc1 lds
    buffer_load_dwordx4 v2, s[28:31], s56 offen offset:3072 sc1 lds
    s_add_u32 m0, s63, 81920
    s_add_u32 s57, s48, 1
    s_and_b32 s57, s57, 3
    s_lshl_b32 s56, s57, 14
    s_add_u32 s56, s56, s68
    buffer_load_dwordx4 v2, s[28:31], s56 offen offset:0 sc1 lds
    buffer_load_dwordx4 v2, s[28:31], s56 offen offset:1024 sc1 lds
    buffer_load_dwordx4 v2, s[28:31], s56 offen offset:2048 sc1 lds
    buffer_load_dwordx4 v2, s[28:31], s56 offen offset:3072 sc1 lds
    s_barrier
    s_lshl_b32 s10, s51, 5
    s_add_u32 s10, s10, s50
    s_lshr_b32 s57, s10, 6
    s_lshr_b32 s59, s24, s57
    s_and_b32 s59, s59, 1
    s_add_u32 s57, s57, s59
    s_lshl_b32 s57, s57, 6
    s_add_u32 s10, s10, s57
    s_lshl_b32 s10, s10, 7
    s_add_u32 s10, s10, 8
    s_cmp_eq_u32 s51, 0
    s_cselect_b32 s11, 2, 4
    s_mov_b32 s32, s28
    s_mov_b32 s33, s29
    s_mov_b32 s35, 0x20000
    s_add_u32 s57, s51, s46
    s_cmp_eq_u32 s57, 0
    s_cselect_b32 s34, 0, s30
    s_waitcnt vmcnt(4)
    s_barrier
    s_add_u32 m0, s63, 98304
    s_add_u32 s57, s48, 2
    s_and_b32 s57, s57, 3
    s_lshl_b32 s56, s57, 14
    s_add_u32 s56, s56, s68
    buffer_load_dwordx4 v2, s[28:31], s56 offen offset:0 sc1 lds
    buffer_load_dwordx4 v2, s[28:31], s56 offen offset:1024 sc1 lds
    buffer_load_dwordx4 v2, s[28:31], s56 offen offset:2048 sc1 lds
    buffer_load_dwordx4 v2, s[28:31], s56 offen offset:3072 sc1 lds
    s_add_u32 m0, s63, 114688
    s_add_u32 s57, s48, 3
    s_and_b32 s57, s57, 3
    s_lshl_b32 s56, s57, 14
    s_add_u32 s56, s56, s68
    buffer_load_dwordx4 v2, s[28:31], s56 offen offset:0 sc1 lds
    buffer_load_dwordx4 v2, s[28:31], s56 offen offset:1024 sc1 lds
    s_waitcnt vmcnt(6)
    s_barrier
    s_load_dword s61, s[26:27], s10 glc
    buffer_load_dwordx4 v2, s[28:31], s56 offen offset:2048 sc1 lds
    buffer_load_dwordx4 v2, s[28:31], s56 offen offset:3072 sc1 lds
    s_lshl_b32 s64, -1, 0
    s_lshl_b32 s65, -1, 4
    s_lshl_b32 s66, -1, 1
    s_lshl_b32 s67, -1, 5
    s_lshl_b32 s68, -1, 2
    s_lshl_b32 s69, -1, 6
    s_lshl_b32 s70, -1, 3
    s_lshl_b32 s71, -1, 7
    s_lshl_b32 s72, -1, 8
    s_lshl_b32 s73, -1, 12
    s_lshl_b32 s74, -1, 9
    s_lshl_b32 s75, -1, 13
    s_lshl_b32 s76, -1, 10
    s_lshl_b32 s77, -1, 14
    s_lshl_b32 s78, -1, 11
    s_lshl_b32 s79, -1, 15
    s_lshl_b32 s80, -1, 16
    s_lshl_b32 s81, -1, 20
    s_lshl_b32 s82, -1, 17
    s_lshl_b32 s83, -1, 21
    s_lshl_b32 s84, -1, 18
    s_lshl_b32 s85, -1, 22
    s_lshl_b32 s86, -1, 19
    s_lshl_b32 s87, -1, 23
    s_lshl_b32 s88, -1, 24
    s_lshl_b32 s89, -1, 28
    s_lshl_b32 s90, -1, 25
    s_lshl_b32 s91, -1, 29
    s_lshl_b32 s92, -1, 26
    s_lshl_b32 s93, -1, 30
    s_lshl_b32 s94, -1, 27
    s_lshl_b32 s95, -1, 31
    s_mov_b32 s96, 0xffff
    s_mov_b32 s97, 0xffff
    s_waitcnt vmcnt(4)
    s_barrier
    s_mov_b32 s59, 0x40000
L_psp_14:
    s_waitcnt lgkmcnt(0)
    s_cmp_ge_u32 s61, s11
    s_cbranch_scc1 L_pok_13
    s_load_dword s61, s[26:27], s10 glc
    s_sub_u32 s59, s59, 1
    s_cbranch_scc0 L_psp_14
    s_waitcnt lgkmcnt(0)
L_pok_13:
    s_add_u32 m0, s63, 131072
    s_mov_b32 s56, s62
    buffer_load_dwordx4 v2, s[32:35], s56 offen offset:0 sc1 lds
    buffer_load_dwordx4 v2, s[32:35], s56 offen offset:1024 sc1 lds
    buffer_load_dwordx4 v2, s[32:35], s56 offen offset:2048 sc1 lds
    buffer_load_dwordx4 v2, s[32:35], s56 offen offset:3072 sc1 lds
    s_lshl_b32 s56, s50, 3
    s_add_u32 s56, s56, s51
    s_lshl_b32 s56, s56, 3
    s_add_u32 s56, s56, s44
    s_lshl_b32 s56, s56, 10
    s_add_u32 s56, s56, 16777216
    s_andn2_b32 s59, s56, 0x1fff
    s_add_u32 s56, s56, s59
    s_andn2_b32 s59, s56, 0x1fffff
    s_add_u32 s56, s56, s59
    s_add_u32 s56, s56, s25
    buffer_load_dwordx4 v[20:23], v2, s[28:31], s56 offen sc1
    s_waitcnt vmcnt(5)
    s_barrier
    s_lshr_b32 s58, s48, 2
    s_lshl_b32 s58, s58, 3
    s_add_u32 s58, s58, s49
    s_lshl_b32 s58, s58, 2
    s_add_u32 s58, s58, s45
    s_lshr_b32 s57, s58, 6
    s_lshr_b32 s59, s24, s57
    s_and_b32 s59, s59, 1
    s_add_u32 s57, s57, s59
    s_lshl_b32 s57, s57, 6
    s_add_u32 s58, s58, s57
    s_lshl_b32 s58, s58, 7
    s_atomic_add s60, s[26:27], s58 offset:12
    s_cmp_ge_u32 s48, 28
    s_cbranch_scc1 L_lastq_15
    s_lshr_b32 s58, s48, 2
    s_lshl_b32 s58, s58, 3
    s_add_u32 s58, s58, s49
    s_lshl_b32 s58, s58, 2
    s_add_u32 s58, s58, 32
    s_add_u32 s58, s58, s45
    s_lshr_b32 s57, s58, 6
    s_lshr_b32 s59, s24, s57
    s_and_b32 s59, s59, 1
    s_add_u32 s57, s57, s59
    s_lshl_b32 s57, s57, 6
    s_add_u32 s58, s58, s57
    s_lshl_b32 s58, s58, 7
    s_atomic_add s60, s[26:27], s58 offset:12
L_lastq_15:
    s_branch L_midj_7
L_mid1_6:
    s_waitcnt vmcnt(4)
    s_barrier
    s_add_u32 m0, s63, 49152
    s_add_u32 s57, s54, 1
    s_and_b32 s57, s57, 3
    s_lshl_b32 s56, s57, 8
    s_add_u32 s56, s56, s64
    buffer_load_dwordx4 v24, s[32:35], s56 offen offset:0  lds
    buffer_load_dwordx4 v25, s[32:35], s56 offen offset:1024  lds
    buffer_load_dwordx4 v26, s[32:35], s56 offen offset:2048  lds
    buffer_load_dwordx4 v27, s[32:35], s56 offen offset:3072  lds
    s_add_u32 m0, s63, 81920
    s_add_u32 s57, s54, 1
    s_and_b32 s57, s57, 3
    s_mul_i32 s56, s57, s67
    s_add_u32 s56, s56, s65
    buffer_load_dwordx4 v40, s[36:39], s56 offen offset:0  lds
    buffer_load_dwordx4 v41, s[36:39], s56 offen offset:1024  lds
    s_waitcnt vmcnt(6)
    s_barrier
    buffer_load_dwordx4 v42, s[36:39], s56 offen offset:2048  lds
    buffer_load_dwordx4 v43, s[36:39], s56 offen offset:3072  lds
    s_add_u32 m0, s63, 65536
    s_add_u32 s57, s54, 1
    s_and_b32 s57, s57, 3
    s_lshl_b32 s56, s57, 8
    s_add_u32 s56, s56, s64
    s_xor_b32 s56, s56, 128
    buffer_load_dwordx4 v24, s[32:35], s56 offen offset:0  lds
    buffer_load_dwordx4 v25, s[32:35], s56 offen offset:1024  lds
    buffer_load_dwordx4 v26, s[32:35], s56 offen offset:2048  lds
    buffer_load_dwordx4 v27, s[32:35], s56 offen offset:3072  lds
    v_lshlrev_b32 v34, 7, v1
    v_lshrrev_b32 v33, 4, v1
    s_cmp_eq_u32 s45, 0
    s_cselect_b32 s59, 1024, 0
    v_mad_u32_u24 v34, v33, s59, v34
    v_add_u32 v34, s59, v34
    s_mov_b64 s[40:41], s[6:7]
    s_mov_b32 s57, 24
    s_mov_b32 s58, 0
    s_cmp_eq_u32 s45, 1
    s_cselect_b64 s[40:41], s[14:15], s[40:41]
    s_cselect_b32 s57, 8, s57
    s_cselect_b32 s58, 0, s58
    s_cmp_eq_u32 s45, 2
    s_cselect_b64 s[40:41], s[16:17], s[40:41]
    s_cselect_b32 s57, 14, s57
    s_cselect_b32 s58, 0, s58
    s_cmp_eq_u32 s45, 3
    s_cselect_b64 s[40:41], s[16:17], s[40:41]
    s_cselect_b32 s57, 14, s57
    s_cselect_b32 s58, 14, s58
    s_lshl_b32 s57, s57, 9
    s_mul_i32 s56, s57, s70
    s_lshl_b32 s58, s58, 16
    s_add_u32 s56, s56, s58
    s_branch L_pgo7
L_pg7:
    s_setpc_b64 s[58:59]
L_pgo7:
    s_and_b32 s41, s41, 0xffff
    s_add_u32 s42, s56, s57
    s_mov_b32 s43, 0x20000
    buffer_load_dword v35, v34, s[40:43], s56 offen
    s_mov_b32 s40, s24
    s_and_b32 s41, s25, 0xffff
    s_mov_b32 s42, 256
    s_mov_b32 s43, 0x20000
    s_add_u32 m0, s63, 98304
    s_add_u32 s57, s54, 2
    s_and_b32 s57, s57, 3
    s_lshl_b32 s56, s57, 8
    s_add_u32 s56, s56, s64
    buffer_load_dwordx4 v24, s[32:35], s56 offen offset:0  lds
    buffer_load_dwordx4 v25, s[32:35], s56 offen offset:1024  lds
    s_waitcnt vmcnt(7)
    s_barrier
    buffer_load_dwordx4 v26, s[32:35], s56 offen offset:2048  lds
    buffer_load_dwordx4 v27, s[32:35], s56 offen offset:3072  lds
    s_add_u32 m0, s63, 131072
    s_add_u32 s57, s54, 2
    s_and_b32 s57, s57, 3
    s_mul_i32 s56, s57, s67
    s_add_u32 s56, s56, s65
    buffer_load_dwordx4 v40, s[36:39], s56 offen offset:0  lds
    buffer_load_dwordx4 v41, s[36:39], s56 offen offset:1024  lds
    s_waitcnt vmcnt(7)
    s_barrier
    buffer_load_dwordx4 v42, s[36:39], s56 offen offset:2048  lds
    buffer_load_dwordx4 v43, s[36:39], s56 offen offset:3072  lds
    s_add_u32 m0, s63, 114688
    s_add_u32 s57, s54, 2
    s_and_b32 s57, s57, 3
    s_lshl_b32 s56, s57, 8
    s_add_u32 s56, s56, s64
    s_xor_b32 s56, s56, 128
    buffer_load_dwordx4 v24, s[32:35], s56 offen offset:0  lds
    buffer_load_dwordx4 v25, s[32:35], s56 offen offset:1024  lds
    buffer_load_dwordx4 v26, s[32:35], s56 offen offset:2048  lds
    buffer_load_dwordx4 v27, s[32:35], s56 offen offset:3072  lds
    s_add_u32 m0, s63, 0
    s_add_u32 s57, s54, 3
    s_and_b32 s57, s57, 3
    s_lshl_b32 s56, s57, 8
    s_add_u32 s56, s56, s64
    buffer_load_dwordx4 v24, s[32:35], s56 offen offset:0  lds
    buffer_load_dwordx4 v25, s[32:35], s56 offen offset:1024  lds
    s_waitcnt vmcnt(6)
    s_barrier
    buffer_load_dwordx4 v26, s[32:35], s56 offen offset:2048  lds
    buffer_load_dwordx4 v27, s[32:35], s56 offen offset:3072  lds
    s_add_u32 m0, s63, 32768
    s_add_u32 s57, s54, 3
    s_and_b32 s57, s57, 3
    s_mul_i32 s56, s57, s67
    s_add_u32 s56, s56, s65
    buffer_load_dwordx4 v40, s[36:39], s56 offen offset:0  lds
    buffer_load_dwordx4 v41, s[36:39], s56 offen offset:1024  lds
    s_waitcnt vmcnt(6)
    s_barrier
    s_cmp_eq_u32 s44, 4
    s_cbranch_scc0 L_ow_16
    s_mov_b64 exec, 1
    buffer_load_dword v17, v18, s[40:43], 0 offen sc1
    s_mov_b64 exec, -1
L_ow_16:
    buffer_load_dwordx4 v42, s[36:39], s56 offen offset:2048  lds
    buffer_load_dwordx4 v43, s[36:39], s56 offen offset:3072  lds
    s_add_u32 m0, s63, 16384
    s_add_u32 s57, s54, 3
    s_and_b32 s57, s57, 3
    s_lshl_b32 s56, s57, 8
    s_add_u32 s56, s56, s64
    s_xor_b32 s56, s56, 128
    buffer_load_dwordx4 v24, s[32:35], s56 offen offset:0  lds
    buffer_load_dwordx4 v25, s[32:35], s56 offen offset:1024  lds
    buffer_load_dwordx4 v26, s[32:35], s56 offen offset:2048  lds
    buffer_load_dwordx4 v27, s[32:35], s56 offen offset:3072  lds
    s_mov_b32 s32, s6
    s_and_b32 s33, s7, 0xffff
    s_mov_b32 s34, 1572864
    s_mov_b32 s35, 0x20000
    s_add_u32 m0, s63, 81920
    s_add_u32 s57, s54, 0
    s_and_b32 s57, s57, 3
    s_mul_i32 s56, s57, 393216
    s_add_u32 s56, s56, s66
    buffer_load_dwordx4 v28, s[32:35], s56 offen offset:0  lds
    buffer_load_dwordx4 v29, s[32:35], s56 offen offset:1024  lds
    s_waitcnt vmcnt(6)
    s_barrier
    buffer_load_dwordx4 v30, s[32:35], s56 offen offset:2048  lds
    buffer_load_dwordx4 v31, s[32:35], s56 offen offset:3072  lds
    s_add_u32 m0, s63, 98304
    s_add_u32 s57, s54, 1
    s_and_b32 s57, s57, 3
    s_mul_i32 s56, s57, 393216
    s_add_u32 s56, s56, s66
    buffer_load_dwordx4 v28, s[32:35], s56 offen offset:0  lds
    buffer_load_dwordx4 v29, s[32:35], s56 offen offset:1024  lds
    s_waitcnt vmcnt(6)
    s_barrier
    buffer_load_dwordx4 v30, s[32:35], s56 offen offset:2048  lds
    buffer_load_dwordx4 v31, s[32:35], s56 offen offset:3072  lds
    s_add_u32 m0, s63, 114688
    s_add_u32 s57, s54, 2
    s_and_b32 s57, s57, 3
    s_mul_i32 s56, s57, 393216
    s_add_u32 s56, s56, s66
    buffer_load_dwordx4 v28, s[32:35], s56 offen offset:0  lds
    buffer_load_dwordx4 v29, s[32:35], s56 offen offset:1024  lds
    buffer_load_dwordx4 v30, s[32:35], s56 offen offset:2048  lds
    buffer_load_dwordx4 v31, s[32:35], s56 offen offset:3072  lds
    s_cmp_eq_u32 s44, 4
    s_cbranch_scc0 L_rok_17
    s_mov_b32 s59, 0x20000
    s_waitcnt vmcnt(18)
L_rsp_18:
    v_readfirstlane_b32 s57, v17
    s_and_b32 s57, s57, 255
    s_cmp_ge_u32 s57, 32
    s_cbranch_scc1 L_rok_17
    s_sleep 32
    s_mov_b64 exec, 1
    buffer_load_dword v17, v18, s[40:43], 0 offen sc1
    s_mov_b64 exec, -1
    s_waitcnt vmcnt(0)
    s_sub_u32 s59, s59, 1
    s_cbranch_scc0 L_rsp_18
L_rok_17:
    s_barrier
    s_load_dword s59, s[24:25], 0
    s_add_u32 m0, s63, 131072
    s_add_u32 s57, s54, 3
    s_and_b32 s57, s57, 3
    s_mul_i32 s56, s57, 393216
    s_add_u32 s56, s56, s66
    buffer_load_dwordx4 v28, s[32:35], s56 offen offset:0  lds
    buffer_load_dwordx4 v29, s[32:35], s56 offen offset:1024  lds
    s_waitcnt vmcnt(10)
    s_barrier
    buffer_load_dwordx4 v30, s[32:35], s56 offen offset:2048  lds
    buffer_load_dwordx4 v31, s[32:35], s56 offen offset:3072  lds
    s_mov_b32 s36, s14
    s_and_b32 s37, s15, 0xffff
    s_mov_b32 s38, 524288
    s_mov_b32 s39, 0x20000
    s_add_u32 m0, s20, 49152
    s_add_u32 s57, s48, 2
    s_and_b32 s57, s57, 3
    s_lshl_b32 s56, s57, 17
    s_add_u32 s56, s56, s69
    buffer_load_dwordx4 v4, s[36:39], s56 offen offset:0  lds
    buffer_load_dwordx4 v5, s[36:39], s56 offen offset:1024  lds
    s_xor_b32 m0, m0, 2048
    s_nop 0
    buffer_load_dwordx4 v6, s[36:39], s56 offen offset:0  lds
    buffer_load_dwordx4 v7, s[36:39], s56 offen offset:1024  lds
    s_waitcnt lgkmcnt(0)
    s_bfe_u32 s57, s59, 0xc0008
    s_cmp_gt_u32 s57, 32
    s_cselect_b32 s24, 15, 0
    s_bfe_u32 s57, s59, 0x10014
    s_lshl_b32 s57, s57, 0
    s_xor_b32 s24, s24, s57
    s_bfe_u32 s57, s59, 0x10016
    s_lshl_b32 s57, s57, 1
    s_xor_b32 s24, s24, s57
    s_bfe_u32 s57, s59, 0x10018
    s_lshl_b32 s57, s57, 2
    s_xor_b32 s24, s24, s57
    s_bfe_u32 s57, s59, 0x1001a
    s_lshl_b32 s57, s57, 3
    s_xor_b32 s24, s24, s57
    s_lshr_b32 s57, s48, 3
    s_lshr_b32 s57, s24, s57
    s_and_b32 s57, s57, 1
    s_lshl_b32 s25, s57, 13
    s_lshl_b32 s68, s48, 16
    s_lshl_b32 s58, s46, 15
    s_add_u32 s68, s68, s58
    s_lshl_b32 s58, s47, 12
    s_add_u32 s68, s68, s58
    s_add_u32 s68, s68, 23068672
    s_andn2_b32 s59, s68, 0x1fff
    s_add_u32 s68, s68, s59
    s_andn2_b32 s59, s68, 0x1fffff
    s_add_u32 s68, s68, s59
    s_add_u32 s68, s68, s25
    v_bfe_u32 v32, v1, 2, 1
    v_mul_u32_u24 v32, 66, v32
    v_and_b32 v33, 1, v1
    s_lshl_b32 s58, s48, 6
    s_sub_u32 s58, s58, 2
    v_add3_u32 v32, v32, v33, s58
    v_cmp_gt_u32 vcc, 2048, v32
    v_and_b32 v61, 31, v32
    v_lshlrev_b32 v61, 4, v61
    v_bfe_u32 v33, v32, 5, 5
    v_lshl_add_u32 v61, v33, 16, v61
    v_bfe_u32 v33, v32, 10, 1
    v_lshl_add_u32 v61, v33, 22, v61
    v_bfe_u32 v33, v32, 9, 2
    v_lshrrev_b32 v33, v33, s24
    v_and_b32 v33, 1, v33
    v_lshl_add_u32 v61, v33, 13, v61
    v_bfe_u32 v33, v1, 1, 1
    v_lshl_add_u32 v61, v33, 9, v61
    v_bfe_u32 v33, v1, 2, 2
    v_lshl_add_u32 v61, v33, 14, v61
    v_bfrev_b32 v33, 1
    v_cndmask_b32 v61, v33, v61, vcc
    s_lshl_b32 s62, s50, 3
    s_add_u32 s62, s62, s51
    s_lshl_b32 s62, s62, 13
    s_add_u32 s62, s62, s63
    s_add_u32 s62, s62, 18866176
    s_andn2_b32 s59, s62, 0x1fff
    s_add_u32 s62, s62, s59
    s_andn2_b32 s59, s62, 0x1fffff
    s_add_u32 s62, s62, s59
    s_add_u32 s58, s51, s46
    s_sub_u32 s58, s58, 1
    s_bfe_u32 s58, s58, 0x20001
    s_lshr_b32 s58, s24, s58
    s_and_b32 s58, s58, 1
    s_lshl_b32 s58, s58, 13
    s_add_u32 s62, s62, s58
    s_lshl_b32 s10, s48, 3
    s_add_u32 s10, s10, s49
    s_lshr_b32 s57, s10, 6
    s_lshr_b32 s59, s24, s57
    s_and_b32 s59, s59, 1
    s_add_u32 s57, s57, s59
    s_lshl_b32 s57, s57, 6
    s_add_u32 s10, s10, s57
    s_lshl_b32 s10, s10, 7
    s_add_u32 s10, s10, 0
    s_waitcnt vmcnt(12)
    s_barrier
    s_barrier
    s_add_u32 m0, s20, 65536
    s_add_u32 s57, s48, 3
    s_and_b32 s57, s57, 3
    s_lshl_b32 s56, s57, 17
    s_add_u32 s56, s56, s69
    buffer_load_dwordx4 v4, s[36:39], s56 offen offset:0  lds
    buffer_load_dwordx4 v5, s[36:39], s56 offen offset:1024  lds
    s_xor_b32 m0, m0, 2048
    s_nop 0
    buffer_load_dwordx4 v6, s[36:39], s56 offen offset:0  lds
    buffer_load_dwordx4 v7, s[36:39], s56 offen offset:1024  lds
    s_add_u32 m0, s20, 16384
    s_add_u32 s57, s48, 0
    s_and_b32 s57, s57, 3
    s_lshl_b32 s56, s57, 17
    s_add_u32 s56, s56, s69
    buffer_load_dwordx4 v4, s[36:39], s56 offen offset:0  lds
    buffer_load_dwordx4 v5, s[36:39], s56 offen offset:1024  lds
    s_waitcnt vmcnt(14)
    s_barrier
    s_xor_b32 m0, m0, 2048
    s_nop 0
    buffer_load_dwordx4 v6, s[36:39], s56 offen offset:0  lds
    buffer_load_dwordx4 v7, s[36:39], s56 offen offset:1024  lds
    s_add_u32 m0, s20, 32768
    s_add_u32 s57, s48, 1
    s_and_b32 s57, s57, 3
    s_lshl_b32 s56, s57, 17
    s_add_u32 s56, s56, s69
    buffer_load_dwordx4 v4, s[36:39], s56 offen offset:0  lds
    buffer_load_dwordx4 v5, s[36:39], s56 offen offset:1024  lds
    s_xor_b32 m0, m0, 2048
    s_nop 0
    buffer_load_dwordx4 v6, s[36:39], s56 offen offset:0  lds
    buffer_load_dwordx4 v7, s[36:39], s56 offen offset:1024  lds
    s_waitcnt vmcnt(16)
    s_barrier
    s_load_dword s61, s[26:27], s10 glc
    s_mov_b32 s59, 0x40000
L_psp_20:
    s_waitcnt lgkmcnt(0)
    s_cmp_ge_u32 s61, 12
    s_cbranch_scc1 L_pok_19
    s_load_dword s61, s[26:27], s10 glc
    s_sub_u32 s59, s59, 1
    s_cbranch_scc0 L_psp_20
    s_waitcnt lgkmcnt(0)
L_pok_19:
    s_lshl_b32 s58, s45, 11
    s_mov_b32 m0, s58
    s_add_u32 s58, s58, 92274688
    s_mov_b64 exec, 0xffff
    buffer_load_dwordx4 v61, s[28:31], s58 offen offset:0 sc1 lds
    buffer_load_dwordx4 v61, s[28:31], s58 offen offset:1024 sc1 lds
    s_mov_b64 exec, -1
    s_add_u32 m0, s63, 147456
    s_add_u32 s57, s48, 0
    s_and_b32 s57, s57, 3
    s_lshl_b32 s56, s57, 14
    s_add_u32 s56, s56, s68
    buffer_load_dwordx4 v2, s[28:31], s56 offen offset:0 sc1 lds
    buffer_load_dwordx4 v2, s[28:31], s56 offen offset:1024 sc1 lds
    buffer_load_dwordx4 v2, s[28:31], s56 offen offset:2048 sc1 lds
    buffer_load_dwordx4 v2, s[28:31], s56 offen offset:3072 sc1 lds
    s_add_u32 m0, s63, 81920
    s_add_u32 s57, s48, 1
    s_and_b32 s57, s57, 3
    s_lshl_b32 s56, s57, 14
    s_add_u32 s56, s56, s68
    buffer_load_dwordx4 v2, s[28:31], s56 offen offset:0 sc1 lds
    buffer_load_dwordx4 v2, s[28:31], s56 offen offset:1024 sc1 lds
    buffer_load_dwordx4 v2, s[28:31], s56 offen offset:2048 sc1 lds
    buffer_load_dwordx4 v2, s[28:31], s56 offen offset:3072 sc1 lds
    s_barrier
    s_lshr_b32 s58, s48, 2
    s_lshl_b32 s58, s58, 3
    s_add_u32 s58, s58, s49
    s_lshl_b32 s58, s58, 2
    s_add_u32 s58, s58, s45
    s_lshr_b32 s57, s58, 6
    s_lshr_b32 s59, s24, s57
    s_and_b32 s59, s59, 1
    s_add_u32 s57, s57, s59
    s_lshl_b32 s57, s57, 6
    s_add_u32 s58, s58, s57
    s_lshl_b32 s58, s58, 7
    s_atomic_add s60, s[26:27], s58 offset:8
    s_cmp_ge_u32 s48, 28
    s_cbranch_scc1 L_lastq_21
    s_lshr_b32 s58, s48, 2
    s_lshl_b32 s58, s58, 3
    s_add_u32 s58, s58, s49
    s_lshl_b32 s58, s58, 2
    s_add_u32 s58, s58, 32
    s_add_u32 s58, s58, s45
    s_lshr_b32 s57, s58, 6
    s_lshr_b32 s59, s24, s57
    s_and_b32 s59, s59, 1
    s_add_u32 s57, s57, s59
    s_lshl_b32 s57, s57, 6
    s_add_u32 s58, s58, s57
    s_lshl_b32 s58, s58, 7
    s_atomic_add s60, s[26:27], s58 offset:8
L_lastq_21:
    s_lshl_b32 s10, s51, 5
    s_add_u32 s10, s10, s50
    s_lshr_b32 s57, s10, 6
    s_lshr_b32 s59, s24, s57
    s_and_b32 s59, s59, 1
    s_add_u32 s57, s57, s59
    s_lshl_b32 s57, s57, 6
    s_add_u32 s10, s10, s57
    s_lshl_b32 s10, s10, 7
    s_add_u32 s10, s10, 8
    s_cmp_eq_u32 s51, 0
    s_cselect_b32 s11, 2, 4
    s_mov_b32 s32, s28
    s_mov_b32 s33, s29
    s_mov_b32 s35, 0x20000
    s_add_u32 s57, s51, s46
    s_cmp_eq_u32 s57, 0
    s_cselect_b32 s34, 0, s30
    s_waitcnt vmcnt(4)
    s_barrier
    s_add_u32 m0, s63, 98304
    s_add_u32 s57, s48, 2
    s_and_b32 s57, s57, 3
    s_lshl_b32 s56, s57, 14
    s_add_u32 s56, s56, s68
    buffer_load_dwordx4 v2, s[28:31], s56 offen offset:0 sc1 lds
    buffer_load_dwordx4 v2, s[28:31], s56 offen offset:1024 sc1 lds
    buffer_load_dwordx4 v2, s[28:31], s56 offen offset:2048 sc1 lds
    buffer_load_dwordx4 v2, s[28:31], s56 offen offset:3072 sc1 lds
    s_add_u32 m0, s63, 114688
    s_add_u32 s57, s48, 3
    s_and_b32 s57, s57, 3
    s_lshl_b32 s56, s57, 14
    s_add_u32 s56, s56, s68
    buffer_load_dwordx4 v2, s[28:31], s56 offen offset:0 sc1 lds
    buffer_load_dwordx4 v2, s[28:31], s56 offen offset:1024 sc1 lds
    s_waitcnt vmcnt(6)
    s_barrier
    s_load_dword s61, s[26:27], s10 glc
    buffer_load_dwordx4 v2, s[28:31], s56 offen offset:2048 sc1 lds
    buffer_load_dwordx4 v2, s[28:31], s56 offen offset:3072 sc1 lds
    s_lshl_b32 s64, -1, 0
    s_lshl_b32 s65, -1, 4
    s_lshl_b32 s66, -1, 1
    s_lshl_b32 s67, -1, 5
    s_lshl_b32 s68, -1, 2
    s_lshl_b32 s69, -1, 6
    s_lshl_b32 s70, -1, 3
    s_lshl_b32 s71, -1, 7
    s_lshl_b32 s72, -1, 8
    s_lshl_b32 s73, -1, 12
    s_lshl_b32 s74, -1, 9
    s_lshl_b32 s75, -1, 13
    s_lshl_b32 s76, -1, 10
    s_lshl_b32 s77, -1, 14
    s_lshl_b32 s78, -1, 11
    s_lshl_b32 s79, -1, 15
    s_lshl_b32 s80, -1, 16
    s_lshl_b32 s81, -1, 20
    s_lshl_b32 s82, -1, 17
    s_lshl_b32 s83, -1, 21
    s_lshl_b32 s84, -1, 18
    s_lshl_b32 s85, -1, 22
    s_lshl_b32 s86, -1, 19
    s_lshl_b32 s87, -1, 23
    s_lshl_b32 s88, -1, 24
    s_lshl_b32 s89, -1, 28
    s_lshl_b32 s90, -1, 25
    s_lshl_b32 s91, -1, 29
    s_lshl_b32 s92, -1, 26
    s_lshl_b32 s93, -1, 30
    s_lshl_b32 s94, -1, 27
    s_lshl_b32 s95, -1, 31
    s_mov_b32 s96, 0xffff
    s_mov_b32 s97, 0xffff
    s_waitcnt vmcnt(4)
    s_barrier
    s_mov_b32 s59, 0x40000
L_psp_23:
    s_waitcnt lgkmcnt(0)
    s_cmp_ge_u32 s61, s11
    s_cbranch_scc1 L_pok_22
    s_load_dword s61, s[26:27], s10 glc
    s_sub_u32 s59, s59, 1
    s_cbranch_scc0 L_psp_23
    s_waitcnt lgkmcnt(0)
L_pok_22:
    s_add_u32 m0, s63, 131072
    s_mov_b32 s56, s62
    buffer_load_dwordx4 v2, s[32:35], s56 offen offset:0 sc1 lds
    buffer_load_dwordx4 v2, s[32:35], s56 offen offset:1024 sc1 lds
    buffer_load_dwordx4 v2, s[32:35], s56 offen offset:2048 sc1 lds
    buffer_load_dwordx4 v2, s[32:35], s56 offen offset:3072 sc1 lds
    s_lshl_b32 s56, s50, 3
    s_add_u32 s56, s56, s51
    s_lshl_b32 s56, s56, 3
    s_add_u32 s56, s56, s44
    s_lshl_b32 s56, s56, 10
    s_add_u32 s56, s56, 16777216
    s_andn2_b32 s59, s56, 0x1fff
    s_add_u32 s56, s56, s59
    s_andn2_b32 s59, s56, 0x1fffff
    s_add_u32 s56, s56, s59
    s_add_u32 s56, s56, s25
    buffer_load_dwordx4 v[20:23], v2, s[28:31], s56 offen sc1
    s_waitcnt vmcnt(5)
    s_barrier
L_midj_7:
    s_add_u32 s10, s10, 4
    v_lshrrev_b32 v0, 3, v1
    v_mul_u32_u24 v13, 3584, v0
    v_bfe_u32 v0, v1, 4, 1
    v_lshlrev_b32 v0, 2, v0
    v_and_b32 v19, 7, v1
    v_xor_b32 v0, v0, v19
    v_lshl_add_u32 v13, v0, 4, v13
    v_add_u32 v14, 27648, v13
    v_add_u32 v15, 55296, v13
    v_add_u32 v16, 82944, v13
    s_mov_b32 s36, s16
    s_and_b32 s37, s17, 0xffff
    s_mov_b32 s38, 1835008
    s_mov_b32 s39, 0x20000
    s_cmp_lt_u32 s53, 14
    s_cselect_b32 s38, s38, 0
    s_mul_i32 s56, s45, 114688
    s_lshl_b32 s58, s53, 8
    s_add_u32 s56, s56, s58
    s_mov_b32 s57, 0
    s_mul_i32 s12, s57, 458752
    s_add_u32 s12, s12, s56
    s_mov_b32 s57, 1
    s_mul_i32 s13, s57, 458752
    s_add_u32 s13, s13, s56
    s_mov_b32 s57, 2
    s_mul_i32 s14, s57, 458752
    s_add_u32 s14, s14, s56
    s_mov_b32 s57, 3
    s_mul_i32 s15, s57, 458752
    s_add_u32 s15, s15, s56
    s_lshl_b32 s58, s44, 10
    s_add_u32 s58, s58, 131072
    v_add_u32 v108, s58, v2
    v_and_b32 v0, 15, v1
    v_lshrrev_b32 v19, 5, v1
    v_lshlrev_b32 v0, 4, v0
    v_lshl_add_u32 v0, v19, 8, v0
    s_add_u32 s58, s58, 16384
    v_add_u32 v109, s58, v0
    v_mov_b32 v48, 0x3f803f80
    v_mov_b32 v0, 0xffff
    v_mov_b32 v49, v48
    v_mov_b32 v50, v48
    v_mov_b32 v51, v48
    v_mov_b32 v52, v48
    v_mov_b32 v53, v48
    v_mov_b32 v54, v48
    v_mov_b32 v55, v48
    v_mov_b32 v56, v48
    v_mov_b32 v57, v48
    v_mov_b32 v58, v48
    v_mov_b32 v59, v48
    v_mov_b32 v60, v48
    v_mov_b32 v61, v48
    v_mov_b32 v62, v48
    v_mov_b32 v63, v48
    v_cndmask_b32 v24, 0, v0, s[64:65]
    v_cndmask_b32 v24, v24, -1, s[66:67]
    v_cndmask_b32 v25, 0, v0, s[68:69]
    v_cndmask_b32 v25, v25, -1, s[70:71]
    v_cndmask_b32 v26, 0, v0, s[72:73]
    v_cndmask_b32 v26, v26, -1, s[74:75]
    v_cndmask_b32 v27, 0, v0, s[76:77]
    v_cndmask_b32 v27, v27, -1, s[78:79]
    v_cndmask_b32 v28, 0, v0, s[80:81]
    v_cndmask_b32 v28, v28, -1, s[82:83]
    v_cndmask_b32 v29, 0, v0, s[84:85]
    v_cndmask_b32 v29, v29, -1, s[86:87]
    v_cndmask_b32 v30, 0, v0, s[88:89]
    v_cndmask_b32 v30, v30, -1, s[90:91]
    v_cndmask_b32 v31, 0, v0, s[92:93]
    v_cndmask_b32 v31, v31, -1, s[94:95]
    s_sub_u32 s54, 8, s44
    s_cmp_eq_u32 s51, 0
    s_cselect_b32 s54, s54, 0
    s_barrier
    s_load_dword s61, s[26:27], s10 glc
    s_waitcnt vmcnt(0)
    s_barrier
    s_waitcnt lgkmcnt(0)
    s_cmp_ge_u32 s61, s11
    s_cbranch_scc1 L_okv_24
    s_load_dword s61, s[26:27], s10 glc
    s_add_u32 m0, s63, 0
    s_add_u32 s56, s12, 0
    buffer_load_dwordx4 v13, s[36:39], s56 offen offset:0 lds
    buffer_load_dwordx4 v14, s[36:39], s56 offen offset:1024 lds
    buffer_load_dwordx4 v15, s[36:39], s56 offen offset:2048 lds
    buffer_load_dwordx4 v16, s[36:39], s56 offen offset:3072 lds
    s_waitcnt lgkmcnt(0)
    s_barrier
    s_lshr_b32 s58, s48, 1
    s_lshl_b32 s58, s58, 4
    s_add_u32 s58, s58, s45
    s_lshr_b32 s57, s58, 6
    s_lshr_b32 s59, s24, s57
    s_and_b32 s59, s59, 1
    s_add_u32 s57, s57, s59
    s_lshl_b32 s57, s57, 6
    s_add_u32 s58, s58, s57
    s_lshl_b32 s58, s58, 7
    s_atomic_add s60, s[26:27], s58 offset:16
    s_atomic_add s60, s[26:27], s58 offset:528
    s_atomic_add s60, s[26:27], s58 offset:1040
    s_atomic_add s60, s[26:27], s58 offset:1552
    s_cmp_ge_u32 s61, s11
    s_cbranch_scc1 L_pok_26
    s_load_dword s61, s[26:27], s10 glc
    s_mov_b32 s59, 0x40000
L_psp_27:
    s_waitcnt lgkmcnt(0)
    s_cmp_ge_u32 s61, s11
    s_cbranch_scc1 L_pok_26
    s_load_dword s61, s[26:27], s10 glc
    s_sub_u32 s59, s59, 1
    s_cbranch_scc0 L_psp_27
    s_waitcnt lgkmcnt(0)
L_pok_26:
    s_add_u32 m0, s63, 147456
    s_add_u32 s56, s62, 8388608
    buffer_load_dwordx4 v2, s[32:35], s56 offen offset:0 sc1 lds
    buffer_load_dwordx4 v2, s[32:35], s56 offen offset:1024 sc1 lds
    buffer_load_dwordx4 v2, s[32:35], s56 offen offset:2048 sc1 lds
    buffer_load_dwordx4 v2, s[32:35], s56 offen offset:3072 sc1 lds
    s_add_u32 m0, s63, 16384
    s_add_u32 s56, s13, 0
    buffer_load_dwordx4 v13, s[36:39], s56 offen offset:0 lds
    buffer_load_dwordx4 v14, s[36:39], s56 offen offset:1024 lds
    buffer_load_dwordx4 v15, s[36:39], s56 offen offset:2048 lds
    buffer_load_dwordx4 v16, s[36:39], s56 offen offset:3072 lds
    s_waitcnt vmcnt(4)
    s_branch L_jv_25
L_okv_24:
    s_add_u32 m0, s63, 147456
    s_add_u32 s56, s62, 8388608
    buffer_load_dwordx4 v2, s[32:35], s56 offen offset:0 sc1 lds
    buffer_load_dwordx4 v2, s[32:35], s56 offen offset:1024 sc1 lds
    buffer_load_dwordx4 v2, s[32:35], s56 offen offset:2048 sc1 lds
    buffer_load_dwordx4 v2, s[32:35], s56 offen offset:3072 sc1 lds
    s_add_u32 m0, s63, 0
    s_add_u32 s56, s12, 0
    buffer_load_dwordx4 v13, s[36:39], s56 offen offset:0 lds
    buffer_load_dwordx4 v14, s[36:39], s56 offen offset:1024 lds
    buffer_load_dwordx4 v15, s[36:39], s56 offen offset:2048 lds
    buffer_load_dwordx4 v16, s[36:39], s56 offen offset:3072 lds
    s_barrier
    s_lshr_b32 s58, s48, 1
    s_lshl_b32 s58, s58, 4
    s_add_u32 s58, s58, s45
    s_lshr_b32 s57, s58, 6
    s_lshr_b32 s59, s24, s57
    s_and_b32 s59, s59, 1
    s_add_u32 s57, s57, s59
    s_lshl_b32 s57, s57, 6
    s_add_u32 s58, s58, s57
    s_lshl_b32 s58, s58, 7
    s_atomic_add s60, s[26:27], s58 offset:16
    s_atomic_add s60, s[26:27], s58 offset:528
    s_atomic_add s60, s[26:27], s58 offset:1040
    s_atomic_add s60, s[26:27], s58 offset:1552
    s_add_u32 m0, s63, 16384
    s_add_u32 s56, s13, 0
    buffer_load_dwordx4 v13, s[36:39], s56 offen offset:0 lds
    buffer_load_dwordx4 v14, s[36:39], s56 offen offset:1024 lds
    buffer_load_dwordx4 v15, s[36:39], s56 offen offset:2048 lds
    buffer_load_dwordx4 v16, s[36:39], s56 offen offset:3072 lds
    s_waitcnt vmcnt(8)
L_jv_25:
    s_barrier
    s_add_u32 m0, s63, 32768
    s_add_u32 s56, s14, 0
    buffer_load_dwordx4 v13, s[36:39], s56 offen offset:0 lds
    buffer_load_dwordx4 v14, s[36:39], s56 offen offset:1024 lds
    buffer_load_dwordx4 v15, s[36:39], s56 offen offset:2048 lds
    buffer_load_dwordx4 v16, s[36:39], s56 offen offset:3072 lds
    s_add_u32 m0, s63, 49152
    s_add_u32 s56, s15, 0
    buffer_load_dwordx4 v13, s[36:39], s56 offen offset:0 lds
    buffer_load_dwordx4 v14, s[36:39], s56 offen offset:1024 lds
    buffer_load_dwordx4 v15, s[36:39], s56 offen offset:2048 lds
    buffer_load_dwordx4 v16, s[36:39], s56 offen offset:3072 lds
    s_add_u32 m0, s63, 65536
    s_add_u32 s56, s12, 128
    buffer_load_dwordx4 v13, s[36:39], s56 offen offset:0 lds
    buffer_load_dwordx4 v14, s[36:39], s56 offen offset:1024 lds
    buffer_load_dwordx4 v15, s[36:39], s56 offen offset:2048 lds
    buffer_load_dwordx4 v16, s[36:39], s56 offen offset:3072 lds
    s_add_u32 m0, s63, 81920
    s_add_u32 s56, s13, 128
    buffer_load_dwordx4 v13, s[36:39], s56 offen offset:0 lds
    buffer_load_dwordx4 v14, s[36:39], s56 offen offset:1024 lds
    buffer_load_dwordx4 v15, s[36:39], s56 offen offset:2048 lds
    buffer_load_dwordx4 v16, s[36:39], s56 offen offset:3072 lds
    s_add_u32 m0, s63, 98304
    s_add_u32 s56, s14, 128
    buffer_load_dwordx4 v13, s[36:39], s56 offen offset:0 lds
    buffer_load_dwordx4 v14, s[36:39], s56 offen offset:1024 lds
    buffer_load_dwordx4 v15, s[36:39], s56 offen offset:2048 lds
    buffer_load_dwordx4 v16, s[36:39], s56 offen offset:3072 lds
    s_lshl_b32 s10, s52, 4
    s_add_u32 s10, s10, s53
    s_lshr_b32 s57, s10, 6
    s_lshr_b32 s59, s24, s57
    s_and_b32 s59, s59, 1
    s_add_u32 s57, s57, s59
    s_lshl_b32 s57, s57, 6
    s_add_u32 s10, s10, s57
    s_lshl_b32 s10, s10, 7
    s_add_u32 s10, s10, 16
    s_cmp_eq_u32 s44, 5
    s_cbranch_scc0 L_ow_28
    s_load_dword s61, s[26:27], s10 glc
L_ow_28:
    s_add_u32 m0, s63, 114688
    s_add_u32 s56, s15, 128
    buffer_load_dwordx4 v13, s[36:39], s56 offen offset:0 lds
    buffer_load_dwordx4 v14, s[36:39], s56 offen offset:1024 lds
    buffer_load_dwordx4 v15, s[36:39], s56 offen offset:2048 lds
    buffer_load_dwordx4 v16, s[36:39], s56 offen offset:3072 lds
    s_cmp_lg_u32 s49, 3
    s_cbranch_scc0 L_csi_29
    s_cmp_eq_u32 s44, 5
    s_cbranch_scc0 L_ow_30
    s_mov_b32 s59, 0x40000
L_psp_32:
    s_waitcnt lgkmcnt(0)
    s_cmp_ge_u32 s61, 16
    s_cbranch_scc1 L_pok_31
    s_load_dword s61, s[26:27], s10 glc
    s_sub_u32 s59, s59, 1
    s_cbranch_scc0 L_psp_32
    s_waitcnt lgkmcnt(0)
L_pok_31:
L_ow_30:
L_csi_29:
    s_barrier
    s_lshl_b32 s4, s45, 15
    s_lshl_b32 s56, s49, 7
    s_add_u32 s4, s4, s56
    s_mov_b32 s32, s8
    s_and_b32 s33, s9, 0xffff
    s_mov_b32 s34, 524288
    s_mov_b32 s35, 0x20000
    s_mov_b32 s40, s18
    s_and_b32 s41, s19, 0xffff
    s_mov_b32 s42, 1835008
    s_mov_b32 s43, 0x20000
    s_add_u32 s10, s10, 20
    s_and_b32 s56, s48, 1
    s_lshl_b32 s57, s56, 17
    s_add_u32 s7, s4, s57
    s_add_u32 s4, s7, s57
    s_bfe_u32 s56, s48, 0x10001
    s_lshl_b32 s56, s56, 17
    s_add_u32 s4, s4, s56
    s_bfe_u32 s12, s48, 0x20001
    s_lshl_b32 s12, s12, 19
    s_lshl_b32 s13, s45, 18
    s_add_u32 s13, s13, s12
    s_add_u32 s13, s13, 0
    s_cmp_ge_u32 s13, 1835008
    s_cselect_b32 s57, 1835008, 0
    s_sub_u32 s13, s13, s57
    s_andn2_b32 s57, 1, s48
    s_lshl_b32 s57, s57, 10
    s_add_u32 s57, s57, s49
    s_lshl_b32 s57, s57, 7
    s_add_u32 s13, s13, s57
    s_lshl_b32 s14, s45, 18
    s_add_u32 s14, s14, s12
    s_add_u32 s14, s14, 1048576
    s_cmp_ge_u32 s14, 1835008
    s_cselect_b32 s57, 1835008, 0
    s_sub_u32 s14, s14, s57
    s_andn2_b32 s57, 1, s48
    s_lshl_b32 s57, s57, 10
    s_add_u32 s57, s57, s49
    s_lshl_b32 s57, s57, 7
    s_add_u32 s14, s14, s57
    s_cmp_eq_u32 s45, 3
    s_cselect_b32 s14, 0x40000000, s14
    s_cmp_eq_u32 s51, 0
    s_cbranch_scc1 L_attg_33
    ds_read_b128 v[64:67], v108 offset:0
    ds_read_b128 v[68:71], v108 offset:8192
    ds_read_b128 v[72:75], v108 offset:1024
    ds_read_b128 v[76:79], v108 offset:2048
    s_branch L_pgo8
L_pg8:
    s_setpc_b64 s[58:59]
L_pgo8:
    ds_read_b128 v[80:83], v108 offset:3072
    ds_read_b128 v[84:87], v108 offset:4096
    ds_read_b128 v[88:91], v108 offset:5120
    ds_read_b128 v[92:95], v108 offset:6144
    ds_read_b128 v[96:99], v108 offset:7168
    s_waitcnt lgkmcnt(8)
    v_mfma_f32_32x32x16_bf16 v[144:159], v[64:67], v[20:23], 0
    s_waitcnt lgkmcnt(7)
    v_mfma_f32_32x32x16_bf16 v[128:143], v[68:71], v[20:23], 0
    s_nop 11
    v_cndmask_b32 v128, v144, v128, s[64:65]
    v_cndmask_b32 v129, v145, v129, s[66:67]
    v_cndmask_b32 v130, v146, v130, s[68:69]
    v_cndmask_b32 v131, v147, v131, s[70:71]
    v_cndmask_b32 v132, v148, v132, s[72:73]
    v_cndmask_b32 v133, v149, v133, s[74:75]
    s_waitcnt lgkmcnt(0)
    v_cndmask_b32 v134, v150, v134, s[76:77]
    v_cndmask_b32 v135, v151, v135, s[78:79]
    v_cndmask_b32 v136, v152, v136, s[80:81]
    v_cndmask_b32 v137, v153, v137, s[82:83]
    v_cndmask_b32 v138, v154, v138, s[84:85]
    v_cndmask_b32 v139, v155, v139, s[86:87]
    v_cndmask_b32 v140, v156, v140, s[88:89]
    v_cndmask_b32 v141, v157, v141, s[90:91]
    v_cndmask_b32 v142, v158, v142, s[92:93]
    v_cndmask_b32 v143, v159, v143, s[94:95]
    v_max_f32 v100, v128, v129
    v_max_f32 v101, v130, v131
    v_max3_f32 v100, v132, v133, v100
    v_max3_f32 v101, v134, v135, v101
    v_max3_f32 v100, v136, v137, v100
    v_max3_f32 v101, v138, v139, v101
    v_max3_f32 v100, v140, v141, v100
    v_max3_f32 v101, v142, v143, v101
    v_max_f32 v100, v100, v101
    v_mov_b32 v101, v100
    s_nop 1
    v_permlane32_swap_b32 v100, v101
    s_nop 0
    v_max_f32 v100, v100, v101
    v_sub_f32 v112, 0, v100
    v_mov_b32 v113, v112
    v_mov_b32 v114, v112
    v_mov_b32 v115, v112
    v_mov_b32 v116, v112
    v_mov_b32 v117, v112
    v_mov_b32 v118, v112
    v_mov_b32 v119, v112
    v_mov_b32 v120, v112
    v_mov_b32 v121, v112
    v_mov_b32 v122, v112
    v_mov_b32 v123, v112
    v_mov_b32 v124, v112
    v_mov_b32 v125, v112
    v_mov_b32 v126, v112
    v_mov_b32 v127, v112
    s_waitcnt vmcnt(16)
    s_cmp_lg_u32 s49, 3
    s_cbranch_scc1 L_nw_36
    s_waitcnt vmcnt(0)
L_nw_36:
    s_barrier
    s_setprio 1
    v_add_f32 v128, v128, v112
    v_add_f32 v129, v129, v113
    v_mfma_f32_32x32x16_bf16 v[144:159], v[72:75], v[20:23], v[112:127]
    v_add_f32 v130, v130, v114
    v_add_f32 v131, v131, v115
    v_add_f32 v132, v132, v116
    v_add_f32 v133, v133, v117
    v_add_f32 v134, v134, v118
    v_add_f32 v135, v135, v119
    v_add_f32 v136, v136, v120
    v_add_f32 v137, v137, v121
    v_add_f32 v138, v138, v122
    v_add_f32 v139, v139, v123
    v_add_f32 v140, v140, v124
    v_add_f32 v141, v141, v125
    v_add_f32 v142, v142, v126
    v_add_f32 v143, v143, v127
    v_exp_f32 v128, v128
    v_exp_f32 v129, v129
    v_exp_f32 v130, v130
    v_exp_f32 v131, v131
    v_exp_f32 v132, v132
    v_exp_f32 v133, v133
    v_exp_f32 v134, v134
    v_exp_f32 v135, v135
    v_exp_f32 v136, v136
    v_exp_f32 v137, v137
    v_exp_f32 v138, v138
    v_exp_f32 v139, v139
    v_exp_f32 v140, v140
    v_exp_f32 v141, v141
    v_exp_f32 v142, v142
    v_exp_f32 v143, v143
    v_cvt_pk_bf16_f32 v200, v128, v129
    v_cvt_pk_bf16_f32 v201, v130, v131
    v_cvt_pk_bf16_f32 v202, v132, v133
    v_cvt_pk_bf16_f32 v203, v134, v135
    v_cvt_pk_bf16_f32 v204, v136, v137
    v_cvt_pk_bf16_f32 v205, v138, v139
    v_cvt_pk_bf16_f32 v206, v140, v141
    v_cvt_pk_bf16_f32 v207, v142, v143
    v_mov_b32 v128, 0x3f803f80
    v_mov_b32 v129, v128
    v_mov_b32 v130, v128
    v_mov_b32 v131, v128
    v_mov_b32 v132, v128
    v_mov_b32 v133, v128
    v_mov_b32 v134, v128
    v_mov_b32 v135, v128
    s_mov_b64 exec, s[96:97]
    ds_read_b128 v[48:51], v109 offset:8192
    ds_read_b128 v[52:55], v109 offset:8704
    ds_read_b128 v[56:59], v109 offset:0
    ds_read_b128 v[60:63], v109 offset:512
    s_mov_b64 exec, -1
    v_and_b32 v192, v200, v24
    v_and_b32 v193, v201, v25
    v_and_b32 v194, v202, v26
    v_and_b32 v195, v203, v27
    v_and_b32 v196, v204, v28
    v_and_b32 v197, v205, v29
    v_and_b32 v198, v206, v30
    v_and_b32 v199, v207, v31
    v_xor_b32 v200, v200, v192
    v_xor_b32 v201, v201, v193
    v_xor_b32 v202, v202, v194
    v_xor_b32 v203, v203, v195
    v_xor_b32 v204, v204, v196
    v_xor_b32 v205, v205, v197
    v_xor_b32 v206, v206, v198
    v_xor_b32 v207, v207, v199
    v_mfma_f32_32x32x16_bf16 v[160:175], v[76:79], v[20:23], v[112:127]
    v_exp_f32 v144, v144
    s_mov_b64 exec, s[96:97]
    ds_read_b128 v[128:131], v109 offset:1024
    ds_read_b128 v[132:135], v109 offset:1536
    s_mov_b64 exec, -1
    v_exp_f32 v145, v145
    v_exp_f32 v146, v146
    v_exp_f32 v147, v147
    s_waitcnt lgkmcnt(4)
    v_mfma_f32_32x32x16_bf16 v[32:47], v[48:51], v[192:195], 0
    v_exp_f32 v148, v148
    v_exp_f32 v149, v149
    v_exp_f32 v150, v150
    v_exp_f32 v151, v151
    v_mfma_f32_32x32x16_bf16 v[32:47], v[52:55], v[196:199], v[32:47]
    v_exp_f32 v152, v152
    v_exp_f32 v153, v153
    v_exp_f32 v154, v154
    v_exp_f32 v155, v155
    s_waitcnt lgkmcnt(2)
    v_mfma_f32_32x32x16_bf16 v[32:47], v[56:59], v[200:203], v[32:47]
    v_exp_f32 v156, v156
    v_exp_f32 v157, v157
    v_exp_f32 v158, v158
    v_exp_f32 v159, v159
    v_mfma_f32_32x32x16_bf16 v[32:47], v[60:63], v[204:207], v[32:47]
    v_cvt_pk_bf16_f32 v184, v144, v145
    v_cvt_pk_bf16_f32 v185, v146, v147
    v_cvt_pk_bf16_f32 v186, v148, v149
    v_cvt_pk_bf16_f32 v187, v150, v151
    v_cvt_pk_bf16_f32 v188, v152, v153
    v_cvt_pk_bf16_f32 v189, v154, v155
    v_cvt_pk_bf16_f32 v190, v156, v157
    v_cvt_pk_bf16_f32 v191, v158, v159
    v_mfma_f32_32x32x16_bf16 v[144:159], v[80:83], v[20:23], v[112:127]
    v_exp_f32 v160, v160
    s_mov_b64 exec, s[96:97]
    ds_read_b128 v[48:51], v109 offset:2048
    ds_read_b128 v[52:55], v109 offset:2560
    s_mov_b64 exec, -1
    v_exp_f32 v161, v161
    v_exp_f32 v162, v162
    v_exp_f32 v163, v163
    v_exp_f32 v164, v164
    v_exp_f32 v165, v165
    s_waitcnt lgkmcnt(2)
    v_mfma_f32_32x32x16_bf16 v[32:47], v[128:131], v[184:187], v[32:47]
    v_exp_f32 v166, v166
    v_exp_f32 v167, v167
    v_exp_f32 v168, v168
    v_exp_f32 v169, v169
    v_exp_f32 v170, v170
    v_exp_f32 v171, v171
    v_mfma_f32_32x32x16_bf16 v[32:47], v[132:135], v[188:191], v[32:47]
    v_exp_f32 v172, v172
    v_exp_f32 v173, v173
    v_exp_f32 v174, v174
    v_exp_f32 v175, v175
    v_cvt_pk_bf16_f32 v176, v160, v161
    v_cvt_pk_bf16_f32 v177, v162, v163
    v_cvt_pk_bf16_f32 v178, v164, v165
    v_cvt_pk_bf16_f32 v179, v166, v167
    v_cvt_pk_bf16_f32 v180, v168, v169
    v_cvt_pk_bf16_f32 v181, v170, v171
    v_cvt_pk_bf16_f32 v182, v172, v173
    v_cvt_pk_bf16_f32 v183, v174, v175
    v_mfma_f32_32x32x16_bf16 v[160:175], v[84:87], v[20:23], v[112:127]
    v_exp_f32 v144, v144
    s_mov_b64 exec, s[96:97]
    ds_read_b128 v[56:59], v109 offset:3072
    ds_read_b128 v[60:63], v109 offset:3584
    s_mov_b64 exec, -1
    v_exp_f32 v145, v145
    v_exp_f32 v146, v146
    v_exp_f32 v147, v147
    v_exp_f32 v148, v148
    v_exp_f32 v149, v149
    s_waitcnt lgkmcnt(2)
    v_mfma_f32_32x32x16_bf16 v[32:47], v[48:51], v[176:179], v[32:47]
    v_exp_f32 v150, v150
    v_exp_f32 v151, v151
    v_exp_f32 v152, v152
    v_exp_f32 v153, v153
    v_exp_f32 v154, v154
    v_exp_f32 v155, v155
    v_mfma_f32_32x32x16_bf16 v[32:47], v[52:55], v[180:183], v[32:47]
    v_exp_f32 v156, v156
    v_exp_f32 v157, v157
    v_exp_f32 v158, v158
    v_exp_f32 v159, v159
    v_cvt_pk_bf16_f32 v184, v144, v145
    v_cvt_pk_bf16_f32 v185, v146, v147
    v_cvt_pk_bf16_f32 v186, v148, v149
    v_cvt_pk_bf16_f32 v187, v150, v151
    v_cvt_pk_bf16_f32 v188, v152, v153
    v_cvt_pk_bf16_f32 v189, v154, v155
    v_cvt_pk_bf16_f32 v190, v156, v157
    v_cvt_pk_bf16_f32 v191, v158, v159
    v_mfma_f32_32x32x16_bf16 v[144:159], v[88:91], v[20:23], v[112:127]
    v_exp_f32 v160, v160
    s_mov_b64 exec, s[96:97]
    ds_read_b128 v[128:131], v109 offset:4096
    ds_read_b128 v[132:135], v109 offset:4608
    s_mov_b64 exec, -1
    v_exp_f32 v161, v161
    v_exp_f32 v162, v162
    v_exp_f32 v163, v163
    v_exp_f32 v164, v164
    v_exp_f32 v165, v165
    s_waitcnt lgkmcnt(2)
    v_mfma_f32_32x32x16_bf16 v[32:47], v[56:59], v[184:187], v[32:47]
    v_exp_f32 v166, v166
    v_exp_f32 v167, v167
    v_exp_f32 v168, v168
    v_exp_f32 v169, v169
    v_exp_f32 v170, v170
    v_exp_f32 v171, v171
    v_mfma_f32_32x32x16_bf16 v[32:47], v[60:63], v[188:191], v[32:47]
    v_exp_f32 v172, v172
    v_exp_f32 v173, v173
    v_exp_f32 v174, v174
    v_exp_f32 v175, v175
    v_cvt_pk_bf16_f32 v176, v160, v161
    v_cvt_pk_bf16_f32 v177, v162, v163
    v_cvt_pk_bf16_f32 v178, v164, v165
    v_cvt_pk_bf16_f32 v179, v166, v167
    v_cvt_pk_bf16_f32 v180, v168, v169
    v_cvt_pk_bf16_f32 v181, v170, v171
    v_cvt_pk_bf16_f32 v182, v172, v173
    v_cvt_pk_bf16_f32 v183, v174, v175
    s_waitcnt vmcnt(0)
    s_barrier
    v_mfma_f32_32x32x16_bf16 v[160:175], v[92:95], v[20:23], v[112:127]
    v_exp_f32 v144, v144
    s_mov_b64 exec, s[96:97]
    ds_read_b128 v[48:51], v109 offset:5120
    ds_read_b128 v[52:55], v109 offset:5632
    s_mov_b64 exec, -1
    v_exp_f32 v145, v145
    v_exp_f32 v146, v146
    v_exp_f32 v147, v147
    v_exp_f32 v148, v148
    v_exp_f32 v149, v149
    s_waitcnt lgkmcnt(2)
    v_mfma_f32_32x32x16_bf16 v[32:47], v[128:131], v[176:179], v[32:47]
    v_exp_f32 v150, v150
    v_exp_f32 v151, v151
    v_exp_f32 v152, v152
    v_exp_f32 v153, v153
    v_exp_f32 v154, v154
    v_exp_f32 v155, v155
    v_mfma_f32_32x32x16_bf16 v[32:47], v[132:135], v[180:183], v[32:47]
    v_exp_f32 v156, v156
    v_exp_f32 v157, v157
    v_exp_f32 v158, v158
    v_exp_f32 v159, v159
    v_cvt_pk_bf16_f32 v184, v144, v145
    v_cvt_pk_bf16_f32 v185, v146, v147
    v_cvt_pk_bf16_f32 v186, v148, v149
    v_cvt_pk_bf16_f32 v187, v150, v151
    v_cvt_pk_bf16_f32 v188, v152, v153
    v_cvt_pk_bf16_f32 v189, v154, v155
    v_cvt_pk_bf16_f32 v190, v156, v157
    v_cvt_pk_bf16_f32 v191, v158, v159
    v_mfma_f32_32x32x16_bf16 v[144:159], v[96:99], v[20:23], v[112:127]
    v_exp_f32 v160, v160
    s_mov_b64 exec, s[96:97]
    ds_read_b128 v[56:59], v109 offset:6144
    ds_read_b128 v[60:63], v109 offset:6656
    s_mov_b64 exec, -1
    v_exp_f32 v161, v161
    v_exp_f32 v162, v162
    v_exp_f32 v163, v163
    v_exp_f32 v164, v164
    v_exp_f32 v165, v165
    s_waitcnt lgkmcnt(2)
    v_mfma_f32_32x32x16_bf16 v[32:47], v[48:51], v[184:187], v[32:47]
    v_exp_f32 v166, v166
    v_exp_f32 v167, v167
    v_exp_f32 v168, v168
    v_exp_f32 v169, v169
    v_exp_f32 v170, v170
    v_exp_f32 v171, v171
    v_mfma_f32_32x32x16_bf16 v[32:47], v[52:55], v[188:191], v[32:47]
    v_exp_f32 v172, v172
    v_exp_f32 v173, v173
    v_exp_f32 v174, v174
    v_exp_f32 v175, v175
    v_cvt_pk_bf16_f32 v176, v160, v161
    v_cvt_pk_bf16_f32 v177, v162, v163
    v_cvt_pk_bf16_f32 v178, v164, v165
    v_cvt_pk_bf16_f32 v179, v166, v167
    v_cvt_pk_bf16_f32 v180, v168, v169
    v_cvt_pk_bf16_f32 v181, v170, v171
    v_cvt_pk_bf16_f32 v182, v172, v173
    v_cvt_pk_bf16_f32 v183, v174, v175
    v_exp_f32 v144, v144
    s_mov_b64 exec, s[96:97]
    ds_read_b128 v[128:131], v109 offset:7168
    ds_read_b128 v[132:135], v109 offset:7680
    s_mov_b64 exec, -1
    v_exp_f32 v145, v145
    v_exp_f32 v146, v146
    v_exp_f32 v147, v147
    v_exp_f32 v148, v148
    v_exp_f32 v149, v149
    s_waitcnt lgkmcnt(2)
    v_mfma_f32_32x32x16_bf16 v[32:47], v[56:59], v[176:179], v[32:47]
    v_exp_f32 v150, v150
    v_exp_f32 v151, v151
    v_exp_f32 v152, v152
    v_exp_f32 v153, v153
    v_exp_f32 v154, v154
    v_exp_f32 v155, v155
    v_mfma_f32_32x32x16_bf16 v[32:47], v[60:63], v[180:183], v[32:47]
    v_exp_f32 v156, v156
    v_exp_f32 v157, v157
    v_exp_f32 v158, v158
    v_exp_f32 v159, v159
    v_cvt_pk_bf16_f32 v184, v144, v145
    v_cvt_pk_bf16_f32 v185, v146, v147
    v_cvt_pk_bf16_f32 v186, v148, v149
    v_cvt_pk_bf16_f32 v187, v150, v151
    v_cvt_pk_bf16_f32 v188, v152, v153
    v_cvt_pk_bf16_f32 v189, v154, v155
    v_cvt_pk_bf16_f32 v190, v156, v157
    v_cvt_pk_bf16_f32 v191, v158, v159
    s_waitcnt lgkmcnt(0)
    v_mfma_f32_32x32x16_bf16 v[32:47], v[128:131], v[184:187], v[32:47]
    s_lshl_b32 s56, s51, 3
    s_add_u32 s56, s56, s44
    s_lshl_b32 s56, s56, 5
    s_add_u32 s56, s56, s50
    v_mfma_f32_32x32x16_bf16 v[32:47], v[132:135], v[188:191], v[32:47]
    s_lshl_b32 s56, s56, 10
    s_add_u32 s56, s56, 27262976
    s_andn2_b32 s59, s56, 0x1fff
    s_add_u32 s56, s56, s59
    s_andn2_b32 s59, s56, 0x1fffff
    s_add_u32 s56, s56, s59
    s_add_u32 s56, s56, s25
    s_nop 4
    v_mov_b32 v41, 0x67800000
L_attj_34:
    v_cmp_nle_f32 vcc, v40, v41
    s_cbranch_vccnz L_redo_101021
L_attr_35:
    v_rcp_f32 v40, v40
    s_nop 0
    v_mul_f32 v32, v32, v40
    v_mul_f32 v33, v33, v40
    v_mul_f32 v34, v34, v40
    v_mul_f32 v35, v35, v40
    v_mul_f32 v36, v36, v40
    v_mul_f32 v37, v37, v40
    v_mul_f32 v38, v38, v40
    v_mul_f32 v39, v39, v40
    v_cvt_pk_bf16_f32 v24, v32, v33
    v_cvt_pk_bf16_f32 v25, v34, v35
    v_cvt_pk_bf16_f32 v26, v36, v37
    v_cvt_pk_bf16_f32 v27, v38, v39
    buffer_store_dwordx4 v[24:27], v2, s[28:31], s56 offen sc1
    s_setprio 0
    s_barrier
    s_cmp_eq_u32 s44, 5
    s_cbranch_scc0 L_ow_2061
    s_cmp_lg_u32 s49, 3
    s_cbranch_scc0 L_nocs_2062
    s_load_dword s61, s[26:27], s10 glc
    s_mov_b32 s59, 0x40000
L_psp_2064:
    s_waitcnt lgkmcnt(0)
    s_cmp_ge_u32 s61, 4
    s_cbranch_scc1 L_pok_2063
    s_load_dword s61, s[26:27], s10 glc
    s_sub_u32 s59, s59, 1
    s_cbranch_scc0 L_psp_2064
    s_waitcnt lgkmcnt(0)
L_pok_2063:
    s_mov_b32 m0, 133120
    s_lshl_b32 s56, s53, 9
    s_add_u32 s56, s56, 13369344
    s_mov_b32 exec_hi, 0
    buffer_load_dwordx4 v2, s[28:31], s56 offen sc1 lds
    s_mov_b32 exec_hi, -1
L_nocs_2062:
L_ow_2061:
    s_add_u32 m0, s20, 147456
    s_xor_b32 s56, s4, 0
    buffer_load_dwordx4 v4, s[32:35], s56 offen offset:0  lds
    buffer_load_dwordx4 v5, s[32:35], s56 offen offset:1024  lds
    s_xor_b32 m0, m0, 2048
    s_nop 0
    buffer_load_dwordx4 v6, s[32:35], s56 offen offset:0  lds
    buffer_load_dwordx4 v7, s[32:35], s56 offen offset:1024  lds
    s_lshl_b32 s10, s48, 3
    s_add_u32 s10, s10, s49
    s_lshr_b32 s57, s10, 6
    s_lshr_b32 s59, s24, s57
    s_and_b32 s59, s59, 1
    s_add_u32 s57, s57, s59
    s_lshl_b32 s57, s57, 6
    s_add_u32 s10, s10, s57
    s_lshl_b32 s10, s10, 7
    s_add_u32 s10, s10, 4
    s_barrier
    s_waitcnt vmcnt(4)
    s_barrier
    s_lshl_b32 s58, s51, 2
    s_lshr_b32 s59, s50, 4
    s_add_u32 s58, s58, s59
    s_lshl_b32 s58, s58, 3
    s_add_u32 s58, s58, s45
    s_lshr_b32 s57, s58, 6
    s_lshr_b32 s59, s24, s57
    s_and_b32 s59, s59, 1
    s_add_u32 s57, s57, s59
    s_lshl_b32 s57, s57, 6
    s_add_u32 s58, s58, s57
    s_lshl_b32 s58, s58, 7
    s_atomic_add s60, s[26:27], s58 offset:4
    s_atomic_add s60, s[26:27], s58 offset:516
    s_atomic_add s60, s[26:27], s58 offset:2052
    s_atomic_add s60, s[26:27], s58 offset:2564
    s_add_u32 m0, s20, 0
    s_xor_b32 s56, s4, 131072
    buffer_load_dwordx4 v4, s[32:35], s56 offen offset:0  lds
    buffer_load_dwordx4 v5, s[32:35], s56 offen offset:1024  lds
    s_xor_b32 m0, m0, 2048
    s_nop 0
    buffer_load_dwordx4 v6, s[32:35], s56 offen offset:0  lds
    buffer_load_dwordx4 v7, s[32:35], s56 offen offset:1024  lds
    s_add_u32 m0, s20, 16384
    s_add_u32 s56, s12, 0
    s_cmp_ge_u32 s56, 1835008
    s_cselect_b32 s57, 1835008, 0
    s_sub_u32 s56, s56, s57
    s_add_u32 s56, s56, s7
    buffer_load_dwordx4 v4, s[40:43], s56 offen offset:0  lds
    buffer_load_dwordx4 v5, s[40:43], s56 offen offset:1024  lds
    s_xor_b32 m0, m0, 2048
    s_nop 0
    buffer_load_dwordx4 v6, s[40:43], s56 offen offset:0  lds
    buffer_load_dwordx4 v7, s[40:43], s56 offen offset:1024  lds
    s_add_u32 m0, s20, 32768
    s_add_u32 s56, s12, 262144
    s_cmp_ge_u32 s56, 1835008
    s_cselect_b32 s57, 1835008, 0
    s_sub_u32 s56, s56, s57
    s_add_u32 s56, s56, s7
    buffer_load_dwordx4 v4, s[40:43], s56 offen offset:0  lds
    buffer_load_dwordx4 v5, s[40:43], s56 offen offset:1024  lds
    s_xor_b32 m0, m0, 2048
    s_nop 0
    buffer_load_dwordx4 v6, s[40:43], s56 offen offset:0  lds
    buffer_load_dwordx4 v7, s[40:43], s56 offen offset:1024  lds
    s_add_u32 m0, s20, 49152
    s_add_u32 s56, s12, 524288
    s_cmp_ge_u32 s56, 1835008
    s_cselect_b32 s57, 1835008, 0
    s_sub_u32 s56, s56, s57
    s_add_u32 s56, s56, s7
    buffer_load_dwordx4 v4, s[40:43], s56 offen offset:0  lds
    buffer_load_dwordx4 v5, s[40:43], s56 offen offset:1024  lds
    s_xor_b32 m0, m0, 2048
    s_nop 0
    buffer_load_dwordx4 v6, s[40:43], s56 offen offset:0  lds
    buffer_load_dwordx4 v7, s[40:43], s56 offen offset:1024  lds
    v_lshrrev_b32 v40, 5, v1
    v_bfe_u32 v41, v1, 2, 2
    v_lshl_add_u32 v41, v40, 2, v41
    v_lshlrev_b32 v20, 7, v41
    v_bfe_u32 v41, v1, 3, 1
    v_xor_b32 v41, s47, v41
    v_lshl_add_u32 v20, v41, 6, v20
    v_bfe_u32 v41, v1, 4, 1
    v_lshl_add_u32 v20, v41, 5, v20
    v_and_b32 v41, 3, v1
    v_lshl_add_u32 v20, v41, 3, v20
    s_lshl_b32 s56, s47, 11
    v_add_u32 v20, s56, v20
    v_xor_b32 v21, 64, v20
    v_add_u32 v22, 0x20000, v20
    v_add_u32 v23, 0x20000, v21
    s_lshr_b32 s59, s48, 1
    s_and_b32 s59, s59, 3
    s_lshl_b32 s68, s59, 16
    s_add_u32 s69, s68, 32768
    s_cmp_eq_u32 s69, 229376
    s_cselect_b32 s69, 0, s69
    s_add_u32 s70, s69, 32768
    s_cmp_eq_u32 s70, 229376
    s_cselect_b32 s70, 0, s70
    s_add_u32 s71, s70, 32768
    s_cmp_eq_u32 s71, 229376
    s_cselect_b32 s71, 0, s71
    s_add_u32 s72, s71, 32768
    s_cmp_eq_u32 s72, 229376
    s_cselect_b32 s72, 0, s72
    s_add_u32 s73, s72, 32768
    s_cmp_eq_u32 s73, 229376
    s_cselect_b32 s73, 0, s73
    s_add_u32 s74, s73, 32768
    s_cmp_eq_u32 s74, 229376
    s_cselect_b32 s74, 0, s74
    s_xor_b32 s59, s48, 1
    s_lshl_b32 s59, s59, 1
    s_add_u32 s59, s59, s46
    s_lshl_b32 s75, s59, 17
    s_and_b32 s57, s48, 1
    s_lshl_b32 s57, s57, 3
    s_add_u32 s57, s57, s47
    s_lshl_b32 s57, s57, 10
    s_add_u32 s75, s75, s57
    s_add_u32 s75, s75, 41943040
    s_andn2_b32 s59, s75, 0x1fff
    s_add_u32 s75, s75, s59
    s_andn2_b32 s59, s75, 0x1fffff
    s_add_u32 s75, s75, s59
    s_add_u32 s75, s75, s25
    s_add_u32 s76, s75, 4096
    s_xor_b32 s59, s75, 16384
    s_add_u32 s77, s59, 6144
    s_xor_b32 s59, s48, 1
    s_lshl_b32 s59, s59, 1
    s_add_u32 s59, s59, s46
    s_lshl_b32 s59, s59, 1
    s_and_b32 s57, s48, 1
    s_add_u32 s59, s59, s57
    s_lshl_b32 s78, s59, 1
    s_bfe_u32 s57, s48, 0x10001
    s_add_u32 s59, s78, s57
    s_lshl_b32 s59, s59, 3
    s_add_u32 s59, s59, s47
    s_lshl_b32 s59, s59, 10
    s_add_u32 s78, s59, 27262976
    s_andn2_b32 s59, s78, 0x1fff
    s_add_u32 s78, s78, s59
    s_andn2_b32 s59, s78, 0x1fffff
    s_add_u32 s78, s78, s59
    s_add_u32 s78, s78, s25
    s_xor_b32 s79, s78, 16384
    s_xor_b32 s59, s48, 1
    s_lshl_b32 s59, s59, 1
    s_add_u32 s59, s59, s46
    s_and_b32 s80, s59, 3
    s_lshr_b32 s59, s48, 1
    s_lshl_b32 s59, s59, 3
    s_add_u32 s59, s59, s49
    s_lshl_b32 s59, s59, 2
    s_add_u32 s59, s59, s80
    s_lshl_b32 s59, s59, 7
    s_add_u32 s80, s59, 13238272
    s_barrier
    s_load_dword s61, s[26:27], s10 glc
    s_add_u32 m0, s20, 65536
    s_add_u32 s56, s12, 786432
    s_cmp_ge_u32 s56, 1835008
    s_cselect_b32 s57, 1835008, 0
    s_sub_u32 s56, s56, s57
    s_add_u32 s56, s56, s7
    buffer_load_dwordx4 v4, s[40:43], s56 offen offset:0  lds
    buffer_load_dwordx4 v5, s[40:43], s56 offen offset:1024  lds
    s_xor_b32 m0, m0, 2048
    s_nop 0
    buffer_load_dwordx4 v6, s[40:43], s56 offen offset:0  lds
    buffer_load_dwordx4 v7, s[40:43], s56 offen offset:1024  lds
    s_add_u32 m0, s20, 81920
    s_add_u32 s56, s12, 1048576
    s_cmp_ge_u32 s56, 1835008
    s_cselect_b32 s57, 1835008, 0
    s_sub_u32 s56, s56, s57
    s_add_u32 s56, s56, s7
    buffer_load_dwordx4 v4, s[40:43], s56 offen offset:0  lds
    buffer_load_dwordx4 v5, s[40:43], s56 offen offset:1024  lds
    s_xor_b32 m0, m0, 2048
    s_nop 0
    buffer_load_dwordx4 v6, s[40:43], s56 offen offset:0  lds
    buffer_load_dwordx4 v7, s[40:43], s56 offen offset:1024  lds
    s_mov_b32 s59, 0x40000
L_psp_2066:
    s_waitcnt lgkmcnt(0)
    s_cmp_ge_u32 s61, 16
    s_cbranch_scc1 L_pok_2065
    s_load_dword s61, s[26:27], s10 glc
    s_sub_u32 s59, s59, 1
    s_cbranch_scc0 L_psp_2066
    s_waitcnt lgkmcnt(0)
L_pok_2065:
    s_lshl_b32 s10, s48, 3
    s_add_u32 s10, s10, s49
    s_lshr_b32 s57, s10, 6
    s_lshr_b32 s59, s24, s57
    s_and_b32 s59, s59, 1
    s_add_u32 s57, s57, s59
    s_lshl_b32 s57, s57, 6
    s_add_u32 s10, s10, s57
    s_lshl_b32 s10, s10, 7
    s_add_u32 s10, s10, 20
    s_barrier
    s_cmp_lg_u32 s49, 3
    s_cbranch_scc0 L_idle_2067
    s_lshl_b32 s58, s52, 1
    s_and_b32 s59, s53, 1
    s_add_u32 s58, s58, s59
    s_lshl_b32 s58, s58, 3
    s_add_u32 s58, s58, s45
    s_lshr_b32 s57, s58, 6
    s_lshr_b32 s59, s24, s57
    s_and_b32 s59, s59, 1
    s_add_u32 s57, s57, s59
    s_lshl_b32 s57, s57, 6
    s_add_u32 s58, s58, s57
    s_lshl_b32 s58, s58, 7
    s_atomic_add s60, s[26:27], s58 offset:20
    s_atomic_add s60, s[26:27], s58 offset:532
L_idle_2067:
    s_add_u32 m0, s20, 98304
    s_add_u32 s56, s12, 1310720
    s_cmp_ge_u32 s56, 1835008
    s_cselect_b32 s57, 1835008, 0
    s_sub_u32 s56, s56, s57
    s_add_u32 s56, s56, s7
    buffer_load_dwordx4 v4, s[40:43], s56 offen offset:0  lds
    buffer_load_dwordx4 v5, s[40:43], s56 offen offset:1024  lds
    s_xor_b32 m0, m0, 2048
    s_nop 0
    buffer_load_dwordx4 v6, s[40:43], s56 offen offset:0  lds
    buffer_load_dwordx4 v7, s[40:43], s56 offen offset:1024  lds
    s_add_u32 s81, s78, 0
    buffer_load_dwordx4 v[208:211], v2, s[28:31], s81 offen offset:0 sc1
    s_add_u32 s81, s78, 0
    buffer_load_dwordx4 v[212:215], v2, s[28:31], s81 offen offset:2048 sc1
    s_add_u32 s81, s78, 4096
    buffer_load_dwordx4 v[216:219], v2, s[28:31], s81 offen offset:0 sc1
    s_add_u32 s81, s78, 4096
    buffer_load_dwordx4 v[220:223], v2, s[28:31], s81 offen offset:2048 sc1
    s_barrier
    s_add_u32 m0, s20, 114688
    s_add_u32 s56, s12, 1572864
    s_cmp_ge_u32 s56, 1835008
    s_cselect_b32 s57, 1835008, 0
    s_sub_u32 s56, s56, s57
    s_add_u32 s56, s56, s7
    buffer_load_dwordx4 v4, s[40:43], s56 offen offset:0  lds
    buffer_load_dwordx4 v5, s[40:43], s56 offen offset:1024  lds
    s_xor_b32 m0, m0, 2048
    s_nop 0
    buffer_load_dwordx4 v6, s[40:43], s56 offen offset:0  lds
    buffer_load_dwordx4 v7, s[40:43], s56 offen offset:1024  lds
    s_load_dword s61, s[26:27], s10 glc
    s_add_u32 s81, s79, 0
    buffer_load_dwordx4 v[224:227], v2, s[28:31], s81 offen offset:0 sc1
    s_add_u32 s81, s79, 0
    buffer_load_dwordx4 v[228:231], v2, s[28:31], s81 offen offset:2048 sc1
    s_add_u32 s81, s79, 4096
    buffer_load_dwordx4 v[232:235], v2, s[28:31], s81 offen offset:0 sc1
    s_add_u32 s81, s79, 4096
    buffer_load_dwordx4 v[236:239], v2, s[28:31], s81 offen offset:2048 sc1
    s_waitcnt lgkmcnt(0)
    s_barrier
    s_cmp_lg_u32 s49, 3
    s_cbranch_scc0 L_idle_2068
    s_lshl_b32 s58, s52, 1
    s_and_b32 s59, s53, 1
    s_add_u32 s58, s58, s59
    s_lshl_b32 s58, s58, 3
    s_add_u32 s58, s58, s45
    s_lshr_b32 s57, s58, 6
    s_lshr_b32 s59, s24, s57
    s_and_b32 s59, s59, 1
    s_add_u32 s57, s57, s59
    s_lshl_b32 s57, s57, 6
    s_add_u32 s58, s58, s57
    s_lshl_b32 s58, s58, 7
    s_atomic_add s60, s[26:27], s58 offset:24
    s_atomic_add s60, s[26:27], s58 offset:536
L_idle_2068:
    s_cmp_ge_u32 s61, 7
    s_cbranch_scc1 L_pok_2069
    s_load_dword s61, s[26:27], s10 glc
    s_mov_b32 s59, 0x40000
L_psp_2070:
    s_waitcnt lgkmcnt(0)
    s_cmp_ge_u32 s61, 7
    s_cbranch_scc1 L_pok_2069
    s_load_dword s61, s[26:27], s10 glc
    s_sub_u32 s59, s59, 1
    s_cbranch_scc0 L_psp_2070
    s_waitcnt lgkmcnt(0)
L_pok_2069:
    s_add_u32 s10, s10, 4
    v_and_b32 v19, 31, v1
    v_lshlrev_b32 v19, 2, v19
    buffer_load_dword v14, v19, s[28:31], s80 offen sc1
    s_add_u32 s81, s75, s68
    buffer_load_dwordx4 v[240:243], v2, s[28:31], s81 offen offset:0 sc1
    s_add_u32 s81, s75, s69
    buffer_load_dwordx4 v[244:247], v2, s[28:31], s81 offen offset:0 sc1
    s_add_u32 s81, s75, s70
    buffer_load_dwordx4 v[248:251], v2, s[28:31], s81 offen offset:0 sc1
    s_add_u32 s81, s75, s71
    buffer_load_dwordx4 v[252:255], v2, s[28:31], s81 offen offset:0 sc1
    s_add_u32 s81, s75, s72
    buffer_load_dwordx4 v[112:115], v2, s[28:31], s81 offen offset:0 sc1
    s_add_u32 s81, s75, s73
    s_branch L_pgo9
L_pg9:
    s_setpc_b64 s[58:59]
L_pgo9:
    buffer_load_dwordx4 v[116:119], v2, s[28:31], s81 offen offset:0 sc1
    s_add_u32 s81, s75, s74
    buffer_load_dwordx4 v[120:123], v2, s[28:31], s81 offen offset:0 sc1
    s_waitcnt vmcnt(12)
    s_barrier
    s_cmp_lg_u32 s49, 3
    s_cbranch_scc0 L_idle_2071
    s_lshl_b32 s58, s52, 1
    s_and_b32 s59, s53, 1
    s_add_u32 s58, s58, s59
    s_lshl_b32 s58, s58, 3
    s_add_u32 s58, s58, s45
    s_lshr_b32 s57, s58, 6
    s_lshr_b32 s59, s24, s57
    s_and_b32 s59, s59, 1
    s_add_u32 s57, s57, s59
    s_lshl_b32 s57, s57, 6
    s_add_u32 s58, s58, s57
    s_lshl_b32 s58, s58, 7
    s_atomic_add s60, s[26:27], s58 offset:28
    s_atomic_add s60, s[26:27], s58 offset:540
L_idle_2071:
    s_setprio 1
    ds_read_b64_tr_b16 v[24:25], v22 offset:16384
    ds_read_b64_tr_b16 v[26:27], v22 offset:17408
    ds_read_b64_tr_b16 v[28:29], v23 offset:16384
    ds_read_b64_tr_b16 v[30:31], v23 offset:17408
    ds_read_b64_tr_b16 v[32:33], v22 offset:20480
    ds_read_b64_tr_b16 v[34:35], v22 offset:21504
    ds_read_b64_tr_b16 v[36:37], v23 offset:20480
    ds_read_b64_tr_b16 v[38:39], v23 offset:21504
    s_waitcnt vmcnt(19) lgkmcnt(4)
    v_mfma_f32_32x32x16_bf16 v[48:63], v[24:27], v[208:211], 0
    ds_read_b64_tr_b16 v[40:41], v22 offset:24576
    ds_read_b64_tr_b16 v[42:43], v22 offset:25600
    ds_read_b64_tr_b16 v[44:45], v23 offset:24576
    ds_read_b64_tr_b16 v[46:47], v23 offset:25600
    v_mfma_f32_32x32x16_bf16 v[64:79], v[28:31], v[208:211], 0
    s_waitcnt vmcnt(18) lgkmcnt(4)
    v_mfma_f32_32x32x16_bf16 v[48:63], v[32:35], v[212:215], v[48:63]
    ds_read_b64_tr_b16 v[24:25], v22 offset:28672
    ds_read_b64_tr_b16 v[26:27], v22 offset:29696
    ds_read_b64_tr_b16 v[28:29], v23 offset:28672
    ds_read_b64_tr_b16 v[30:31], v23 offset:29696
    v_mfma_f32_32x32x16_bf16 v[64:79], v[36:39], v[212:215], v[64:79]
    s_waitcnt vmcnt(17) lgkmcnt(4)
    v_mfma_f32_32x32x16_bf16 v[48:63], v[40:43], v[216:219], v[48:63]
    ds_read_b64_tr_b16 v[32:33], v20 offset:0
    ds_read_b64_tr_b16 v[34:35], v20 offset:1024
    ds_read_b64_tr_b16 v[36:37], v21 offset:0
    ds_read_b64_tr_b16 v[38:39], v21 offset:1024
    v_mfma_f32_32x32x16_bf16 v[64:79], v[44:47], v[216:219], v[64:79]
    s_waitcnt vmcnt(16) lgkmcnt(4)
    v_mfma_f32_32x32x16_bf16 v[48:63], v[24:27], v[220:223], v[48:63]
    v_subrev_u32 v22, 0x10000, v22
    v_subrev_u32 v23, 0x10000, v23
    ds_read_b64_tr_b16 v[40:41], v20 offset:4096
    ds_read_b64_tr_b16 v[42:43], v20 offset:5120
    ds_read_b64_tr_b16 v[44:45], v21 offset:4096
    ds_read_b64_tr_b16 v[46:47], v21 offset:5120
    v_mfma_f32_32x32x16_bf16 v[64:79], v[28:31], v[220:223], v[64:79]
    s_load_dword s61, s[26:27], s10 glc
    s_waitcnt vmcnt(11) lgkmcnt(4)
    v_mfma_f32_32x32x16_bf16 v[48:63], v[32:35], v[224:227], v[48:63]
    ds_read_b64_tr_b16 v[24:25], v20 offset:8192
    ds_read_b64_tr_b16 v[26:27], v20 offset:9216
    ds_read_b64_tr_b16 v[28:29], v21 offset:8192
    ds_read_b64_tr_b16 v[30:31], v21 offset:9216
    v_mfma_f32_32x32x16_bf16 v[64:79], v[36:39], v[224:227], v[64:79]
    s_waitcnt vmcnt(10) lgkmcnt(4)
    v_mfma_f32_32x32x16_bf16 v[48:63], v[40:43], v[228:231], v[48:63]
    ds_read_b64_tr_b16 v[32:33], v20 offset:12288
    ds_read_b64_tr_b16 v[34:35], v20 offset:13312
    ds_read_b64_tr_b16 v[36:37], v21 offset:12288
    ds_read_b64_tr_b16 v[38:39], v21 offset:13312
    v_mfma_f32_32x32x16_bf16 v[64:79], v[44:47], v[228:231], v[64:79]
    s_waitcnt vmcnt(9) lgkmcnt(4)
    v_mfma_f32_32x32x16_bf16 v[48:63], v[24:27], v[232:235], v[48:63]
    ds_read_b64_tr_b16 v[40:41], v20 offset:16384
    ds_read_b64_tr_b16 v[42:43], v20 offset:17408
    ds_read_b64_tr_b16 v[44:45], v21 offset:16384
    ds_read_b64_tr_b16 v[46:47], v21 offset:17408
    v_mfma_f32_32x32x16_bf16 v[64:79], v[28:31], v[232:235], v[64:79]
    s_waitcnt vmcnt(8) lgkmcnt(4)
    v_mfma_f32_32x32x16_bf16 v[48:63], v[32:35], v[236:239], v[48:63]
    ds_read_b64_tr_b16 v[24:25], v20 offset:32768
    ds_read_b64_tr_b16 v[26:27], v20 offset:33792
    ds_read_b64_tr_b16 v[28:29], v21 offset:32768
    ds_read_b64_tr_b16 v[30:31], v21 offset:33792
    v_mfma_f32_32x32x16_bf16 v[64:79], v[36:39], v[236:239], v[64:79]
    s_mov_b32 s59, 0x40000
L_psp_2073:
    s_waitcnt lgkmcnt(0)
    s_cmp_ge_u32 s61, 7
    s_cbranch_scc1 L_pok_2072
    s_load_dword s61, s[26:27], s10 glc
    s_sub_u32 s59, s59, 1
    s_cbranch_scc0 L_psp_2073
    s_waitcnt lgkmcnt(0)
L_pok_2072:
    s_add_u32 s10, s10, 4
    s_add_u32 s81, s75, s68
    buffer_load_dwordx4 v[124:127], v2, s[28:31], s81 offen offset:2048 sc1
    s_waitcnt vmcnt(7) lgkmcnt(4)
    v_mfma_f32_32x32x16_bf16 v[80:95], v[40:43], v[240:243], 0
    ds_read_b64_tr_b16 v[32:33], v20 offset:49152
    ds_read_b64_tr_b16 v[34:35], v20 offset:50176
    ds_read_b64_tr_b16 v[36:37], v21 offset:49152
    ds_read_b64_tr_b16 v[38:39], v21 offset:50176
    v_mfma_f32_32x32x16_bf16 v[96:111], v[44:47], v[240:243], 0
    s_barrier
    s_cmp_lg_u32 s49, 3
    s_cbranch_scc0 L_idle_2074
    s_lshl_b32 s58, s52, 4
    s_add_u32 s58, s58, s45
    s_lshr_b32 s57, s58, 6
    s_lshr_b32 s59, s24, s57
    s_and_b32 s59, s59, 1
    s_add_u32 s57, s57, s59
    s_lshl_b32 s57, s57, 6
    s_add_u32 s58, s58, s57
    s_lshl_b32 s58, s58, 7
    s_atomic_add s60, s[26:27], s58 offset:32
    s_atomic_add s60, s[26:27], s58 offset:544
    s_atomic_add s60, s[26:27], s58 offset:1056
    s_atomic_add s60, s[26:27], s58 offset:1568
L_idle_2074:
    s_add_u32 s81, s75, s69
    buffer_load_dwordx4 v[128:131], v2, s[28:31], s81 offen offset:2048 sc1
    s_barrier
    s_waitcnt vmcnt(7) lgkmcnt(4)
    v_mfma_f32_32x32x16_bf16 v[80:95], v[24:27], v[244:247], v[80:95]
    ds_read_b64_tr_b16 v[40:41], v22 offset:0
    ds_read_b64_tr_b16 v[42:43], v22 offset:1024
    ds_read_b64_tr_b16 v[44:45], v23 offset:0
    ds_read_b64_tr_b16 v[46:47], v23 offset:1024
    v_mfma_f32_32x32x16_bf16 v[96:111], v[28:31], v[244:247], v[96:111]
    s_add_u32 s81, s75, s70
    buffer_load_dwordx4 v[132:135], v2, s[28:31], s81 offen offset:2048 sc1
    s_waitcnt vmcnt(7) lgkmcnt(4)
    v_mfma_f32_32x32x16_bf16 v[80:95], v[32:35], v[248:251], v[80:95]
    ds_read_b64_tr_b16 v[24:25], v22 offset:16384
    ds_read_b64_tr_b16 v[26:27], v22 offset:17408
    ds_read_b64_tr_b16 v[28:29], v23 offset:16384
    ds_read_b64_tr_b16 v[30:31], v23 offset:17408
    v_mfma_f32_32x32x16_bf16 v[96:111], v[36:39], v[248:251], v[96:111]
    s_add_u32 s81, s75, s71
    buffer_load_dwordx4 v[136:139], v2, s[28:31], s81 offen offset:2048 sc1
    s_load_dword s61, s[26:27], s10 glc
    v_sub_f32 v15, 1.0, v14
    v_mul_f32 v48, v48, v14
    v_mul_f32 v49, v49, v14
    v_mul_f32 v50, v50, v14
    s_waitcnt vmcnt(7) lgkmcnt(4)
    v_mfma_f32_32x32x16_bf16 v[80:95], v[40:43], v[252:255], v[80:95]
    ds_read_b64_tr_b16 v[32:33], v22 offset:32768
    ds_read_b64_tr_b16 v[34:35], v22 offset:33792
    ds_read_b64_tr_b16 v[36:37], v23 offset:32768
    ds_read_b64_tr_b16 v[38:39], v23 offset:33792
    v_mfma_f32_32x32x16_bf16 v[96:111], v[44:47], v[252:255], v[96:111]
    s_add_u32 s81, s75, s72
    buffer_load_dwordx4 v[140:143], v2, s[28:31], s81 offen offset:2048 sc1
    v_mul_f32 v51, v51, v14
    v_mul_f32 v52, v52, v14
    v_mul_f32 v53, v53, v14
    v_mul_f32 v54, v54, v14
    s_waitcnt vmcnt(7) lgkmcnt(4)
    v_mfma_f32_32x32x16_bf16 v[80:95], v[24:27], v[112:115], v[80:95]
    ds_read_b64_tr_b16 v[40:41], v22 offset:49152
    ds_read_b64_tr_b16 v[42:43], v22 offset:50176
    ds_read_b64_tr_b16 v[44:45], v23 offset:49152
    ds_read_b64_tr_b16 v[46:47], v23 offset:50176
    v_mfma_f32_32x32x16_bf16 v[96:111], v[28:31], v[112:115], v[96:111]
    s_add_u32 s81, s75, s73
    buffer_load_dwordx4 v[144:147], v2, s[28:31], s81 offen offset:2048 sc1
    v_mul_f32 v55, v55, v14
    v_mul_f32 v56, v56, v14
    v_mul_f32 v57, v57, v14
    v_mul_f32 v58, v58, v14
    s_waitcnt vmcnt(7) lgkmcnt(4)
    v_mfma_f32_32x32x16_bf16 v[80:95], v[32:35], v[116:119], v[80:95]
    ds_read_b64_tr_b16 v[24:25], v20 offset:20480
    ds_read_b64_tr_b16 v[26:27], v20 offset:21504
    ds_read_b64_tr_b16 v[28:29], v21 offset:20480
    ds_read_b64_tr_b16 v[30:31], v21 offset:21504
    v_mfma_f32_32x32x16_bf16 v[96:111], v[36:39], v[116:119], v[96:111]
    s_add_u32 s81, s75, s74
    buffer_load_dwordx4 v[148:151], v2, s[28:31], s81 offen offset:2048 sc1
    v_mul_f32 v59, v59, v14
    v_mul_f32 v60, v60, v14
    v_mul_f32 v61, v61, v14
    v_mul_f32 v62, v62, v14
    s_waitcnt vmcnt(7) lgkmcnt(4)
    v_mfma_f32_32x32x16_bf16 v[80:95], v[40:43], v[120:123], v[80:95]
    ds_read_b64_tr_b16 v[32:33], v20 offset:36864
    ds_read_b64_tr_b16 v[34:35], v20 offset:37888
    ds_read_b64_tr_b16 v[36:37], v21 offset:36864
    ds_read_b64_tr_b16 v[38:39], v21 offset:37888
    v_mfma_f32_32x32x16_bf16 v[96:111], v[44:47], v[120:123], v[96:111]
    s_mov_b32 s59, 0x40000
L_psp_2076:
    s_waitcnt lgkmcnt(0)
    s_cmp_ge_u32 s61, 7
    s_cbranch_scc1 L_pok_2075
    s_load_dword s61, s[26:27], s10 glc
    s_sub_u32 s59, s59, 1
    s_cbranch_scc0 L_psp_2076
    s_waitcnt lgkmcnt(0)
L_pok_2075:
    s_add_u32 s10, s10, 4
    s_add_u32 s81, s76, s68
    buffer_load_dwordx4 v[152:155], v2, s[28:31], s81 offen offset:0 sc1
    v_mul_f32 v63, v63, v14
    v_mul_f32 v64, v64, v14
    v_mul_f32 v65, v65, v14
    v_mul_f32 v66, v66, v14
    s_waitcnt vmcnt(7) lgkmcnt(4)
    v_mfma_f32_32x32x16_bf16 v[80:95], v[24:27], v[124:127], v[80:95]
    ds_read_b64_tr_b16 v[40:41], v20 offset:53248
    ds_read_b64_tr_b16 v[42:43], v20 offset:54272
    ds_read_b64_tr_b16 v[44:45], v21 offset:53248
    ds_read_b64_tr_b16 v[46:47], v21 offset:54272
    v_mfma_f32_32x32x16_bf16 v[96:111], v[28:31], v[124:127], v[96:111]
    s_add_u32 s81, s76, s69
    buffer_load_dwordx4 v[156:159], v2, s[28:31], s81 offen offset:0 sc1
    v_mul_f32 v67, v67, v14
    v_mul_f32 v68, v68, v14
    v_mul_f32 v69, v69, v14
    v_mul_f32 v70, v70, v14
    s_waitcnt vmcnt(7) lgkmcnt(4)
    v_mfma_f32_32x32x16_bf16 v[80:95], v[32:35], v[128:131], v[80:95]
    ds_read_b64_tr_b16 v[24:25], v22 offset:4096
    ds_read_b64_tr_b16 v[26:27], v22 offset:5120
    ds_read_b64_tr_b16 v[28:29], v23 offset:4096
    ds_read_b64_tr_b16 v[30:31], v23 offset:5120
    v_mfma_f32_32x32x16_bf16 v[96:111], v[36:39], v[128:131], v[96:111]
    s_add_u32 s81, s76, s70
    buffer_load_dwordx4 v[160:163], v2, s[28:31], s81 offen offset:0 sc1
    v_mul_f32 v71, v71, v14
    v_mul_f32 v72, v72, v14
    v_mul_f32 v73, v73, v14
    v_mul_f32 v74, v74, v14
    s_waitcnt vmcnt(7) lgkmcnt(4)
    v_mfma_f32_32x32x16_bf16 v[80:95], v[40:43], v[132:135], v[80:95]
    ds_read_b64_tr_b16 v[32:33], v22 offset:20480
    ds_read_b64_tr_b16 v[34:35], v22 offset:21504
    ds_read_b64_tr_b16 v[36:37], v23 offset:20480
    ds_read_b64_tr_b16 v[38:39], v23 offset:21504
    v_mfma_f32_32x32x16_bf16 v[96:111], v[44:47], v[132:135], v[96:111]
    s_add_u32 s81, s76, s71
    buffer_load_dwordx4 v[164:167], v2, s[28:31], s81 offen offset:0 sc1
    v_mul_f32 v75, v75, v14
    v_mul_f32 v76, v76, v14
    v_mul_f32 v77, v77, v14
    v_mul_f32 v78, v78, v14
    s_waitcnt vmcnt(7) lgkmcnt(4)
    v_mfma_f32_32x32x16_bf16 v[80:95], v[24:27], v[136:139], v[80:95]
    ds_read_b64_tr_b16 v[40:41], v22 offset:36864
    ds_read_b64_tr_b16 v[42:43], v22 offset:37888
    ds_read_b64_tr_b16 v[44:45], v23 offset:36864
    ds_read_b64_tr_b16 v[46:47], v23 offset:37888
    v_mfma_f32_32x32x16_bf16 v[96:111], v[28:31], v[136:139], v[96:111]
    s_add_u32 s81, s76, s72
    buffer_load_dwordx4 v[168:171], v2, s[28:31], s81 offen offset:0 sc1
    v_mul_f32 v79, v79, v14
    s_waitcnt vmcnt(7) lgkmcnt(4)
    v_mfma_f32_32x32x16_bf16 v[80:95], v[32:35], v[140:143], v[80:95]
    ds_read_b64_tr_b16 v[24:25], v22 offset:53248
    ds_read_b64_tr_b16 v[26:27], v22 offset:54272
    ds_read_b64_tr_b16 v[28:29], v23 offset:53248
    ds_read_b64_tr_b16 v[30:31], v23 offset:54272
    v_mfma_f32_32x32x16_bf16 v[96:111], v[36:39], v[140:143], v[96:111]
    s_add_u32 s81, s76, s73
    buffer_load_dwordx4 v[172:175], v2, s[28:31], s81 offen offset:0 sc1
    s_waitcnt vmcnt(7) lgkmcnt(4)
    v_mfma_f32_32x32x16_bf16 v[80:95], v[40:43], v[144:147], v[80:95]
    ds_read_b64_tr_b16 v[32:33], v20 offset:24576
    ds_read_b64_tr_b16 v[34:35], v20 offset:25600
    ds_read_b64_tr_b16 v[36:37], v21 offset:24576
    ds_read_b64_tr_b16 v[38:39], v21 offset:25600
    v_mfma_f32_32x32x16_bf16 v[96:111], v[44:47], v[144:147], v[96:111]
    s_add_u32 s81, s76, s74
    buffer_load_dwordx4 v[176:179], v2, s[28:31], s81 offen offset:0 sc1
    s_waitcnt vmcnt(7) lgkmcnt(4)
    v_mfma_f32_32x32x16_bf16 v[80:95], v[24:27], v[148:151], v[80:95]
    ds_read_b64_tr_b16 v[40:41], v20 offset:40960
    ds_read_b64_tr_b16 v[42:43], v20 offset:41984
    ds_read_b64_tr_b16 v[44:45], v21 offset:40960
    ds_read_b64_tr_b16 v[46:47], v21 offset:41984
    v_mfma_f32_32x32x16_bf16 v[96:111], v[28:31], v[148:151], v[96:111]
    s_barrier
    s_waitcnt vmcnt(6) lgkmcnt(4)
    v_mfma_f32_32x32x16_bf16 v[80:95], v[32:35], v[152:155], v[80:95]
    ds_read_b64_tr_b16 v[24:25], v20 offset:57344
    ds_read_b64_tr_b16 v[26:27], v20 offset:58368
    ds_read_b64_tr_b16 v[28:29], v21 offset:57344
    ds_read_b64_tr_b16 v[30:31], v21 offset:58368
    v_mfma_f32_32x32x16_bf16 v[96:111], v[36:39], v[152:155], v[96:111]
    s_waitcnt vmcnt(5) lgkmcnt(4)
    v_mfma_f32_32x32x16_bf16 v[80:95], v[40:43], v[156:159], v[80:95]
    ds_read_b64_tr_b16 v[32:33], v22 offset:8192
    ds_read_b64_tr_b16 v[34:35], v22 offset:9216
    ds_read_b64_tr_b16 v[36:37], v23 offset:8192
    ds_read_b64_tr_b16 v[38:39], v23 offset:9216
    v_mfma_f32_32x32x16_bf16 v[96:111], v[44:47], v[156:159], v[96:111]
    s_add_u32 m0, s20, 147456
    s_add_u32 s56, s14, 98304
    buffer_load_dwordx4 v4, s[40:43], s56 offen offset:0  lds
    buffer_load_dwordx4 v5, s[40:43], s56 offen offset:1024  lds
    s_xor_b32 m0, m0, 2048
    s_nop 0
    buffer_load_dwordx4 v6, s[40:43], s56 offen offset:0  lds
    buffer_load_dwordx4 v7, s[40:43], s56 offen offset:1024  lds
    s_load_dword s61, s[26:27], s10 glc
    s_waitcnt vmcnt(8) lgkmcnt(4)
    v_mfma_f32_32x32x16_bf16 v[80:95], v[24:27], v[160:163], v[80:95]
    ds_read_b64_tr_b16 v[40:41], v22 offset:24576
    ds_read_b64_tr_b16 v[42:43], v22 offset:25600
    ds_read_b64_tr_b16 v[44:45], v23 offset:24576
    ds_read_b64_tr_b16 v[46:47], v23 offset:25600
    v_mfma_f32_32x32x16_bf16 v[96:111], v[28:31], v[160:163], v[96:111]
    s_add_u32 m0, s20, 131072
    s_add_u32 s56, s13, 98304
    buffer_load_dwordx4 v4, s[40:43], s56 offen offset:0  lds
    buffer_load_dwordx4 v5, s[40:43], s56 offen offset:1024  lds
    s_xor_b32 m0, m0, 2048
    s_nop 0
    buffer_load_dwordx4 v6, s[40:43], s56 offen offset:0  lds
    buffer_load_dwordx4 v7, s[40:43], s56 offen offset:1024  lds
    s_waitcnt vmcnt(11) lgkmcnt(4)
    v_mfma_f32_32x32x16_bf16 v[80:95], v[32:35], v[164:167], v[80:95]
    ds_read_b64_tr_b16 v[24:25], v22 offset:40960
    ds_read_b64_tr_b16 v[26:27], v22 offset:41984
    ds_read_b64_tr_b16 v[28:29], v23 offset:40960
    ds_read_b64_tr_b16 v[30:31], v23 offset:41984
    v_mfma_f32_32x32x16_bf16 v[96:111], v[36:39], v[164:167], v[96:111]
    s_waitcnt vmcnt(10) lgkmcnt(4)
    v_mfma_f32_32x32x16_bf16 v[80:95], v[40:43], v[168:171], v[80:95]
    ds_read_b64_tr_b16 v[32:33], v22 offset:57344
    ds_read_b64_tr_b16 v[34:35], v22 offset:58368
    ds_read_b64_tr_b16 v[36:37], v23 offset:57344
    ds_read_b64_tr_b16 v[38:39], v23 offset:58368
    v_mfma_f32_32x32x16_bf16 v[96:111], v[44:47], v[168:171], v[96:111]
    s_waitcnt vmcnt(9) lgkmcnt(4)
    v_mfma_f32_32x32x16_bf16 v[80:95], v[24:27], v[172:175], v[80:95]
    v_mfma_f32_32x32x16_bf16 v[96:111], v[28:31], v[172:175], v[96:111]
    s_mov_b32 s59, 0x40000
L_psp_2078:
    s_waitcnt lgkmcnt(0)
    s_cmp_ge_u32 s61, 14
    s_cbranch_scc1 L_pok_2077
    s_load_dword s61, s[26:27], s10 glc
    s_sub_u32 s59, s59, 1
    s_cbranch_scc0 L_psp_2078
    s_waitcnt lgkmcnt(0)
L_pok_2077:
    s_add_u32 s10, s10, 4
    s_barrier
    s_waitcnt vmcnt(8) lgkmcnt(0)
    v_mfma_f32_32x32x16_bf16 v[80:95], v[32:35], v[176:179], v[80:95]
    v_mfma_f32_32x32x16_bf16 v[96:111], v[36:39], v[176:179], v[96:111]
    s_lshl_b32 s56, s48, 3
    s_add_u32 s56, s56, s49
    s_lshl_b32 s4, s56, 14
    s_add_u32 s4, s4, s63
    s_add_u32 s4, s4, 33554432
    s_andn2_b32 s59, s4, 0x1fff
    s_add_u32 s4, s4, s59
    s_andn2_b32 s59, s4, 0x1fffff
    s_add_u32 s4, s4, s59
    s_add_u32 s4, s4, s25
    s_xor_b32 s5, s4, 262144
    s_lshl_b32 s57, s47, 11
    s_add_u32 s5, s5, s57
    s_xor_b32 s58, s5, 4096
    s_lshr_b32 s57, s56, 6
    s_lshr_b32 s59, s24, s57
    s_and_b32 s59, s59, 1
    s_add_u32 s57, s57, s59
    s_lshl_b32 s57, s57, 6
    s_add_u32 s56, s56, s57
    s_lshl_b32 s56, s56, 7
    s_lshl_b32 s57, s46, 2
    s_add_u32 s56, s56, s57
    s_add_u32 s6, s56, 40
    s_xor_b32 s6, s6, 1024
    v_mov_b32 v19, 1
    v_mov_b32 v18, 0
    s_add_u32 s57, s63, 0
    v_add_u32 v16, s57, v2
    v_fmac_f32 v48, v80, v15
    v_fmac_f32 v49, v81, v15
    v_fmac_f32 v50, v82, v15
    v_fmac_f32 v51, v83, v15
    v_fmac_f32 v52, v84, v15
    v_fmac_f32 v53, v85, v15
    v_fmac_f32 v54, v86, v15
    v_fmac_f32 v55, v87, v15
    v_fmac_f32 v56, v88, v15
    v_fmac_f32 v57, v89, v15
    v_fmac_f32 v58, v90, v15
    v_fmac_f32 v59, v91, v15
    v_fmac_f32 v60, v92, v15
    v_fmac_f32 v61, v93, v15
    v_fmac_f32 v62, v94, v15
    v_fmac_f32 v63, v95, v15
    v_cvt_pk_bf16_f32 v48, v48, v49
    v_cvt_pk_bf16_f32 v49, v50, v51
    v_cvt_pk_bf16_f32 v50, v52, v53
    v_cvt_pk_bf16_f32 v51, v54, v55
    v_cvt_pk_bf16_f32 v52, v56, v57
    v_cvt_pk_bf16_f32 v53, v58, v59
    v_cvt_pk_bf16_f32 v54, v60, v61
    v_cvt_pk_bf16_f32 v55, v62, v63
    buffer_store_dwordx4 v[48:51], v2, s[28:31], s5 offen offset:0 sc1
    buffer_store_dwordx4 v[52:55], v2, s[28:31], s5 offen offset:1024 sc1
    v_fmac_f32 v64, v96, v15
    v_fmac_f32 v65, v97, v15
    v_fmac_f32 v66, v98, v15
    v_fmac_f32 v67, v99, v15
    v_fmac_f32 v68, v100, v15
    v_fmac_f32 v69, v101, v15
    v_fmac_f32 v70, v102, v15
    v_fmac_f32 v71, v103, v15
    v_fmac_f32 v72, v104, v15
    v_fmac_f32 v73, v105, v15
    v_fmac_f32 v74, v106, v15
    v_fmac_f32 v75, v107, v15
    v_fmac_f32 v76, v108, v15
    v_fmac_f32 v77, v109, v15
    v_fmac_f32 v78, v110, v15
    v_fmac_f32 v79, v111, v15
    v_cvt_pk_bf16_f32 v64, v64, v65
    v_cvt_pk_bf16_f32 v65, v66, v67
    v_cvt_pk_bf16_f32 v66, v68, v69
    v_cvt_pk_bf16_f32 v67, v70, v71
    v_cvt_pk_bf16_f32 v68, v72, v73
    v_cvt_pk_bf16_f32 v69, v74, v75
    v_cvt_pk_bf16_f32 v70, v76, v77
    v_cvt_pk_bf16_f32 v71, v78, v79
    buffer_store_dwordx4 v[64:67], v2, s[28:31], s58 offen offset:0 sc1
    buffer_store_dwordx4 v[68:71], v2, s[28:31], s58 offen offset:1024 sc1
    s_xor_b32 s10, s6, 1024
    s_waitcnt vmcnt(0)
    s_atomic_add s60, s[26:27], s6
    s_load_dword s61, s[26:27], s10 glc
    s_barrier
    s_mov_b32 s59, 0x40000
L_psp_2080:
    s_waitcnt lgkmcnt(0)
    s_cmp_ge_u32 s61, 2
    s_cbranch_scc1 L_pok_2079
    s_load_dword s61, s[26:27], s10 glc
    s_sub_u32 s59, s59, 1
    s_cbranch_scc0 L_psp_2080
    s_waitcnt lgkmcnt(0)
L_pok_2079:
    buffer_load_dwordx4 v[112:115], v2, s[28:31], s4 offen offset:0 sc1
    buffer_load_dwordx4 v[116:119], v2, s[28:31], s4 offen offset:2048 sc1
    buffer_load_dwordx4 v[120:123], v2, s[28:31], s4 offen offset:1024 sc1
    buffer_load_dwordx4 v[124:127], v2, s[28:31], s4 offen offset:3072 sc1
    s_waitcnt vmcnt(2)
    v_lshlrev_b32 v80, 16, v112
    v_lshlrev_b32 v81, 16, v116
    v_and_b32 v112, 0xffff0000, v112
    v_and_b32 v116, 0xffff0000, v116
    v_add_f32 v80, v80, v81
    v_add_f32 v81, v112, v116
    v_lshlrev_b32 v82, 16, v113
    v_lshlrev_b32 v83, 16, v117
    v_and_b32 v113, 0xffff0000, v113
    v_and_b32 v117, 0xffff0000, v117
    v_add_f32 v82, v82, v83
    v_add_f32 v83, v113, v117
    v_lshlrev_b32 v84, 16, v114
    v_lshlrev_b32 v85, 16, v118
    v_and_b32 v114, 0xffff0000, v114
    v_and_b32 v118, 0xffff0000, v118
    v_add_f32 v84, v84, v85
    v_add_f32 v85, v114, v118
    v_lshlrev_b32 v86, 16, v115
    v_lshlrev_b32 v87, 16, v119
    v_and_b32 v115, 0xffff0000, v115
    v_and_b32 v119, 0xffff0000, v119
    v_add_f32 v86, v86, v87
    v_add_f32 v87, v115, v119
    ds_write_b128 v16, v[80:83] offset:0
    ds_write_b128 v16, v[84:87] offset:1024
    s_waitcnt vmcnt(0)
    v_lshlrev_b32 v88, 16, v120
    v_lshlrev_b32 v89, 16, v124
    v_and_b32 v120, 0xffff0000, v120
    v_and_b32 v124, 0xffff0000, v124
    v_add_f32 v88, v88, v89
    v_add_f32 v89, v120, v124
    v_lshlrev_b32 v90, 16, v121
    v_lshlrev_b32 v91, 16, v125
    v_and_b32 v121, 0xffff0000, v121
    v_and_b32 v125, 0xffff0000, v125
    v_add_f32 v90, v90, v91
    v_add_f32 v91, v121, v125
    v_lshlrev_b32 v92, 16, v122
    v_lshlrev_b32 v93, 16, v126
    v_and_b32 v122, 0xffff0000, v122
    v_and_b32 v126, 0xffff0000, v126
    v_add_f32 v92, v92, v93
    v_add_f32 v93, v122, v126
    v_lshlrev_b32 v94, 16, v123
    v_lshlrev_b32 v95, 16, v127
    v_and_b32 v123, 0xffff0000, v123
    v_and_b32 v127, 0xffff0000, v127
    v_add_f32 v94, v94, v95
    v_add_f32 v95, v123, v127
    ds_write_b128 v16, v[88:91] offset:2048
    ds_write_b128 v16, v[92:95] offset:3072
    s_waitcnt lgkmcnt(0)
    s_barrier
    s_branch L_fin_4
L_cold:
L_attg_100008:
    s_barrier
    ds_read_b128 v[64:67], v108 offset:0
    ds_read_b128 v[68:71], v108 offset:8192
    ds_read_b128 v[72:75], v108 offset:1024
    ds_read_b128 v[76:79], v108 offset:2048
    ds_read_b128 v[80:83], v108 offset:3072
    ds_read_b128 v[84:87], v108 offset:4096
    ds_read_b128 v[88:91], v108 offset:5120
    ds_read_b128 v[92:95], v108 offset:6144
    ds_read_b128 v[96:99], v108 offset:7168
    s_waitcnt lgkmcnt(8)
    v_mfma_f32_32x32x16_bf16 v[144:159], v[64:67], v[20:23], 0
    s_waitcnt lgkmcnt(7)
    v_mfma_f32_32x32x16_bf16 v[128:143], v[68:71], v[20:23], 0
    s_nop 11
    s_cmp_gt_u32 s54, 0
    s_cbranch_scc0 L_ok_101012
    v_mov_b32 v144, 0xf149f2ca
    v_mov_b32 v145, 0xf149f2ca
    v_mov_b32 v146, 0xf149f2ca
    v_mov_b32 v147, 0xf149f2ca
    v_mov_b32 v148, 0xf149f2ca
    v_mov_b32 v149, 0xf149f2ca
    v_mov_b32 v150, 0xf149f2ca
    v_mov_b32 v151, 0xf149f2ca
    v_mov_b32 v152, 0xf149f2ca
    v_mov_b32 v153, 0xf149f2ca
    v_mov_b32 v154, 0xf149f2ca
    v_mov_b32 v155, 0xf149f2ca
    v_mov_b32 v156, 0xf149f2ca
    v_mov_b32 v157, 0xf149f2ca
    v_mov_b32 v158, 0xf149f2ca
    v_mov_b32 v159, 0xf149f2ca
L_ok_101012:
    v_cndmask_b32 v128, v144, v128, s[64:65]
    v_cndmask_b32 v129, v145, v129, s[66:67]
    v_cndmask_b32 v130, v146, v130, s[68:69]
    v_cndmask_b32 v131, v147, v131, s[70:71]
    v_cndmask_b32 v132, v148, v132, s[72:73]
    v_cndmask_b32 v133, v149, v133, s[74:75]
    s_waitcnt lgkmcnt(0)
    v_cndmask_b32 v134, v150, v134, s[76:77]
    v_cndmask_b32 v135, v151, v135, s[78:79]
    v_cndmask_b32 v136, v152, v136, s[80:81]
    v_cndmask_b32 v137, v153, v137, s[82:83]
    v_cndmask_b32 v138, v154, v138, s[84:85]
    v_cndmask_b32 v139, v155, v139, s[86:87]
    v_cndmask_b32 v140, v156, v140, s[88:89]
    v_cndmask_b32 v141, v157, v141, s[90:91]
    v_cndmask_b32 v142, v158, v142, s[92:93]
    v_cndmask_b32 v143, v159, v143, s[94:95]
    s_waitcnt vmcnt(0)
    s_barrier
    v_max_f32 v100, v128, v129
    v_max_f32 v101, v130, v131
    v_max3_f32 v100, v132, v133, v100
    v_max3_f32 v101, v134, v135, v101
    v_max3_f32 v100, v136, v137, v100
    v_max3_f32 v101, v138, v139, v101
    v_max3_f32 v100, v140, v141, v100
    v_max3_f32 v101, v142, v143, v101
    v_max_f32 v100, v100, v101
    v_mov_b32 v101, v100
    s_nop 1
    v_permlane32_swap_b32 v100, v101
    s_nop 0
    v_max_f32 v100, v100, v101
    v_sub_f32 v112, 0, v100
    v_mov_b32 v113, v112
    v_mov_b32 v114, v112
    v_mov_b32 v115, v112
    v_mov_b32 v116, v112
    v_mov_b32 v117, v112
    v_mov_b32 v118, v112
    v_mov_b32 v119, v112
    v_mov_b32 v120, v112
    v_mov_b32 v121, v112
    v_mov_b32 v122, v112
    v_mov_b32 v123, v112
    v_mov_b32 v124, v112
    v_mov_b32 v125, v112
    v_mov_b32 v126, v112
    v_mov_b32 v127, v112
    v_add_f32 v128, v128, v112
    v_add_f32 v129, v129, v113
    v_mfma_f32_32x32x16_bf16 v[144:159], v[72:75], v[20:23], v[112:127]
    v_add_f32 v130, v130, v114
    v_add_f32 v131, v131, v115
    v_add_f32 v132, v132, v116
    v_add_f32 v133, v133, v117
    v_add_f32 v134, v134, v118
    v_add_f32 v135, v135, v119
    v_add_f32 v136, v136, v120
    v_add_f32 v137, v137, v121
    v_add_f32 v138, v138, v122
    v_add_f32 v139, v139, v123
    v_add_f32 v140, v140, v124
    v_add_f32 v141, v141, v125
    v_add_f32 v142, v142, v126
    v_add_f32 v143, v143, v127
    v_exp_f32 v128, v128
    v_exp_f32 v129, v129
    v_exp_f32 v130, v130
    v_exp_f32 v131, v131
    v_exp_f32 v132, v132
    v_exp_f32 v133, v133
    v_exp_f32 v134, v134
    v_exp_f32 v135, v135
    v_exp_f32 v136, v136
    v_exp_f32 v137, v137
    v_exp_f32 v138, v138
    v_exp_f32 v139, v139
    v_exp_f32 v140, v140
    v_exp_f32 v141, v141
    v_exp_f32 v142, v142
    v_exp_f32 v143, v143
    v_cvt_pk_bf16_f32 v200, v128, v129
    v_cvt_pk_bf16_f32 v201, v130, v131
    v_cvt_pk_bf16_f32 v202, v132, v133
    v_cvt_pk_bf16_f32 v203, v134, v135
    v_cvt_pk_bf16_f32 v204, v136, v137
    v_cvt_pk_bf16_f32 v205, v138, v139
    v_cvt_pk_bf16_f32 v206, v140, v141
    v_cvt_pk_bf16_f32 v207, v142, v143
    v_mov_b32 v128, 0x3f803f80
    v_mov_b32 v129, v128
    v_mov_b32 v130, v128
    v_mov_b32 v131, v128
    v_mov_b32 v132, v128
    v_mov_b32 v133, v128
    v_mov_b32 v134, v128
    v_mov_b32 v135, v128
    s_waitcnt vmcnt(0)
    s_barrier
    s_mov_b64 exec, s[96:97]
    ds_read_b128 v[48:51], v109 offset:8192
    ds_read_b128 v[52:55], v109 offset:8704
    ds_read_b128 v[56:59], v109 offset:0
    ds_read_b128 v[60:63], v109 offset:512
    s_mov_b64 exec, -1
    v_and_b32 v192, v200, v24
    v_and_b32 v193, v201, v25
    v_and_b32 v194, v202, v26
    v_and_b32 v195, v203, v27
    v_and_b32 v196, v204, v28
    v_and_b32 v197, v205, v29
    v_and_b32 v198, v206, v30
    v_and_b32 v199, v207, v31
    v_xor_b32 v200, v200, v192
    v_xor_b32 v201, v201, v193
    v_xor_b32 v202, v202, v194
    v_xor_b32 v203, v203, v195
    v_xor_b32 v204, v204, v196
    v_xor_b32 v205, v205, v197
    v_xor_b32 v206, v206, v198
    v_xor_b32 v207, v207, v199
    s_cmp_gt_u32 s54, 1
    s_cbranch_scc0 L_ok_101013
    v_mov_b32 v144, 0xf149f2ca
    v_mov_b32 v145, 0xf149f2ca
    v_mov_b32 v146, 0xf149f2ca
    v_mov_b32 v147, 0xf149f2ca
    v_mov_b32 v148, 0xf149f2ca
    v_mov_b32 v149, 0xf149f2ca
    v_mov_b32 v150, 0xf149f2ca
    v_mov_b32 v151, 0xf149f2ca
    v_mov_b32 v152, 0xf149f2ca
    v_mov_b32 v153, 0xf149f2ca
    v_mov_b32 v154, 0xf149f2ca
    v_mov_b32 v155, 0xf149f2ca
    v_mov_b32 v156, 0xf149f2ca
    v_mov_b32 v157, 0xf149f2ca
    v_mov_b32 v158, 0xf149f2ca
    v_mov_b32 v159, 0xf149f2ca
L_ok_101013:
    v_mfma_f32_32x32x16_bf16 v[160:175], v[76:79], v[20:23], v[112:127]
    v_exp_f32 v144, v144
    s_mov_b64 exec, s[96:97]
    ds_read_b128 v[128:131], v109 offset:1024
    ds_read_b128 v[132:135], v109 offset:1536
    s_mov_b64 exec, -1
    v_exp_f32 v145, v145
    v_exp_f32 v146, v146
    v_exp_f32 v147, v147
    s_waitcnt lgkmcnt(4)
    v_mfma_f32_32x32x16_bf16 v[32:47], v[48:51], v[192:195], 0
    v_exp_f32 v148, v148
    v_exp_f32 v149, v149
    v_exp_f32 v150, v150
    v_exp_f32 v151, v151
    v_mfma_f32_32x32x16_bf16 v[32:47], v[52:55], v[196:199], v[32:47]
    v_exp_f32 v152, v152
    v_exp_f32 v153, v153
    v_exp_f32 v154, v154
    v_exp_f32 v155, v155
    s_waitcnt lgkmcnt(2)
    v_mfma_f32_32x32x16_bf16 v[32:47], v[56:59], v[200:203], v[32:47]
    v_exp_f32 v156, v156
    v_exp_f32 v157, v157
    v_exp_f32 v158, v158
    v_exp_f32 v159, v159
    v_mfma_f32_32x32x16_bf16 v[32:47], v[60:63], v[204:207], v[32:47]
    v_cvt_pk_bf16_f32 v184, v144, v145
    v_cvt_pk_bf16_f32 v185, v146, v147
    v_cvt_pk_bf16_f32 v186, v148, v149
    v_cvt_pk_bf16_f32 v187, v150, v151
    v_cvt_pk_bf16_f32 v188, v152, v153
    v_cvt_pk_bf16_f32 v189, v154, v155
    v_cvt_pk_bf16_f32 v190, v156, v157
    v_cvt_pk_bf16_f32 v191, v158, v159
    s_cmp_gt_u32 s54, 2
    s_cbranch_scc0 L_ok_101014
    v_mov_b32 v160, 0xf149f2ca
    v_mov_b32 v161, 0xf149f2ca
    v_mov_b32 v162, 0xf149f2ca
    v_mov_b32 v163, 0xf149f2ca
    v_mov_b32 v164, 0xf149f2ca
    v_mov_b32 v165, 0xf149f2ca
    v_mov_b32 v166, 0xf149f2ca
    v_mov_b32 v167, 0xf149f2ca
    v_mov_b32 v168, 0xf149f2ca
    v_mov_b32 v169, 0xf149f2ca
    v_mov_b32 v170, 0xf149f2ca
    v_mov_b32 v171, 0xf149f2ca
    v_mov_b32 v172, 0xf149f2ca
    v_mov_b32 v173, 0xf149f2ca
    v_mov_b32 v174, 0xf149f2ca
    v_mov_b32 v175, 0xf149f2ca
L_ok_101014:
    v_mfma_f32_32x32x16_bf16 v[144:159], v[80:83], v[20:23], v[112:127]
    v_exp_f32 v160, v160
    s_mov_b64 exec, s[96:97]
    ds_read_b128 v[48:51], v109 offset:2048
    ds_read_b128 v[52:55], v109 offset:2560
    s_mov_b64 exec, -1
    v_exp_f32 v161, v161
    v_exp_f32 v162, v162
    v_exp_f32 v163, v163
    v_exp_f32 v164, v164
    v_exp_f32 v165, v165
    s_waitcnt lgkmcnt(2)
    v_mfma_f32_32x32x16_bf16 v[32:47], v[128:131], v[184:187], v[32:47]
    v_exp_f32 v166, v166
    v_exp_f32 v167, v167
    v_exp_f32 v168, v168
    v_exp_f32 v169, v169
    v_exp_f32 v170, v170
    v_exp_f32 v171, v171
    v_mfma_f32_32x32x16_bf16 v[32:47], v[132:135], v[188:191], v[32:47]
    v_exp_f32 v172, v172
    v_exp_f32 v173, v173
    v_exp_f32 v174, v174
    v_exp_f32 v175, v175
    v_cvt_pk_bf16_f32 v176, v160, v161
    v_cvt_pk_bf16_f32 v177, v162, v163
    v_cvt_pk_bf16_f32 v178, v164, v165
    v_cvt_pk_bf16_f32 v179, v166, v167
    v_cvt_pk_bf16_f32 v180, v168, v169
    v_cvt_pk_bf16_f32 v181, v170, v171
    v_cvt_pk_bf16_f32 v182, v172, v173
    v_cvt_pk_bf16_f32 v183, v174, v175
    s_cmp_gt_u32 s54, 3
    s_cbranch_scc0 L_ok_101015
    v_mov_b32 v144, 0xf149f2ca
    v_mov_b32 v145, 0xf149f2ca
    v_mov_b32 v146, 0xf149f2ca
    v_mov_b32 v147, 0xf149f2ca
    v_mov_b32 v148, 0xf149f2ca
    v_mov_b32 v149, 0xf149f2ca
    v_mov_b32 v150, 0xf149f2ca
    v_mov_b32 v151, 0xf149f2ca
    v_mov_b32 v152, 0xf149f2ca
    v_mov_b32 v153, 0xf149f2ca
    v_mov_b32 v154, 0xf149f2ca
    v_mov_b32 v155, 0xf149f2ca
    v_mov_b32 v156, 0xf149f2ca
    v_mov_b32 v157, 0xf149f2ca
    v_mov_b32 v158, 0xf149f2ca
    v_mov_b32 v159, 0xf149f2ca
L_ok_101015:
    v_mfma_f32_32x32x16_bf16 v[160:175], v[84:87], v[20:23], v[112:127]
    v_exp_f32 v144, v144
    s_mov_b64 exec, s[96:97]
    ds_read_b128 v[56:59], v109 offset:3072
    ds_read_b128 v[60:63], v109 offset:3584
    s_mov_b64 exec, -1
    v_exp_f32 v145, v145
    v_exp_f32 v146, v146
    v_exp_f32 v147, v147
    v_exp_f32 v148, v148
    v_exp_f32 v149, v149
    s_waitcnt lgkmcnt(2)
    v_mfma_f32_32x32x16_bf16 v[32:47], v[48:51], v[176:179], v[32:47]
    v_exp_f32 v150, v150
    v_exp_f32 v151, v151
    v_exp_f32 v152, v152
    v_exp_f32 v153, v153
    v_exp_f32 v154, v154
    v_exp_f32 v155, v155
    v_mfma_f32_32x32x16_bf16 v[32:47], v[52:55], v[180:183], v[32:47]
    v_exp_f32 v156, v156
    v_exp_f32 v157, v157
    v_exp_f32 v158, v158
    v_exp_f32 v159, v159
    v_cvt_pk_bf16_f32 v184, v144, v145
    v_cvt_pk_bf16_f32 v185, v146, v147
    v_cvt_pk_bf16_f32 v186, v148, v149
    v_cvt_pk_bf16_f32 v187, v150, v151
    v_cvt_pk_bf16_f32 v188, v152, v153
    v_cvt_pk_bf16_f32 v189, v154, v155
    v_cvt_pk_bf16_f32 v190, v156, v157
    v_cvt_pk_bf16_f32 v191, v158, v159
    s_cmp_gt_u32 s54, 4
    s_cbranch_scc0 L_ok_101016
    v_mov_b32 v160, 0xf149f2ca
    v_mov_b32 v161, 0xf149f2ca
    v_mov_b32 v162, 0xf149f2ca
    v_mov_b32 v163, 0xf149f2ca
    v_mov_b32 v164, 0xf149f2ca
    v_mov_b32 v165, 0xf149f2ca
    v_mov_b32 v166, 0xf149f2ca
    v_mov_b32 v167, 0xf149f2ca
    v_mov_b32 v168, 0xf149f2ca
    v_mov_b32 v169, 0xf149f2ca
    v_mov_b32 v170, 0xf149f2ca
    v_mov_b32 v171, 0xf149f2ca
    v_mov_b32 v172, 0xf149f2ca
    v_mov_b32 v173, 0xf149f2ca
    v_mov_b32 v174, 0xf149f2ca
    v_mov_b32 v175, 0xf149f2ca
L_ok_101016:
    v_mfma_f32_32x32x16_bf16 v[144:159], v[88:91], v[20:23], v[112:127]
    v_exp_f32 v160, v160
    s_mov_b64 exec, s[96:97]
    ds_read_b128 v[128:131], v109 offset:4096
    ds_read_b128 v[132:135], v109 offset:4608
    s_mov_b64 exec, -1
    v_exp_f32 v161, v161
    v_exp_f32 v162, v162
    v_exp_f32 v163, v163
    v_exp_f32 v164, v164
    v_exp_f32 v165, v165
    s_waitcnt lgkmcnt(2)
    v_mfma_f32_32x32x16_bf16 v[32:47], v[56:59], v[184:187], v[32:47]
    v_exp_f32 v166, v166
    v_exp_f32 v167, v167
    v_exp_f32 v168, v168
    v_exp_f32 v169, v169
    v_exp_f32 v170, v170
    v_exp_f32 v171, v171
    v_mfma_f32_32x32x16_bf16 v[32:47], v[60:63], v[188:191], v[32:47]
    v_exp_f32 v172, v172
    v_exp_f32 v173, v173
    v_exp_f32 v174, v174
    v_exp_f32 v175, v175
    v_cvt_pk_bf16_f32 v176, v160, v161
    v_cvt_pk_bf16_f32 v177, v162, v163
    v_cvt_pk_bf16_f32 v178, v164, v165
    v_cvt_pk_bf16_f32 v179, v166, v167
    v_cvt_pk_bf16_f32 v180, v168, v169
    v_cvt_pk_bf16_f32 v181, v170, v171
    v_cvt_pk_bf16_f32 v182, v172, v173
    v_cvt_pk_bf16_f32 v183, v174, v175
    s_cmp_gt_u32 s54, 5
    s_cbranch_scc0 L_ok_101017
    v_mov_b32 v144, 0xf149f2ca
    v_mov_b32 v145, 0xf149f2ca
    v_mov_b32 v146, 0xf149f2ca
    v_mov_b32 v147, 0xf149f2ca
    v_mov_b32 v148, 0xf149f2ca
    v_mov_b32 v149, 0xf149f2ca
    v_mov_b32 v150, 0xf149f2ca
    v_mov_b32 v151, 0xf149f2ca
    v_mov_b32 v152, 0xf149f2ca
    v_mov_b32 v153, 0xf149f2ca
    v_mov_b32 v154, 0xf149f2ca
    v_mov_b32 v155, 0xf149f2ca
    v_mov_b32 v156, 0xf149f2ca
    v_mov_b32 v157, 0xf149f2ca
    v_mov_b32 v158, 0xf149f2ca
    v_mov_b32 v159, 0xf149f2ca
L_ok_101017:
    v_mfma_f32_32x32x16_bf16 v[160:175], v[92:95], v[20:23], v[112:127]
    v_exp_f32 v144, v144
    s_mov_b64 exec, s[96:97]
    ds_read_b128 v[48:51], v109 offset:5120
    ds_read_b128 v[52:55], v109 offset:5632
    s_mov_b64 exec, -1
    v_exp_f32 v145, v145
    v_exp_f32 v146, v146
    v_exp_f32 v147, v147
    v_exp_f32 v148, v148
    v_exp_f32 v149, v149
    s_waitcnt lgkmcnt(2)
    v_mfma_f32_32x32x16_bf16 v[32:47], v[128:131], v[176:179], v[32:47]
    v_exp_f32 v150, v150
    v_exp_f32 v151, v151
    v_exp_f32 v152, v152
    v_exp_f32 v153, v153
    v_exp_f32 v154, v154
    v_exp_f32 v155, v155
    v_mfma_f32_32x32x16_bf16 v[32:47], v[132:135], v[180:183], v[32:47]
    v_exp_f32 v156, v156
    v_exp_f32 v157, v157
    v_exp_f32 v158, v158
    v_exp_f32 v159, v159
    v_cvt_pk_bf16_f32 v184, v144, v145
    v_cvt_pk_bf16_f32 v185, v146, v147
    v_cvt_pk_bf16_f32 v186, v148, v149
    v_cvt_pk_bf16_f32 v187, v150, v151
    v_cvt_pk_bf16_f32 v188, v152, v153
    v_cvt_pk_bf16_f32 v189, v154, v155
    v_cvt_pk_bf16_f32 v190, v156, v157
    v_cvt_pk_bf16_f32 v191, v158, v159
    s_cmp_gt_u32 s54, 6
    s_cbranch_scc0 L_ok_101018
    v_mov_b32 v160, 0xf149f2ca
    v_mov_b32 v161, 0xf149f2ca
    v_mov_b32 v162, 0xf149f2ca
    v_mov_b32 v163, 0xf149f2ca
    v_mov_b32 v164, 0xf149f2ca
    v_mov_b32 v165, 0xf149f2ca
    v_mov_b32 v166, 0xf149f2ca
    v_mov_b32 v167, 0xf149f2ca
    v_mov_b32 v168, 0xf149f2ca
    v_mov_b32 v169, 0xf149f2ca
    v_mov_b32 v170, 0xf149f2ca
    v_mov_b32 v171, 0xf149f2ca
    v_mov_b32 v172, 0xf149f2ca
    v_mov_b32 v173, 0xf149f2ca
    v_mov_b32 v174, 0xf149f2ca
    v_mov_b32 v175, 0xf149f2ca
L_ok_101018:
    v_mfma_f32_32x32x16_bf16 v[144:159], v[96:99], v[20:23], v[112:127]
    v_exp_f32 v160, v160
    s_mov_b64 exec, s[96:97]
    ds_read_b128 v[56:59], v109 offset:6144
    ds_read_b128 v[60:63], v109 offset:6656
    s_mov_b64 exec, -1
    v_exp_f32 v161, v161
    v_exp_f32 v162, v162
    v_exp_f32 v163, v163
    v_exp_f32 v164, v164
    v_exp_f32 v165, v165
    s_waitcnt lgkmcnt(2)
    v_mfma_f32_32x32x16_bf16 v[32:47], v[48:51], v[184:187], v[32:47]
    v_exp_f32 v166, v166
    v_exp_f32 v167, v167
    v_exp_f32 v168, v168
    v_exp_f32 v169, v169
    v_exp_f32 v170, v170
    v_exp_f32 v171, v171
    v_mfma_f32_32x32x16_bf16 v[32:47], v[52:55], v[188:191], v[32:47]
    v_exp_f32 v172, v172
    v_exp_f32 v173, v173
    v_exp_f32 v174, v174
    v_exp_f32 v175, v175
    v_cvt_pk_bf16_f32 v176, v160, v161
    v_cvt_pk_bf16_f32 v177, v162, v163
    v_cvt_pk_bf16_f32 v178, v164, v165
    v_cvt_pk_bf16_f32 v179, v166, v167
    v_cvt_pk_bf16_f32 v180, v168, v169
    v_cvt_pk_bf16_f32 v181, v170, v171
    v_cvt_pk_bf16_f32 v182, v172, v173
    v_cvt_pk_bf16_f32 v183, v174, v175
    s_cmp_gt_u32 s54, 7
    s_cbranch_scc0 L_ok_101019
    v_mov_b32 v144, 0xf149f2ca
    v_mov_b32 v145, 0xf149f2ca
    v_mov_b32 v146, 0xf149f2ca
    v_mov_b32 v147, 0xf149f2ca
    v_mov_b32 v148, 0xf149f2ca
    v_mov_b32 v149, 0xf149f2ca
    v_mov_b32 v150, 0xf149f2ca
    v_mov_b32 v151, 0xf149f2ca
    v_mov_b32 v152, 0xf149f2ca
    v_mov_b32 v153, 0xf149f2ca
    v_mov_b32 v154, 0xf149f2ca
    v_mov_b32 v155, 0xf149f2ca
    v_mov_b32 v156, 0xf149f2ca
    v_mov_b32 v157, 0xf149f2ca
    v_mov_b32 v158, 0xf149f2ca
    v_mov_b32 v159, 0xf149f2ca
L_ok_101019:
    s_barrier
    s_cmp_lg_u32 s49, 3
    s_cbranch_scc0 L_nox1_101020
    s_lshl_b32 s58, s52, 2
    s_add_u32 s58, s58, s45
    s_lshl_b32 s61, s58, 15
    s_add_u32 s61, s61, 25165824
    s_andn2_b32 s59, s61, 0x1fff
    s_add_u32 s61, s61, s59
    s_andn2_b32 s59, s61, 0x1fffff
    s_add_u32 s61, s61, s59
    s_add_u32 s61, s61, s25
    buffer_load_dwordx4 v[208:211], v2, s[28:31], s61 offen offset:0 sc1
    buffer_load_dwordx4 v[212:215], v2, s[28:31], s61 offen offset:1024 sc1
    buffer_load_dwordx4 v[216:219], v2, s[28:31], s61 offen offset:2048 sc1
    buffer_load_dwordx4 v[220:223], v2, s[28:31], s61 offen offset:3072 sc1
    s_add_u32 s61, s61, 4096
L_nox1_101020:
    v_exp_f32 v144, v144
    s_mov_b64 exec, s[96:97]
    ds_read_b128 v[128:131], v109 offset:7168
    ds_read_b128 v[132:135], v109 offset:7680
    s_mov_b64 exec, -1
    v_exp_f32 v145, v145
    v_exp_f32 v146, v146
    v_exp_f32 v147, v147
    v_exp_f32 v148, v148
    v_exp_f32 v149, v149
    s_waitcnt lgkmcnt(2)
    v_mfma_f32_32x32x16_bf16 v[32:47], v[56:59], v[176:179], v[32:47]
    v_exp_f32 v150, v150
    v_exp_f32 v151, v151
    v_exp_f32 v152, v152
    v_exp_f32 v153, v153
    v_exp_f32 v154, v154
    v_exp_f32 v155, v155
    v_mfma_f32_32x32x16_bf16 v[32:47], v[60:63], v[180:183], v[32:47]
    v_exp_f32 v156, v156
    v_exp_f32 v157, v157
    v_exp_f32 v158, v158
    v_exp_f32 v159, v159
    v_cvt_pk_bf16_f32 v184, v144, v145
    v_cvt_pk_bf16_f32 v185, v146, v147
    v_cvt_pk_bf16_f32 v186, v148, v149
    v_cvt_pk_bf16_f32 v187, v150, v151
    v_cvt_pk_bf16_f32 v188, v152, v153
    v_cvt_pk_bf16_f32 v189, v154, v155
    v_cvt_pk_bf16_f32 v190, v156, v157
    v_cvt_pk_bf16_f32 v191, v158, v159
    s_waitcnt lgkmcnt(0)
    v_mfma_f32_32x32x16_bf16 v[32:47], v[128:131], v[184:187], v[32:47]
    s_lshl_b32 s56, s51, 3
    s_add_u32 s56, s56, s44
    s_lshl_b32 s56, s56, 5
    s_add_u32 s56, s56, s50
    v_mfma_f32_32x32x16_bf16 v[32:47], v[132:135], v[188:191], v[32:47]
    s_lshl_b32 s56, s56, 10
    s_add_u32 s56, s56, 27262976
    s_andn2_b32 s59, s56, 0x1fff
    s_add_u32 s56, s56, s59
    s_andn2_b32 s59, s56, 0x1fffff
    s_add_u32 s56, s56, s59
    s_add_u32 s56, s56, s25
    s_nop 4
    v_mov_b32 v41, 0x67800000
    s_branch L_attj_100009
L_g3idle_101022:
    s_waitcnt vmcnt(0)
    s_barrier
    s_cmp_lt_u32 s53, 14
    s_cbranch_scc0 L_nocsum
    v_lshrrev_b32 v112, 5, v1
    v_bfe_u32 v113, v1, 2, 2
    v_lshl_add_u32 v113, v112, 2, v113
    v_lshlrev_b32 v114, 7, v113
    v_bfe_u32 v113, v1, 3, 1
    v_xor_b32 v113, s47, v113
    v_lshl_add_u32 v114, v113, 6, v114
    v_bfe_u32 v113, v1, 4, 1
    v_lshl_add_u32 v114, v113, 5, v114
    v_and_b32 v113, 3, v1
    v_lshl_add_u32 v114, v113, 3, v114
    s_lshl_b32 s56, s46, 16
    v_add_u32 v114, s56, v114
    v_bfe_u32 v112, v1, 2, 1
    v_bfe_u32 v113, v1, 4, 1
    v_cmp_eq_u32 vcc, v112, v113
    v_mov_b32 v113, 0x3f803f80
    v_and_b32 v112, 31, v1
    v_cndmask_b32 v116, 0, v113, vcc
    v_cndmask_b32 v117, 0, v113, vcc
    v_cndmask_b32 v118, 0, v113, vcc
    v_cndmask_b32 v119, 0, v113, vcc
    ds_read_b64_tr_b16 v[124:125], v114 offset:0
    ds_read_b64_tr_b16 v[126:127], v114 offset:1024
    ds_read_b64_tr_b16 v[128:129], v114 offset:2048
    ds_read_b64_tr_b16 v[130:131], v114 offset:3072
    ds_read_b64_tr_b16 v[132:133], v114 offset:4096
    ds_read_b64_tr_b16 v[134:135], v114 offset:5120
    ds_read_b64_tr_b16 v[136:137], v114 offset:6144
    ds_read_b64_tr_b16 v[138:139], v114 offset:7168
    ds_read_b64_tr_b16 v[140:141], v114 offset:8192
    ds_read_b64_tr_b16 v[142:143], v114 offset:9216
    ds_read_b64_tr_b16 v[144:145], v114 offset:10240
    ds_read_b64_tr_b16 v[146:147], v114 offset:11264
    ds_read_b64_tr_b16 v[148:149], v114 offset:12288
    ds_read_b64_tr_b16 v[150:151], v114 offset:13312
    s_waitcnt lgkmcnt(12)
    v_mfma_f32_16x16x32_bf16 v[120:123], v[116:119], v[124:127], 0
    ds_read_b64_tr_b16 v[152:153], v114 offset:14336
    ds_read_b64_tr_b16 v[154:155], v114 offset:15360
    s_waitcnt lgkmcnt(12)
    v_mfma_f32_16x16x32_bf16 v[120:123], v[116:119], v[128:131], v[120:123]
    ds_read_b64_tr_b16 v[124:125], v114 offset:16384
    ds_read_b64_tr_b16 v[126:127], v114 offset:17408
    s_waitcnt lgkmcnt(12)
    v_mfma_f32_16x16x32_bf16 v[120:123], v[116:119], v[132:135], v[120:123]
    ds_read_b64_tr_b16 v[128:129], v114 offset:18432
    ds_read_b64_tr_b16 v[130:131], v114 offset:19456
    s_waitcnt lgkmcnt(12)
    v_mfma_f32_16x16x32_bf16 v[120:123], v[116:119], v[136:139], v[120:123]
    ds_read_b64_tr_b16 v[132:133], v114 offset:20480
    ds_read_b64_tr_b16 v[134:135], v114 offset:21504
    s_waitcnt lgkmcnt(12)
    v_mfma_f32_16x16x32_bf16 v[120:123], v[116:119], v[140:143], v[120:123]
    ds_read_b64_tr_b16 v[136:137], v114 offset:22528
    ds_read_b64_tr_b16 v[138:139], v114 offset:23552
    s_waitcnt lgkmcnt(12)
    v_mfma_f32_16x16x32_bf16 v[120:123], v[116:119], v[144:147], v[120:123]
    ds_read_b64_tr_b16 v[140:141], v114 offset:24576
    ds_read_b64_tr_b16 v[142:143], v114 offset:25600
    s_waitcnt lgkmcnt(12)
    v_mfma_f32_16x16x32_bf16 v[120:123], v[116:119], v[148:151], v[120:123]
    ds_read_b64_tr_b16 v[144:145], v114 offset:26624
    ds_read_b64_tr_b16 v[146:147], v114 offset:27648
    s_waitcnt lgkmcnt(12)
    v_mfma_f32_16x16x32_bf16 v[120:123], v[116:119], v[152:155], v[120:123]
    ds_read_b64_tr_b16 v[148:149], v114 offset:28672
    ds_read_b64_tr_b16 v[150:151], v114 offset:29696
    s_waitcnt lgkmcnt(12)
    v_mfma_f32_16x16x32_bf16 v[120:123], v[116:119], v[124:127], v[120:123]
    ds_read_b64_tr_b16 v[152:153], v114 offset:30720
    ds_read_b64_tr_b16 v[154:155], v114 offset:31744
    s_waitcnt lgkmcnt(12)
    v_mfma_f32_16x16x32_bf16 v[120:123], v[116:119], v[128:131], v[120:123]
    ds_read_b64_tr_b16 v[124:125], v114 offset:32768
    ds_read_b64_tr_b16 v[126:127], v114 offset:33792
    s_waitcnt lgkmcnt(12)
    v_mfma_f32_16x16x32_bf16 v[120:123], v[116:119], v[132:135], v[120:123]
    ds_read_b64_tr_b16 v[128:129], v114 offset:34816
    ds_read_b64_tr_b16 v[130:131], v114 offset:35840
    s_waitcnt lgkmcnt(12)
    v_mfma_f32_16x16x32_bf16 v[120:123], v[116:119], v[136:139], v[120:123]
    ds_read_b64_tr_b16 v[132:133], v114 offset:36864
    ds_read_b64_tr_b16 v[134:135], v114 offset:37888
    s_waitcnt lgkmcnt(12)
    v_mfma_f32_16x16x32_bf16 v[120:123], v[116:119], v[140:143], v[120:123]
    ds_read_b64_tr_b16 v[136:137], v114 offset:38912
    ds_read_b64_tr_b16 v[138:139], v114 offset:39936
    s_waitcnt lgkmcnt(12)
    v_mfma_f32_16x16x32_bf16 v[120:123], v[116:119], v[144:147], v[120:123]
    ds_read_b64_tr_b16 v[140:141], v114 offset:40960
    ds_read_b64_tr_b16 v[142:143], v114 offset:41984
    s_waitcnt lgkmcnt(12)
    v_mfma_f32_16x16x32_bf16 v[120:123], v[116:119], v[148:151], v[120:123]
    ds_read_b64_tr_b16 v[144:145], v114 offset:43008
    ds_read_b64_tr_b16 v[146:147], v114 offset:44032
    s_waitcnt lgkmcnt(12)
    v_mfma_f32_16x16x32_bf16 v[120:123], v[116:119], v[152:155], v[120:123]
    ds_read_b64_tr_b16 v[148:149], v114 offset:45056
    ds_read_b64_tr_b16 v[150:151], v114 offset:46080
    s_waitcnt lgkmcnt(12)
    v_mfma_f32_16x16x32_bf16 v[120:123], v[116:119], v[124:127], v[120:123]
    ds_read_b64_tr_b16 v[152:153], v114 offset:47104
    ds_read_b64_tr_b16 v[154:155], v114 offset:48128
    s_waitcnt lgkmcnt(12)
    v_mfma_f32_16x16x32_bf16 v[120:123], v[116:119], v[128:131], v[120:123]
    ds_read_b64_tr_b16 v[124:125], v114 offset:49152
    ds_read_b64_tr_b16 v[126:127], v114 offset:50176
    s_waitcnt lgkmcnt(12)
    v_mfma_f32_16x16x32_bf16 v[120:123], v[116:119], v[132:135], v[120:123]
    ds_read_b64_tr_b16 v[128:129], v114 offset:51200
    ds_read_b64_tr_b16 v[130:131], v114 offset:52224
    s_waitcnt lgkmcnt(12)
    v_mfma_f32_16x16x32_bf16 v[120:123], v[116:119], v[136:139], v[120:123]
    ds_read_b64_tr_b16 v[132:133], v114 offset:53248
    ds_read_b64_tr_b16 v[134:135], v114 offset:54272
    s_waitcnt lgkmcnt(12)
    v_mfma_f32_16x16x32_bf16 v[120:123], v[116:119], v[140:143], v[120:123]
    ds_read_b64_tr_b16 v[136:137], v114 offset:55296
    ds_read_b64_tr_b16 v[138:139], v114 offset:56320
    s_waitcnt lgkmcnt(12)
    v_mfma_f32_16x16x32_bf16 v[120:123], v[116:119], v[144:147], v[120:123]
    ds_read_b64_tr_b16 v[140:141], v114 offset:57344
    ds_read_b64_tr_b16 v[142:143], v114 offset:58368
    s_waitcnt lgkmcnt(12)
    v_mfma_f32_16x16x32_bf16 v[120:123], v[116:119], v[148:151], v[120:123]
    ds_read_b64_tr_b16 v[144:145], v114 offset:59392
    ds_read_b64_tr_b16 v[146:147], v114 offset:60416
    s_waitcnt lgkmcnt(12)
    v_mfma_f32_16x16x32_bf16 v[120:123], v[116:119], v[152:155], v[120:123]
    ds_read_b64_tr_b16 v[148:149], v114 offset:61440
    ds_read_b64_tr_b16 v[150:151], v114 offset:62464
    s_waitcnt lgkmcnt(12)
    v_mfma_f32_16x16x32_bf16 v[120:123], v[116:119], v[124:127], v[120:123]
    ds_read_b64_tr_b16 v[152:153], v114 offset:63488
    ds_read_b64_tr_b16 v[154:155], v114 offset:64512
    s_waitcnt lgkmcnt(12)
    v_mfma_f32_16x16x32_bf16 v[120:123], v[116:119], v[128:131], v[120:123]
    s_waitcnt lgkmcnt(10)
    v_mfma_f32_16x16x32_bf16 v[120:123], v[116:119], v[132:135], v[120:123]
    s_waitcnt lgkmcnt(8)
    v_mfma_f32_16x16x32_bf16 v[120:123], v[116:119], v[136:139], v[120:123]
    s_waitcnt lgkmcnt(6)
    v_mfma_f32_16x16x32_bf16 v[120:123], v[116:119], v[140:143], v[120:123]
    s_waitcnt lgkmcnt(4)
    v_mfma_f32_16x16x32_bf16 v[120:123], v[116:119], v[144:147], v[120:123]
    s_waitcnt lgkmcnt(2)
    v_mfma_f32_16x16x32_bf16 v[120:123], v[116:119], v[148:151], v[120:123]
    s_waitcnt lgkmcnt(0)
    v_mfma_f32_16x16x32_bf16 v[120:123], v[116:119], v[152:155], v[120:123]
    v_lshlrev_b32 v112, 2, v1
    s_lshl_b32 s56, s53, 2
    s_add_u32 s56, s56, s45
    s_lshl_b32 s56, s56, 7
    s_add_u32 s56, s56, 13369344
    s_lshl_b32 s58, s53, 7
    s_add_u32 s58, s58, 13107236
    v_lshrrev_b32 v19, 2, v1
    v_lshrrev_b32 v113, v19, s24
    v_and_b32 v113, 1, v113
    v_add_u32 v19, v19, v113
    v_lshl_add_u32 v113, v19, 2, v1
    v_lshlrev_b32 v113, 11, v113
    v_mov_b32 v19, 1
    s_mov_b32 exec_hi, 0
    buffer_store_dword v120, v112, s[28:31], s56 offen sc1
    s_mov_b32 exec_lo, 0xffff
    s_waitcnt vmcnt(0)
    buffer_atomic_add v19, v113, s[28:31], s58 offen sc1
    s_mov_b64 exec, -1
L_nocsum:
    s_barrier
    v_lshlrev_b32 v19, 7, v1
    buffer_load_dword v16, v19, s[36:39], s15 offen
    s_barrier
    s_barrier
    s_barrier
    s_barrier
    s_barrier
    s_barrier
    s_barrier
    v_lshrrev_b32 v40, 5, v1
    v_bfe_u32 v41, v1, 2, 2
    v_lshl_add_u32 v41, v40, 2, v41
    v_lshlrev_b32 v20, 7, v41
    v_bfe_u32 v41, v1, 3, 1
    v_xor_b32 v41, s47, v41
    v_lshl_add_u32 v20, v41, 6, v20
    v_bfe_u32 v41, v1, 4, 1
    v_lshl_add_u32 v20, v41, 5, v20
    v_and_b32 v41, 3, v1
    v_lshl_add_u32 v20, v41, 3, v20
    s_lshl_b32 s56, s47, 11
    v_add_u32 v20, s56, v20
    v_xor_b32 v21, 64, v20
    v_add_u32 v22, 0x20000, v20
    v_add_u32 v23, 0x20000, v21
    s_lshr_b32 s59, s48, 1
    s_and_b32 s59, s59, 3
    s_lshl_b32 s68, s59, 16
    s_add_u32 s69, s68, 32768
    s_cmp_eq_u32 s69, 229376
    s_cselect_b32 s69, 0, s69
    s_add_u32 s70, s69, 32768
    s_cmp_eq_u32 s70, 229376
    s_cselect_b32 s70, 0, s70
    s_add_u32 s71, s70, 32768
    s_cmp_eq_u32 s71, 229376
    s_cselect_b32 s71, 0, s71
    s_add_u32 s72, s71, 32768
    s_cmp_eq_u32 s72, 229376
    s_cselect_b32 s72, 0, s72
    s_add_u32 s73, s72, 32768
    s_cmp_eq_u32 s73, 229376
    s_cselect_b32 s73, 0, s73
    s_add_u32 s74, s73, 32768
    s_cmp_eq_u32 s74, 229376
    s_cselect_b32 s74, 0, s74
    s_xor_b32 s59, s48, 0
    s_lshl_b32 s59, s59, 1
    s_add_u32 s59, s59, s46
    s_lshl_b32 s75, s59, 17
    s_and_b32 s57, s48, 1
    s_lshl_b32 s57, s57, 3
    s_add_u32 s57, s57, s47
    s_lshl_b32 s57, s57, 10
    s_add_u32 s75, s75, s57
    s_add_u32 s75, s75, 41943040
    s_andn2_b32 s59, s75, 0x1fff
    s_add_u32 s75, s75, s59
    s_andn2_b32 s59, s75, 0x1fffff
    s_add_u32 s75, s75, s59
    s_add_u32 s75, s75, s25
    s_add_u32 s76, s75, 4096
    s_xor_b32 s59, s75, 16384
    s_add_u32 s77, s59, 6144
    s_xor_b32 s59, s48, 0
    s_lshl_b32 s59, s59, 1
    s_add_u32 s59, s59, s46
    s_lshl_b32 s59, s59, 1
    s_and_b32 s57, s48, 1
    s_add_u32 s59, s59, s57
    s_lshl_b32 s78, s59, 1
    s_bfe_u32 s57, s48, 0x10001
    s_add_u32 s59, s78, s57
    s_lshl_b32 s59, s59, 3
    s_add_u32 s59, s59, s47
    s_lshl_b32 s59, s59, 10
    s_add_u32 s78, s59, 27262976
    s_andn2_b32 s59, s78, 0x1fff
    s_add_u32 s78, s78, s59
    s_andn2_b32 s59, s78, 0x1fffff
    s_add_u32 s78, s78, s59
    s_add_u32 s78, s78, s25
    s_xor_b32 s79, s78, 16384
    s_xor_b32 s59, s48, 0
    s_lshl_b32 s59, s59, 1
    s_add_u32 s59, s59, s46
    s_and_b32 s80, s59, 3
    s_lshr_b32 s59, s48, 1
    s_lshl_b32 s59, s59, 3
    s_add_u32 s59, s59, s49
    s_lshl_b32 s59, s59, 2
    s_add_u32 s59, s59, s80
    s_lshl_b32 s59, s59, 7
    s_add_u32 s80, s59, 13238272
    s_add_u32 s81, s78, 0
    buffer_load_dwordx4 v[208:211], v2, s[28:31], s81 offen offset:0 sc1
    s_add_u32 s81, s78, 0
    buffer_load_dwordx4 v[212:215], v2, s[28:31], s81 offen offset:2048 sc1
    s_add_u32 s81, s78, 4096
    buffer_load_dwordx4 v[216:219], v2, s[28:31], s81 offen offset:0 sc1
    s_add_u32 s81, s78, 4096
    buffer_load_dwordx4 v[220:223], v2, s[28:31], s81 offen offset:2048 sc1
    s_add_u32 s81, s79, 0
    buffer_load_dwordx4 v[224:227], v2, s[28:31], s81 offen offset:0 sc1
    s_add_u32 s81, s79, 0
    buffer_load_dwordx4 v[228:231], v2, s[28:31], s81 offen offset:2048 sc1
    s_add_u32 s81, s79, 4096
    buffer_load_dwordx4 v[232:235], v2, s[28:31], s81 offen offset:0 sc1
    s_add_u32 s81, s79, 4096
    buffer_load_dwordx4 v[236:239], v2, s[28:31], s81 offen offset:2048 sc1
    s_waitcnt vmcnt(0)
    s_branch L_g3join_101023
L_attg_33:
    ds_read_b128 v[64:67], v108 offset:0
    ds_read_b128 v[68:71], v108 offset:8192
    ds_read_b128 v[72:75], v108 offset:1024
    ds_read_b128 v[76:79], v108 offset:2048
    ds_read_b128 v[80:83], v108 offset:3072
    ds_read_b128 v[84:87], v108 offset:4096
    ds_read_b128 v[88:91], v108 offset:5120
    ds_read_b128 v[92:95], v108 offset:6144
    ds_read_b128 v[96:99], v108 offset:7168
    s_waitcnt lgkmcnt(8)
    v_mfma_f32_32x32x16_bf16 v[144:159], v[64:67], v[20:23], 0
    s_waitcnt lgkmcnt(7)
    v_mfma_f32_32x32x16_bf16 v[128:143], v[68:71], v[20:23], 0
    s_nop 11
    s_cmp_gt_u32 s54, 0
    s_cbranch_scc0 L_ok_1037
    v_mov_b32 v144, 0xf149f2ca
    v_mov_b32 v145, 0xf149f2ca
    v_mov_b32 v146, 0xf149f2ca
    v_mov_b32 v147, 0xf149f2ca
    v_mov_b32 v148, 0xf149f2ca
    v_mov_b32 v149, 0xf149f2ca
    v_mov_b32 v150, 0xf149f2ca
    v_mov_b32 v151, 0xf149f2ca
    v_mov_b32 v152, 0xf149f2ca
    v_mov_b32 v153, 0xf149f2ca
    v_mov_b32 v154, 0xf149f2ca
    v_mov_b32 v155, 0xf149f2ca
    v_mov_b32 v156, 0xf149f2ca
    v_mov_b32 v157, 0xf149f2ca
    v_mov_b32 v158, 0xf149f2ca
    v_mov_b32 v159, 0xf149f2ca
L_ok_1037:
    v_cndmask_b32 v128, v144, v128, s[64:65]
    v_cndmask_b32 v129, v145, v129, s[66:67]
    v_cndmask_b32 v130, v146, v130, s[68:69]
    v_cndmask_b32 v131, v147, v131, s[70:71]
    v_cndmask_b32 v132, v148, v132, s[72:73]
    v_cndmask_b32 v133, v149, v133, s[74:75]
    s_waitcnt lgkmcnt(0)
    v_cndmask_b32 v134, v150, v134, s[76:77]
    v_cndmask_b32 v135, v151, v135, s[78:79]
    v_cndmask_b32 v136, v152, v136, s[80:81]
    v_cndmask_b32 v137, v153, v137, s[82:83]
    v_cndmask_b32 v138, v154, v138, s[84:85]
    v_cndmask_b32 v139, v155, v139, s[86:87]
    v_cndmask_b32 v140, v156, v140, s[88:89]
    v_cndmask_b32 v141, v157, v141, s[90:91]
    v_cndmask_b32 v142, v158, v142, s[92:93]
    v_cndmask_b32 v143, v159, v143, s[94:95]
    v_max_f32 v100, v128, v129
    v_max_f32 v101, v130, v131
    v_max3_f32 v100, v132, v133, v100
    v_max3_f32 v101, v134, v135, v101
    v_max3_f32 v100, v136, v137, v100
    v_max3_f32 v101, v138, v139, v101
    v_max3_f32 v100, v140, v141, v100
    v_max3_f32 v101, v142, v143, v101
    v_max_f32 v100, v100, v101
    v_mov_b32 v101, v100
    s_nop 1
    v_permlane32_swap_b32 v100, v101
    s_nop 0
    v_max_f32 v100, v100, v101
    v_sub_f32 v112, 0, v100
    v_mov_b32 v113, v112
    v_mov_b32 v114, v112
    v_mov_b32 v115, v112
    v_mov_b32 v116, v112
    v_mov_b32 v117, v112
    v_mov_b32 v118, v112
    v_mov_b32 v119, v112
    v_mov_b32 v120, v112
    v_mov_b32 v121, v112
    v_mov_b32 v122, v112
    v_mov_b32 v123, v112
    v_mov_b32 v124, v112
    v_mov_b32 v125, v112
    v_mov_b32 v126, v112
    v_mov_b32 v127, v112
    s_waitcnt vmcnt(16)
    s_cmp_lg_u32 s49, 3
    s_cbranch_scc1 L_nw_1038
    s_waitcnt vmcnt(0)
L_nw_1038:
    s_barrier
    s_setprio 1
    v_add_f32 v128, v128, v112
    v_add_f32 v129, v129, v113
    v_mfma_f32_32x32x16_bf16 v[144:159], v[72:75], v[20:23], v[112:127]
    v_add_f32 v130, v130, v114
    v_add_f32 v131, v131, v115
    v_add_f32 v132, v132, v116
    v_add_f32 v133, v133, v117
    v_add_f32 v134, v134, v118
    v_add_f32 v135, v135, v119
    v_add_f32 v136, v136, v120
    v_add_f32 v137, v137, v121
    v_add_f32 v138, v138, v122
    v_add_f32 v139, v139, v123
    v_add_f32 v140, v140, v124
    v_add_f32 v141, v141, v125
    v_add_f32 v142, v142, v126
    v_add_f32 v143, v143, v127
    v_exp_f32 v128, v128
    v_exp_f32 v129, v129
    v_exp_f32 v130, v130
    v_exp_f32 v131, v131
    v_exp_f32 v132, v132
    v_exp_f32 v133, v133
    v_exp_f32 v134, v134
    v_exp_f32 v135, v135
    v_exp_f32 v136, v136
    v_exp_f32 v137, v137
    v_exp_f32 v138, v138
    v_exp_f32 v139, v139
    v_exp_f32 v140, v140
    v_exp_f32 v141, v141
    v_exp_f32 v142, v142
    v_exp_f32 v143, v143
    v_cvt_pk_bf16_f32 v200, v128, v129
    v_cvt_pk_bf16_f32 v201, v130, v131
    v_cvt_pk_bf16_f32 v202, v132, v133
    v_cvt_pk_bf16_f32 v203, v134, v135
    v_cvt_pk_bf16_f32 v204, v136, v137
    v_cvt_pk_bf16_f32 v205, v138, v139
    v_cvt_pk_bf16_f32 v206, v140, v141
    v_cvt_pk_bf16_f32 v207, v142, v143
    v_mov_b32 v128, 0x3f803f80
    v_mov_b32 v129, v128
    v_mov_b32 v130, v128
    v_mov_b32 v131, v128
    v_mov_b32 v132, v128
    v_mov_b32 v133, v128
    v_mov_b32 v134, v128
    v_mov_b32 v135, v128
    s_mov_b64 exec, s[96:97]
    ds_read_b128 v[48:51], v109 offset:8192
    ds_read_b128 v[52:55], v109 offset:8704
    ds_read_b128 v[56:59], v109 offset:0
    ds_read_b128 v[60:63], v109 offset:512
    s_mov_b64 exec, -1
    v_and_b32 v192, v200, v24
    v_and_b32 v193, v201, v25
    v_and_b32 v194, v202, v26
    v_and_b32 v195, v203, v27
    v_and_b32 v196, v204, v28
    v_and_b32 v197, v205, v29
    v_and_b32 v198, v206, v30
    v_and_b32 v199, v207, v31
    v_xor_b32 v200, v200, v192
    v_xor_b32 v201, v201, v193
    v_xor_b32 v202, v202, v194
    v_xor_b32 v203, v203, v195
    v_xor_b32 v204, v204, v196
    v_xor_b32 v205, v205, v197
    v_xor_b32 v206, v206, v198
    v_xor_b32 v207, v207, v199
    s_cmp_gt_u32 s54, 1
    s_cbranch_scc0 L_ok_1039
    v_mov_b32 v144, 0xf149f2ca
    v_mov_b32 v145, 0xf149f2ca
    v_mov_b32 v146, 0xf149f2ca
    v_mov_b32 v147, 0xf149f2ca
    v_mov_b32 v148, 0xf149f2ca
    v_mov_b32 v149, 0xf149f2ca
    v_mov_b32 v150, 0xf149f2ca
    v_mov_b32 v151, 0xf149f2ca
    v_mov_b32 v152, 0xf149f2ca
    v_mov_b32 v153, 0xf149f2ca
    v_mov_b32 v154, 0xf149f2ca
    v_mov_b32 v155, 0xf149f2ca
    v_mov_b32 v156, 0xf149f2ca
    v_mov_b32 v157, 0xf149f2ca
    v_mov_b32 v158, 0xf149f2ca
    v_mov_b32 v159, 0xf149f2ca
L_ok_1039:
    v_mfma_f32_32x32x16_bf16 v[160:175], v[76:79], v[20:23], v[112:127]
    v_exp_f32 v144, v144
    s_mov_b64 exec, s[96:97]
    ds_read_b128 v[128:131], v109 offset:1024
    ds_read_b128 v[132:135], v109 offset:1536
    s_mov_b64 exec, -1
    v_exp_f32 v145, v145
    v_exp_f32 v146, v146
    v_exp_f32 v147, v147
    s_waitcnt lgkmcnt(4)
    v_mfma_f32_32x32x16_bf16 v[32:47], v[48:51], v[192:195], 0
    v_exp_f32 v148, v148
    v_exp_f32 v149, v149
    v_exp_f32 v150, v150
    v_exp_f32 v151, v151
    v_mfma_f32_32x32x16_bf16 v[32:47], v[52:55], v[196:199], v[32:47]
    v_exp_f32 v152, v152
    v_exp_f32 v153, v153
    v_exp_f32 v154, v154
    v_exp_f32 v155, v155
    s_waitcnt lgkmcnt(2)
    v_mfma_f32_32x32x16_bf16 v[32:47], v[56:59], v[200:203], v[32:47]
    v_exp_f32 v156, v156
    v_exp_f32 v157, v157
    v_exp_f32 v158, v158
    v_exp_f32 v159, v159
    v_mfma_f32_32x32x16_bf16 v[32:47], v[60:63], v[204:207], v[32:47]
    v_cvt_pk_bf16_f32 v184, v144, v145
    v_cvt_pk_bf16_f32 v185, v146, v147
    v_cvt_pk_bf16_f32 v186, v148, v149
    v_cvt_pk_bf16_f32 v187, v150, v151
    v_cvt_pk_bf16_f32 v188, v152, v153
    v_cvt_pk_bf16_f32 v189, v154, v155
    v_cvt_pk_bf16_f32 v190, v156, v157
    v_cvt_pk_bf16_f32 v191, v158, v159
    s_cmp_gt_u32 s54, 2
    s_cbranch_scc0 L_ok_1040
    v_mov_b32 v160, 0xf149f2ca
    v_mov_b32 v161, 0xf149f2ca
    v_mov_b32 v162, 0xf149f2ca
    v_mov_b32 v163, 0xf149f2ca
    v_mov_b32 v164, 0xf149f2ca
    v_mov_b32 v165, 0xf149f2ca
    v_mov_b32 v166, 0xf149f2ca
    v_mov_b32 v167, 0xf149f2ca
    v_mov_b32 v168, 0xf149f2ca
    v_mov_b32 v169, 0xf149f2ca
    v_mov_b32 v170, 0xf149f2ca
    v_mov_b32 v171, 0xf149f2ca
    v_mov_b32 v172, 0xf149f2ca
    v_mov_b32 v173, 0xf149f2ca
    v_mov_b32 v174, 0xf149f2ca
    v_mov_b32 v175, 0xf149f2ca
L_ok_1040:
    v_mfma_f32_32x32x16_bf16 v[144:159], v[80:83], v[20:23], v[112:127]
    v_exp_f32 v160, v160
    s_mov_b64 exec, s[96:97]
    ds_read_b128 v[48:51], v109 offset:2048
    ds_read_b128 v[52:55], v109 offset:2560
    s_mov_b64 exec, -1
    v_exp_f32 v161, v161
    v_exp_f32 v162, v162
    v_exp_f32 v163, v163
    v_exp_f32 v164, v164
    v_exp_f32 v165, v165
    s_waitcnt lgkmcnt(2)
    v_mfma_f32_32x32x16_bf16 v[32:47], v[128:131], v[184:187], v[32:47]
    v_exp_f32 v166, v166
    v_exp_f32 v167, v167
    v_exp_f32 v168, v168
    v_exp_f32 v169, v169
    v_exp_f32 v170, v170
    v_exp_f32 v171, v171
    v_mfma_f32_32x32x16_bf16 v[32:47], v[132:135], v[188:191], v[32:47]
    v_exp_f32 v172, v172
    v_exp_f32 v173, v173
    v_exp_f32 v174, v174
    v_exp_f32 v175, v175
    v_cvt_pk_bf16_f32 v176, v160, v161
    v_cvt_pk_bf16_f32 v177, v162, v163
    v_cvt_pk_bf16_f32 v178, v164, v165
    v_cvt_pk_bf16_f32 v179, v166, v167
    v_cvt_pk_bf16_f32 v180, v168, v169
    v_cvt_pk_bf16_f32 v181, v170, v171
    v_cvt_pk_bf16_f32 v182, v172, v173
    v_cvt_pk_bf16_f32 v183, v174, v175
    s_cmp_gt_u32 s54, 3
    s_cbranch_scc0 L_ok_1041
    v_mov_b32 v144, 0xf149f2ca
    v_mov_b32 v145, 0xf149f2ca
    v_mov_b32 v146, 0xf149f2ca
    v_mov_b32 v147, 0xf149f2ca
    v_mov_b32 v148, 0xf149f2ca
    v_mov_b32 v149, 0xf149f2ca
    v_mov_b32 v150, 0xf149f2ca
    v_mov_b32 v151, 0xf149f2ca
    v_mov_b32 v152, 0xf149f2ca
    v_mov_b32 v153, 0xf149f2ca
    v_mov_b32 v154, 0xf149f2ca
    v_mov_b32 v155, 0xf149f2ca
    v_mov_b32 v156, 0xf149f2ca
    v_mov_b32 v157, 0xf149f2ca
    v_mov_b32 v158, 0xf149f2ca
    v_mov_b32 v159, 0xf149f2ca
L_ok_1041:
    v_mfma_f32_32x32x16_bf16 v[160:175], v[84:87], v[20:23], v[112:127]
    v_exp_f32 v144, v144
    s_mov_b64 exec, s[96:97]
    ds_read_b128 v[56:59], v109 offset:3072
    ds_read_b128 v[60:63], v109 offset:3584
    s_mov_b64 exec, -1
    v_exp_f32 v145, v145
    v_exp_f32 v146, v146
    v_exp_f32 v147, v147
    v_exp_f32 v148, v148
    v_exp_f32 v149, v149
    s_waitcnt lgkmcnt(2)
    v_mfma_f32_32x32x16_bf16 v[32:47], v[48:51], v[176:179], v[32:47]
    v_exp_f32 v150, v150
    v_exp_f32 v151, v151
    v_exp_f32 v152, v152
    v_exp_f32 v153, v153
    v_exp_f32 v154, v154
    v_exp_f32 v155, v155
    v_mfma_f32_32x32x16_bf16 v[32:47], v[52:55], v[180:183], v[32:47]
    v_exp_f32 v156, v156
    v_exp_f32 v157, v157
    v_exp_f32 v158, v158
    v_exp_f32 v159, v159
    v_cvt_pk_bf16_f32 v184, v144, v145
    v_cvt_pk_bf16_f32 v185, v146, v147
    v_cvt_pk_bf16_f32 v186, v148, v149
    v_cvt_pk_bf16_f32 v187, v150, v151
    v_cvt_pk_bf16_f32 v188, v152, v153
    v_cvt_pk_bf16_f32 v189, v154, v155
    v_cvt_pk_bf16_f32 v190, v156, v157
    v_cvt_pk_bf16_f32 v191, v158, v159
    s_cmp_gt_u32 s54, 4
    s_cbranch_scc0 L_ok_1042
    v_mov_b32 v160, 0xf149f2ca
    v_mov_b32 v161, 0xf149f2ca
    v_mov_b32 v162, 0xf149f2ca
    v_mov_b32 v163, 0xf149f2ca
    v_mov_b32 v164, 0xf149f2ca
    v_mov_b32 v165, 0xf149f2ca
    v_mov_b32 v166, 0xf149f2ca
    v_mov_b32 v167, 0xf149f2ca
    v_mov_b32 v168, 0xf149f2ca
    v_mov_b32 v169, 0xf149f2ca
    v_mov_b32 v170, 0xf149f2ca
    v_mov_b32 v171, 0xf149f2ca
    v_mov_b32 v172, 0xf149f2ca
    v_mov_b32 v173, 0xf149f2ca
    v_mov_b32 v174, 0xf149f2ca
    v_mov_b32 v175, 0xf149f2ca
L_ok_1042:
    v_mfma_f32_32x32x16_bf16 v[144:159], v[88:91], v[20:23], v[112:127]
    v_exp_f32 v160, v160
    s_mov_b64 exec, s[96:97]
    ds_read_b128 v[128:131], v109 offset:4096
    ds_read_b128 v[132:135], v109 offset:4608
    s_mov_b64 exec, -1
    v_exp_f32 v161, v161
    v_exp_f32 v162, v162
    v_exp_f32 v163, v163
    v_exp_f32 v164, v164
    v_exp_f32 v165, v165
    s_waitcnt lgkmcnt(2)
    v_mfma_f32_32x32x16_bf16 v[32:47], v[56:59], v[184:187], v[32:47]
    v_exp_f32 v166, v166
    v_exp_f32 v167, v167
    v_exp_f32 v168, v168
    v_exp_f32 v169, v169
    v_exp_f32 v170, v170
    v_exp_f32 v171, v171
    v_mfma_f32_32x32x16_bf16 v[32:47], v[60:63], v[188:191], v[32:47]
    v_exp_f32 v172, v172
    v_exp_f32 v173, v173
    v_exp_f32 v174, v174
    v_exp_f32 v175, v175
    v_cvt_pk_bf16_f32 v176, v160, v161
    v_cvt_pk_bf16_f32 v177, v162, v163
    v_cvt_pk_bf16_f32 v178, v164, v165
    v_cvt_pk_bf16_f32 v179, v166, v167
    v_cvt_pk_bf16_f32 v180, v168, v169
    v_cvt_pk_bf16_f32 v181, v170, v171
    v_cvt_pk_bf16_f32 v182, v172, v173
    v_cvt_pk_bf16_f32 v183, v174, v175
    s_waitcnt vmcnt(0)
    s_barrier
    s_cmp_gt_u32 s54, 5
    s_cbranch_scc0 L_ok_1043
    v_mov_b32 v144, 0xf149f2ca
    v_mov_b32 v145, 0xf149f2ca
    v_mov_b32 v146, 0xf149f2ca
    v_mov_b32 v147, 0xf149f2ca
    v_mov_b32 v148, 0xf149f2ca
    v_mov_b32 v149, 0xf149f2ca
    v_mov_b32 v150, 0xf149f2ca
    v_mov_b32 v151, 0xf149f2ca
    v_mov_b32 v152, 0xf149f2ca
    v_mov_b32 v153, 0xf149f2ca
    v_mov_b32 v154, 0xf149f2ca
    v_mov_b32 v155, 0xf149f2ca
    v_mov_b32 v156, 0xf149f2ca
    v_mov_b32 v157, 0xf149f2ca
    v_mov_b32 v158, 0xf149f2ca
    v_mov_b32 v159, 0xf149f2ca
L_ok_1043:
    v_mfma_f32_32x32x16_bf16 v[160:175], v[92:95], v[20:23], v[112:127]
    v_exp_f32 v144, v144
    s_mov_b64 exec, s[96:97]
    ds_read_b128 v[48:51], v109 offset:5120
    ds_read_b128 v[52:55], v109 offset:5632
    s_mov_b64 exec, -1
    v_exp_f32 v145, v145
    v_exp_f32 v146, v146
    v_exp_f32 v147, v147
    v_exp_f32 v148, v148
    v_exp_f32 v149, v149
    s_waitcnt lgkmcnt(2)
    v_mfma_f32_32x32x16_bf16 v[32:47], v[128:131], v[176:179], v[32:47]
    v_exp_f32 v150, v150
    v_exp_f32 v151, v151
    v_exp_f32 v152, v152
    v_exp_f32 v153, v153
    v_exp_f32 v154, v154
    v_exp_f32 v155, v155
    v_mfma_f32_32x32x16_bf16 v[32:47], v[132:135], v[180:183], v[32:47]
    v_exp_f32 v156, v156
    v_exp_f32 v157, v157
    v_exp_f32 v158, v158
    v_exp_f32 v159, v159
    v_cvt_pk_bf16_f32 v184, v144, v145
    v_cvt_pk_bf16_f32 v185, v146, v147
    v_cvt_pk_bf16_f32 v186, v148, v149
    v_cvt_pk_bf16_f32 v187, v150, v151
    v_cvt_pk_bf16_f32 v188, v152, v153
    v_cvt_pk_bf16_f32 v189, v154, v155
    v_cvt_pk_bf16_f32 v190, v156, v157
    v_cvt_pk_bf16_f32 v191, v158, v159
    s_cmp_gt_u32 s54, 6
    s_cbranch_scc0 L_ok_1044
    v_mov_b32 v160, 0xf149f2ca
    v_mov_b32 v161, 0xf149f2ca
    v_mov_b32 v162, 0xf149f2ca
    v_mov_b32 v163, 0xf149f2ca
    v_mov_b32 v164, 0xf149f2ca
    v_mov_b32 v165, 0xf149f2ca
    v_mov_b32 v166, 0xf149f2ca
    v_mov_b32 v167, 0xf149f2ca
    v_mov_b32 v168, 0xf149f2ca
    v_mov_b32 v169, 0xf149f2ca
    v_mov_b32 v170, 0xf149f2ca
    v_mov_b32 v171, 0xf149f2ca
    v_mov_b32 v172, 0xf149f2ca
    v_mov_b32 v173, 0xf149f2ca
    v_mov_b32 v174, 0xf149f2ca
    v_mov_b32 v175, 0xf149f2ca
L_ok_1044:
    v_mfma_f32_32x32x16_bf16 v[144:159], v[96:99], v[20:23], v[112:127]
    v_exp_f32 v160, v160
    s_mov_b64 exec, s[96:97]
    ds_read_b128 v[56:59], v109 offset:6144
    ds_read_b128 v[60:63], v109 offset:6656
    s_mov_b64 exec, -1
    v_exp_f32 v161, v161
    v_exp_f32 v162, v162
    v_exp_f32 v163, v163
    v_exp_f32 v164, v164
    v_exp_f32 v165, v165
    s_waitcnt lgkmcnt(2)
    v_mfma_f32_32x32x16_bf16 v[32:47], v[48:51], v[184:187], v[32:47]
    v_exp_f32 v166, v166
    v_exp_f32 v167, v167
    v_exp_f32 v168, v168
    v_exp_f32 v169, v169
    v_exp_f32 v170, v170
    v_exp_f32 v171, v171
    v_mfma_f32_32x32x16_bf16 v[32:47], v[52:55], v[188:191], v[32:47]
    v_exp_f32 v172, v172
    v_exp_f32 v173, v173
    v_exp_f32 v174, v174
    v_exp_f32 v175, v175
    v_cvt_pk_bf16_f32 v176, v160, v161
    v_cvt_pk_bf16_f32 v177, v162, v163
    v_cvt_pk_bf16_f32 v178, v164, v165
    v_cvt_pk_bf16_f32 v179, v166, v167
    v_cvt_pk_bf16_f32 v180, v168, v169
    v_cvt_pk_bf16_f32 v181, v170, v171
    v_cvt_pk_bf16_f32 v182, v172, v173
    v_cvt_pk_bf16_f32 v183, v174, v175
    s_cmp_gt_u32 s54, 7
    s_cbranch_scc0 L_ok_1045
    v_mov_b32 v144, 0xf149f2ca
    v_mov_b32 v145, 0xf149f2ca
    v_mov_b32 v146, 0xf149f2ca
    v_mov_b32 v147, 0xf149f2ca
    v_mov_b32 v148, 0xf149f2ca
    v_mov_b32 v149, 0xf149f2ca
    v_mov_b32 v150, 0xf149f2ca
    v_mov_b32 v151, 0xf149f2ca
    v_mov_b32 v152, 0xf149f2ca
    v_mov_b32 v153, 0xf149f2ca
    v_mov_b32 v154, 0xf149f2ca
    v_mov_b32 v155, 0xf149f2ca
    v_mov_b32 v156, 0xf149f2ca
    v_mov_b32 v157, 0xf149f2ca
    v_mov_b32 v158, 0xf149f2ca
    v_mov_b32 v159, 0xf149f2ca
L_ok_1045:
    v_exp_f32 v144, v144
    s_mov_b64 exec, s[96:97]
    ds_read_b128 v[128:131], v109 offset:7168
    ds_read_b128 v[132:135], v109 offset:7680
    s_mov_b64 exec, -1
    v_exp_f32 v145, v145
    v_exp_f32 v146, v146
    v_exp_f32 v147, v147
    v_exp_f32 v148, v148
    v_exp_f32 v149, v149
    s_waitcnt lgkmcnt(2)
    v_mfma_f32_32x32x16_bf16 v[32:47], v[56:59], v[176:179], v[32:47]
    v_exp_f32 v150, v150
    v_exp_f32 v151, v151
    v_exp_f32 v152, v152
    v_exp_f32 v153, v153
    v_exp_f32 v154, v154
    v_exp_f32 v155, v155
    v_mfma_f32_32x32x16_bf16 v[32:47], v[60:63], v[180:183], v[32:47]
    v_exp_f32 v156, v156
    v_exp_f32 v157, v157
    v_exp_f32 v158, v158
    v_exp_f32 v159, v159
    v_cvt_pk_bf16_f32 v184, v144, v145
    v_cvt_pk_bf16_f32 v185, v146, v147
    v_cvt_pk_bf16_f32 v186, v148, v149
    v_cvt_pk_bf16_f32 v187, v150, v151
    v_cvt_pk_bf16_f32 v188, v152, v153
    v_cvt_pk_bf16_f32 v189, v154, v155
    v_cvt_pk_bf16_f32 v190, v156, v157
    v_cvt_pk_bf16_f32 v191, v158, v159
    s_waitcnt lgkmcnt(0)
    v_mfma_f32_32x32x16_bf16 v[32:47], v[128:131], v[184:187], v[32:47]
    s_lshl_b32 s56, s51, 3
    s_add_u32 s56, s56, s44
    s_lshl_b32 s56, s56, 5
    s_add_u32 s56, s56, s50
    v_mfma_f32_32x32x16_bf16 v[32:47], v[132:135], v[188:191], v[32:47]
    s_lshl_b32 s56, s56, 10
    s_add_u32 s56, s56, 27262976
    s_andn2_b32 s59, s56, 0x1fff
    s_add_u32 s56, s56, s59
    s_andn2_b32 s59, s56, 0x1fffff
    s_add_u32 s56, s56, s59
    s_add_u32 s56, s56, s25
    s_nop 4
    v_mov_b32 v41, 0x67800000
    s_branch L_attj_34
L_redo_101021:
    s_waitcnt lgkmcnt(8)
    v_mfma_f32_32x32x16_bf16 v[144:159], v[64:67], v[20:23], 0
    s_waitcnt lgkmcnt(7)
    v_mfma_f32_32x32x16_bf16 v[128:143], v[68:71], v[20:23], 0
    s_waitcnt lgkmcnt(6)
    v_mfma_f32_32x32x16_bf16 v[160:175], v[72:75], v[20:23], 0
    s_nop 9
    s_cmp_gt_u32 s54, 0
    s_cbranch_scc0 L_ok_2046
    v_mov_b32 v144, 0xf149f2ca
    v_mov_b32 v145, 0xf149f2ca
    v_mov_b32 v146, 0xf149f2ca
    v_mov_b32 v147, 0xf149f2ca
    v_mov_b32 v148, 0xf149f2ca
    v_mov_b32 v149, 0xf149f2ca
    v_mov_b32 v150, 0xf149f2ca
    v_mov_b32 v151, 0xf149f2ca
    v_mov_b32 v152, 0xf149f2ca
    v_mov_b32 v153, 0xf149f2ca
    v_mov_b32 v154, 0xf149f2ca
    v_mov_b32 v155, 0xf149f2ca
    v_mov_b32 v156, 0xf149f2ca
    v_mov_b32 v157, 0xf149f2ca
    v_mov_b32 v158, 0xf149f2ca
    v_mov_b32 v159, 0xf149f2ca
L_ok_2046:
    v_cndmask_b32 v128, v144, v128, s[64:65]
    v_cndmask_b32 v129, v145, v129, s[66:67]
    v_cndmask_b32 v130, v146, v130, s[68:69]
    v_cndmask_b32 v131, v147, v131, s[70:71]
    v_cndmask_b32 v132, v148, v132, s[72:73]
    v_cndmask_b32 v133, v149, v133, s[74:75]
    s_waitcnt lgkmcnt(0)
    v_mfma_f32_32x32x16_bf16 v[176:191], v[76:79], v[20:23], 0
    v_cndmask_b32 v134, v150, v134, s[76:77]
    v_cndmask_b32 v135, v151, v135, s[78:79]
    v_cndmask_b32 v136, v152, v136, s[80:81]
    v_cndmask_b32 v137, v153, v137, s[82:83]
    v_cndmask_b32 v138, v154, v138, s[84:85]
    v_cndmask_b32 v139, v155, v139, s[86:87]
    v_cndmask_b32 v140, v156, v140, s[88:89]
    v_cndmask_b32 v141, v157, v141, s[90:91]
    v_cndmask_b32 v142, v158, v142, s[92:93]
    v_cndmask_b32 v143, v159, v143, s[94:95]
    v_mfma_f32_32x32x16_bf16 v[144:159], v[80:83], v[20:23], 0
    v_max_f32 v100, v128, v129
    v_max_f32 v101, v130, v131
    v_max3_f32 v100, v132, v133, v100
    v_max3_f32 v101, v134, v135, v101
    v_max3_f32 v100, v136, v137, v100
    v_max3_f32 v101, v138, v139, v101
    v_max3_f32 v100, v140, v141, v100
    v_max3_f32 v101, v142, v143, v101
    s_cmp_gt_u32 s54, 1
    s_cbranch_scc0 L_ok_2047
    v_mov_b32 v160, 0xf149f2ca
    v_mov_b32 v161, 0xf149f2ca
    v_mov_b32 v162, 0xf149f2ca
    v_mov_b32 v163, 0xf149f2ca
    v_mov_b32 v164, 0xf149f2ca
    v_mov_b32 v165, 0xf149f2ca
    v_mov_b32 v166, 0xf149f2ca
    v_mov_b32 v167, 0xf149f2ca
    v_mov_b32 v168, 0xf149f2ca
    v_mov_b32 v169, 0xf149f2ca
    v_mov_b32 v170, 0xf149f2ca
    v_mov_b32 v171, 0xf149f2ca
    v_mov_b32 v172, 0xf149f2ca
    v_mov_b32 v173, 0xf149f2ca
    v_mov_b32 v174, 0xf149f2ca
    v_mov_b32 v175, 0xf149f2ca
L_ok_2047:
    v_max3_f32 v100, v160, v161, v100
    v_max3_f32 v101, v162, v163, v101
    v_max3_f32 v100, v164, v165, v100
    v_max3_f32 v101, v166, v167, v101
    v_max3_f32 v100, v168, v169, v100
    v_max3_f32 v101, v170, v171, v101
    v_max3_f32 v100, v172, v173, v100
    v_max3_f32 v101, v174, v175, v101
    v_mfma_f32_32x32x16_bf16 v[160:175], v[84:87], v[20:23], 0
    s_cmp_gt_u32 s54, 2
    s_cbranch_scc0 L_ok_2048
    v_mov_b32 v176, 0xf149f2ca
    v_mov_b32 v177, 0xf149f2ca
    v_mov_b32 v178, 0xf149f2ca
    v_mov_b32 v179, 0xf149f2ca
    v_mov_b32 v180, 0xf149f2ca
    v_mov_b32 v181, 0xf149f2ca
    v_mov_b32 v182, 0xf149f2ca
    v_mov_b32 v183, 0xf149f2ca
    v_mov_b32 v184, 0xf149f2ca
    v_mov_b32 v185, 0xf149f2ca
    v_mov_b32 v186, 0xf149f2ca
    v_mov_b32 v187, 0xf149f2ca
    v_mov_b32 v188, 0xf149f2ca
    v_mov_b32 v189, 0xf149f2ca
    v_mov_b32 v190, 0xf149f2ca
    v_mov_b32 v191, 0xf149f2ca
L_ok_2048:
    v_max3_f32 v100, v176, v177, v100
    v_max3_f32 v101, v178, v179, v101
    v_max3_f32 v100, v180, v181, v100
    v_max3_f32 v101, v182, v183, v101
    v_max3_f32 v100, v184, v185, v100
    v_max3_f32 v101, v186, v187, v101
    v_max3_f32 v100, v188, v189, v100
    v_max3_f32 v101, v190, v191, v101
    v_mfma_f32_32x32x16_bf16 v[176:191], v[88:91], v[20:23], 0
    s_cmp_gt_u32 s54, 3
    s_cbranch_scc0 L_ok_2049
    v_mov_b32 v144, 0xf149f2ca
    v_mov_b32 v145, 0xf149f2ca
    v_mov_b32 v146, 0xf149f2ca
    v_mov_b32 v147, 0xf149f2ca
    v_mov_b32 v148, 0xf149f2ca
    v_mov_b32 v149, 0xf149f2ca
    v_mov_b32 v150, 0xf149f2ca
    v_mov_b32 v151, 0xf149f2ca
    v_mov_b32 v152, 0xf149f2ca
    v_mov_b32 v153, 0xf149f2ca
    v_mov_b32 v154, 0xf149f2ca
    v_mov_b32 v155, 0xf149f2ca
    v_mov_b32 v156, 0xf149f2ca
    v_mov_b32 v157, 0xf149f2ca
    v_mov_b32 v158, 0xf149f2ca
    v_mov_b32 v159, 0xf149f2ca
L_ok_2049:
    v_max3_f32 v100, v144, v145, v100
    v_max3_f32 v101, v146, v147, v101
    v_max3_f32 v100, v148, v149, v100
    v_max3_f32 v101, v150, v151, v101
    v_max3_f32 v100, v152, v153, v100
    v_max3_f32 v101, v154, v155, v101
    v_max3_f32 v100, v156, v157, v100
    v_max3_f32 v101, v158, v159, v101
    v_mfma_f32_32x32x16_bf16 v[144:159], v[92:95], v[20:23], 0
    s_cmp_gt_u32 s54, 4
    s_cbranch_scc0 L_ok_2050
    v_mov_b32 v160, 0xf149f2ca
    v_mov_b32 v161, 0xf149f2ca
    v_mov_b32 v162, 0xf149f2ca
    v_mov_b32 v163, 0xf149f2ca
    v_mov_b32 v164, 0xf149f2ca
    v_mov_b32 v165, 0xf149f2ca
    v_mov_b32 v166, 0xf149f2ca
    v_mov_b32 v167, 0xf149f2ca
    v_mov_b32 v168, 0xf149f2ca
    v_mov_b32 v169, 0xf149f2ca
    v_mov_b32 v170, 0xf149f2ca
    v_mov_b32 v171, 0xf149f2ca
    v_mov_b32 v172, 0xf149f2ca
    v_mov_b32 v173, 0xf149f2ca
    v_mov_b32 v174, 0xf149f2ca
    v_mov_b32 v175, 0xf149f2ca
L_ok_2050:
    v_max3_f32 v100, v160, v161, v100
    v_max3_f32 v101, v162, v163, v101
    v_max3_f32 v100, v164, v165, v100
    v_max3_f32 v101, v166, v167, v101
    v_max3_f32 v100, v168, v169, v100
    v_max3_f32 v101, v170, v171, v101
    v_max3_f32 v100, v172, v173, v100
    v_max3_f32 v101, v174, v175, v101
    v_mfma_f32_32x32x16_bf16 v[160:175], v[96:99], v[20:23], 0
    s_cmp_gt_u32 s54, 5
    s_cbranch_scc0 L_ok_2051
    v_mov_b32 v176, 0xf149f2ca
    v_mov_b32 v177, 0xf149f2ca
    v_mov_b32 v178, 0xf149f2ca
    v_mov_b32 v179, 0xf149f2ca
    v_mov_b32 v180, 0xf149f2ca
    v_mov_b32 v181, 0xf149f2ca
    v_mov_b32 v182, 0xf149f2ca
    v_mov_b32 v183, 0xf149f2ca
    v_mov_b32 v184, 0xf149f2ca
    v_mov_b32 v185, 0xf149f2ca
    v_mov_b32 v186, 0xf149f2ca
    v_mov_b32 v187, 0xf149f2ca
    v_mov_b32 v188, 0xf149f2ca
    v_mov_b32 v189, 0xf149f2ca
    v_mov_b32 v190, 0xf149f2ca
    v_mov_b32 v191, 0xf149f2ca
L_ok_2051:
    v_max3_f32 v100, v176, v177, v100
    v_max3_f32 v101, v178, v179, v101
    v_max3_f32 v100, v180, v181, v100
    v_max3_f32 v101, v182, v183, v101
    v_max3_f32 v100, v184, v185, v100
    v_max3_f32 v101, v186, v187, v101
    v_max3_f32 v100, v188, v189, v100
    v_max3_f32 v101, v190, v191, v101
    s_cmp_gt_u32 s54, 6
    s_cbranch_scc0 L_ok_2052
    v_mov_b32 v144, 0xf149f2ca
    v_mov_b32 v145, 0xf149f2ca
    v_mov_b32 v146, 0xf149f2ca
    v_mov_b32 v147, 0xf149f2ca
    v_mov_b32 v148, 0xf149f2ca
    v_mov_b32 v149, 0xf149f2ca
    v_mov_b32 v150, 0xf149f2ca
    v_mov_b32 v151, 0xf149f2ca
    v_mov_b32 v152, 0xf149f2ca
    v_mov_b32 v153, 0xf149f2ca
    v_mov_b32 v154, 0xf149f2ca
    v_mov_b32 v155, 0xf149f2ca
    v_mov_b32 v156, 0xf149f2ca
    v_mov_b32 v157, 0xf149f2ca
    v_mov_b32 v158, 0xf149f2ca
    v_mov_b32 v159, 0xf149f2ca
L_ok_2052:
    v_max3_f32 v100, v144, v145, v100
    v_max3_f32 v101, v146, v147, v101
    v_max3_f32 v100, v148, v149, v100
    v_max3_f32 v101, v150, v151, v101
    v_max3_f32 v100, v152, v153, v100
    v_max3_f32 v101, v154, v155, v101
    v_max3_f32 v100, v156, v157, v100
    v_max3_f32 v101, v158, v159, v101
    s_cmp_gt_u32 s54, 7
    s_cbranch_scc0 L_ok_2053
    v_mov_b32 v160, 0xf149f2ca
    v_mov_b32 v161, 0xf149f2ca
    v_mov_b32 v162, 0xf149f2ca
    v_mov_b32 v163, 0xf149f2ca
    v_mov_b32 v164, 0xf149f2ca
    v_mov_b32 v165, 0xf149f2ca
    v_mov_b32 v166, 0xf149f2ca
    v_mov_b32 v167, 0xf149f2ca
    v_mov_b32 v168, 0xf149f2ca
    v_mov_b32 v169, 0xf149f2ca
    v_mov_b32 v170, 0xf149f2ca
    v_mov_b32 v171, 0xf149f2ca
    v_mov_b32 v172, 0xf149f2ca
    v_mov_b32 v173, 0xf149f2ca
    v_mov_b32 v174, 0xf149f2ca
    v_mov_b32 v175, 0xf149f2ca
L_ok_2053:
    v_max3_f32 v100, v160, v161, v100
    v_max3_f32 v101, v162, v163, v101
    v_max3_f32 v100, v164, v165, v100
    v_max3_f32 v101, v166, v167, v101
    v_max3_f32 v100, v168, v169, v100
    v_max3_f32 v101, v170, v171, v101
    v_max3_f32 v100, v172, v173, v100
    v_max3_f32 v101, v174, v175, v101
    v_max_f32 v100, v100, v101
    v_mov_b32 v101, v100
    s_nop 1
    v_permlane32_swap_b32 v100, v101
    s_nop 0
    v_max_f32 v100, v100, v101
    v_sub_f32 v112, 0, v100
    v_mov_b32 v113, v112
    v_mov_b32 v114, v112
    v_mov_b32 v115, v112
    v_mov_b32 v116, v112
    v_mov_b32 v117, v112
    v_mov_b32 v118, v112
    v_mov_b32 v119, v112
    v_mov_b32 v120, v112
    v_mov_b32 v121, v112
    v_mov_b32 v122, v112
    v_mov_b32 v123, v112
    v_mov_b32 v124, v112
    v_mov_b32 v125, v112
    v_mov_b32 v126, v112
    v_mov_b32 v127, v112
    v_add_f32 v128, v128, v112
    v_add_f32 v129, v129, v113
    v_mfma_f32_32x32x16_bf16 v[144:159], v[72:75], v[20:23], v[112:127]
    v_add_f32 v130, v130, v114
    v_add_f32 v131, v131, v115
    v_add_f32 v132, v132, v116
    v_add_f32 v133, v133, v117
    v_add_f32 v134, v134, v118
    v_add_f32 v135, v135, v119
    v_add_f32 v136, v136, v120
    v_add_f32 v137, v137, v121
    v_add_f32 v138, v138, v122
    v_add_f32 v139, v139, v123
    v_add_f32 v140, v140, v124
    v_add_f32 v141, v141, v125
    v_add_f32 v142, v142, v126
    v_add_f32 v143, v143, v127
    v_exp_f32 v128, v128
    v_exp_f32 v129, v129
    v_exp_f32 v130, v130
    v_exp_f32 v131, v131
    v_exp_f32 v132, v132
    v_exp_f32 v133, v133
    v_exp_f32 v134, v134
    v_exp_f32 v135, v135
    v_exp_f32 v136, v136
    v_exp_f32 v137, v137
    v_exp_f32 v138, v138
    v_exp_f32 v139, v139
    v_exp_f32 v140, v140
    v_exp_f32 v141, v141
    v_exp_f32 v142, v142
    v_exp_f32 v143, v143
    v_cvt_pk_bf16_f32 v200, v128, v129
    v_cvt_pk_bf16_f32 v201, v130, v131
    v_cvt_pk_bf16_f32 v202, v132, v133
    v_cvt_pk_bf16_f32 v203, v134, v135
    v_cvt_pk_bf16_f32 v204, v136, v137
    v_cvt_pk_bf16_f32 v205, v138, v139
    v_cvt_pk_bf16_f32 v206, v140, v141
    v_cvt_pk_bf16_f32 v207, v142, v143
    v_mov_b32 v128, 0x3f803f80
    v_mov_b32 v129, v128
    v_mov_b32 v130, v128
    v_mov_b32 v131, v128
    v_mov_b32 v132, v128
    v_mov_b32 v133, v128
    v_mov_b32 v134, v128
    v_mov_b32 v135, v128
    s_mov_b64 exec, s[96:97]
    ds_read_b128 v[48:51], v109 offset:8192
    ds_read_b128 v[52:55], v109 offset:8704
    ds_read_b128 v[56:59], v109 offset:0
    ds_read_b128 v[60:63], v109 offset:512
    s_mov_b64 exec, -1
    v_and_b32 v192, v200, v24
    v_and_b32 v193, v201, v25
    v_and_b32 v194, v202, v26
    v_and_b32 v195, v203, v27
    v_and_b32 v196, v204, v28
    v_and_b32 v197, v205, v29
    v_and_b32 v198, v206, v30
    v_and_b32 v199, v207, v31
    v_xor_b32 v200, v200, v192
    v_xor_b32 v201, v201, v193
    v_xor_b32 v202, v202, v194
    v_xor_b32 v203, v203, v195
    v_xor_b32 v204, v204, v196
    v_xor_b32 v205, v205, v197
    v_xor_b32 v206, v206, v198
    v_xor_b32 v207, v207, v199
    s_cmp_gt_u32 s54, 1
    s_cbranch_scc0 L_ok_2054
    v_mov_b32 v144, 0xf149f2ca
    v_mov_b32 v145, 0xf149f2ca
    v_mov_b32 v146, 0xf149f2ca
    v_mov_b32 v147, 0xf149f2ca
    v_mov_b32 v148, 0xf149f2ca
    v_mov_b32 v149, 0xf149f2ca
    v_mov_b32 v150, 0xf149f2ca
    v_mov_b32 v151, 0xf149f2ca
    v_mov_b32 v152, 0xf149f2ca
    v_mov_b32 v153, 0xf149f2ca
    v_mov_b32 v154, 0xf149f2ca
    v_mov_b32 v155, 0xf149f2ca
    v_mov_b32 v156, 0xf149f2ca
    v_mov_b32 v157, 0xf149f2ca
    v_mov_b32 v158, 0xf149f2ca
    v_mov_b32 v159, 0xf149f2ca
L_ok_2054:
    v_mfma_f32_32x32x16_bf16 v[160:175], v[76:79], v[20:23], v[112:127]
    v_exp_f32 v144, v144
    s_mov_b64 exec, s[96:97]
    ds_read_b128 v[128:131], v109 offset:1024
    ds_read_b128 v[132:135], v109 offset:1536
    s_mov_b64 exec, -1
    v_exp_f32 v145, v145
    v_exp_f32 v146, v146
    v_exp_f32 v147, v147
    s_waitcnt lgkmcnt(4)
    v_mfma_f32_32x32x16_bf16 v[32:47], v[48:51], v[192:195], 0
    v_exp_f32 v148, v148
    v_exp_f32 v149, v149
    v_exp_f32 v150, v150
    v_exp_f32 v151, v151
    v_mfma_f32_32x32x16_bf16 v[32:47], v[52:55], v[196:199], v[32:47]
    v_exp_f32 v152, v152
    v_exp_f32 v153, v153
    v_exp_f32 v154, v154
    v_exp_f32 v155, v155
    s_waitcnt lgkmcnt(2)
    v_mfma_f32_32x32x16_bf16 v[32:47], v[56:59], v[200:203], v[32:47]
    v_exp_f32 v156, v156
    v_exp_f32 v157, v157
    v_exp_f32 v158, v158
    v_exp_f32 v159, v159
    v_mfma_f32_32x32x16_bf16 v[32:47], v[60:63], v[204:207], v[32:47]
    v_cvt_pk_bf16_f32 v184, v144, v145
    v_cvt_pk_bf16_f32 v185, v146, v147
    v_cvt_pk_bf16_f32 v186, v148, v149
    v_cvt_pk_bf16_f32 v187, v150, v151
    v_cvt_pk_bf16_f32 v188, v152, v153
    v_cvt_pk_bf16_f32 v189, v154, v155
    v_cvt_pk_bf16_f32 v190, v156, v157
    v_cvt_pk_bf16_f32 v191, v158, v159
    s_cmp_gt_u32 s54, 2
    s_cbranch_scc0 L_ok_2055
    v_mov_b32 v160, 0xf149f2ca
    v_mov_b32 v161, 0xf149f2ca
    v_mov_b32 v162, 0xf149f2ca
    v_mov_b32 v163, 0xf149f2ca
    v_mov_b32 v164, 0xf149f2ca
    v_mov_b32 v165, 0xf149f2ca
    v_mov_b32 v166, 0xf149f2ca
    v_mov_b32 v167, 0xf149f2ca
    v_mov_b32 v168, 0xf149f2ca
    v_mov_b32 v169, 0xf149f2ca
    v_mov_b32 v170, 0xf149f2ca
    v_mov_b32 v171, 0xf149f2ca
    v_mov_b32 v172, 0xf149f2ca
    v_mov_b32 v173, 0xf149f2ca
    v_mov_b32 v174, 0xf149f2ca
    v_mov_b32 v175, 0xf149f2ca
L_ok_2055:
    v_mfma_f32_32x32x16_bf16 v[144:159], v[80:83], v[20:23], v[112:127]
    v_exp_f32 v160, v160
    s_mov_b64 exec, s[96:97]
    ds_read_b128 v[48:51], v109 offset:2048
    ds_read_b128 v[52:55], v109 offset:2560
    s_mov_b64 exec, -1
    v_exp_f32 v161, v161
    v_exp_f32 v162, v162
    v_exp_f32 v163, v163
    v_exp_f32 v164, v164
    v_exp_f32 v165, v165
    s_waitcnt lgkmcnt(2)
    v_mfma_f32_32x32x16_bf16 v[32:47], v[128:131], v[184:187], v[32:47]
    v_exp_f32 v166, v166
    v_exp_f32 v167, v167
    v_exp_f32 v168, v168
    v_exp_f32 v169, v169
    v_exp_f32 v170, v170
    v_exp_f32 v171, v171
    v_mfma_f32_32x32x16_bf16 v[32:47], v[132:135], v[188:191], v[32:47]
    v_exp_f32 v172, v172
    v_exp_f32 v173, v173
    v_exp_f32 v174, v174
    v_exp_f32 v175, v175
    v_cvt_pk_bf16_f32 v176, v160, v161
    v_cvt_pk_bf16_f32 v177, v162, v163
    v_cvt_pk_bf16_f32 v178, v164, v165
    v_cvt_pk_bf16_f32 v179, v166, v167
    v_cvt_pk_bf16_f32 v180, v168, v169
    v_cvt_pk_bf16_f32 v181, v170, v171
    v_cvt_pk_bf16_f32 v182, v172, v173
    v_cvt_pk_bf16_f32 v183, v174, v175
    s_cmp_gt_u32 s54, 3
    s_cbranch_scc0 L_ok_2056
    v_mov_b32 v144, 0xf149f2ca
    v_mov_b32 v145, 0xf149f2ca
    v_mov_b32 v146, 0xf149f2ca
    v_mov_b32 v147, 0xf149f2ca
    v_mov_b32 v148, 0xf149f2ca
    v_mov_b32 v149, 0xf149f2ca
    v_mov_b32 v150, 0xf149f2ca
    v_mov_b32 v151, 0xf149f2ca
    v_mov_b32 v152, 0xf149f2ca
    v_mov_b32 v153, 0xf149f2ca
    v_mov_b32 v154, 0xf149f2ca
    v_mov_b32 v155, 0xf149f2ca
    v_mov_b32 v156, 0xf149f2ca
    v_mov_b32 v157, 0xf149f2ca
    v_mov_b32 v158, 0xf149f2ca
    v_mov_b32 v159, 0xf149f2ca
L_ok_2056:
    v_mfma_f32_32x32x16_bf16 v[160:175], v[84:87], v[20:23], v[112:127]
    v_exp_f32 v144, v144
    s_mov_b64 exec, s[96:97]
    ds_read_b128 v[56:59], v109 offset:3072
    ds_read_b128 v[60:63], v109 offset:3584
    s_mov_b64 exec, -1
    v_exp_f32 v145, v145
    v_exp_f32 v146, v146
    v_exp_f32 v147, v147
    v_exp_f32 v148, v148
    v_exp_f32 v149, v149
    s_waitcnt lgkmcnt(2)
    v_mfma_f32_32x32x16_bf16 v[32:47], v[48:51], v[176:179], v[32:47]
    v_exp_f32 v150, v150
    v_exp_f32 v151, v151
    v_exp_f32 v152, v152
    v_exp_f32 v153, v153
    v_exp_f32 v154, v154
    v_exp_f32 v155, v155
    v_mfma_f32_32x32x16_bf16 v[32:47], v[52:55], v[180:183], v[32:47]
    v_exp_f32 v156, v156
    v_exp_f32 v157, v157
    v_exp_f32 v158, v158
    v_exp_f32 v159, v159
    v_cvt_pk_bf16_f32 v184, v144, v145
    v_cvt_pk_bf16_f32 v185, v146, v147
    v_cvt_pk_bf16_f32 v186, v148, v149
    v_cvt_pk_bf16_f32 v187, v150, v151
    v_cvt_pk_bf16_f32 v188, v152, v153
    v_cvt_pk_bf16_f32 v189, v154, v155
    v_cvt_pk_bf16_f32 v190, v156, v157
    v_cvt_pk_bf16_f32 v191, v158, v159
    s_cmp_gt_u32 s54, 4
    s_cbranch_scc0 L_ok_2057
    v_mov_b32 v160, 0xf149f2ca
    v_mov_b32 v161, 0xf149f2ca
    v_mov_b32 v162, 0xf149f2ca
    v_mov_b32 v163, 0xf149f2ca
    v_mov_b32 v164, 0xf149f2ca
    v_mov_b32 v165, 0xf149f2ca
    v_mov_b32 v166, 0xf149f2ca
    v_mov_b32 v167, 0xf149f2ca
    v_mov_b32 v168, 0xf149f2ca
    v_mov_b32 v169, 0xf149f2ca
    v_mov_b32 v170, 0xf149f2ca
    v_mov_b32 v171, 0xf149f2ca
    v_mov_b32 v172, 0xf149f2ca
    v_mov_b32 v173, 0xf149f2ca
    v_mov_b32 v174, 0xf149f2ca
    v_mov_b32 v175, 0xf149f2ca
L_ok_2057:
    v_mfma_f32_32x32x16_bf16 v[144:159], v[88:91], v[20:23], v[112:127]
    v_exp_f32 v160, v160
    s_mov_b64 exec, s[96:97]
    ds_read_b128 v[128:131], v109 offset:4096
    ds_read_b128 v[132:135], v109 offset:4608
    s_mov_b64 exec, -1
    v_exp_f32 v161, v161
    v_exp_f32 v162, v162
    v_exp_f32 v163, v163
    v_exp_f32 v164, v164
    v_exp_f32 v165, v165
    s_waitcnt lgkmcnt(2)
    v_mfma_f32_32x32x16_bf16 v[32:47], v[56:59], v[184:187], v[32:47]
    v_exp_f32 v166, v166
    v_exp_f32 v167, v167
    v_exp_f32 v168, v168
    v_exp_f32 v169, v169
    v_exp_f32 v170, v170
    v_exp_f32 v171, v171
    v_mfma_f32_32x32x16_bf16 v[32:47], v[60:63], v[188:191], v[32:47]
    v_exp_f32 v172, v172
    v_exp_f32 v173, v173
    v_exp_f32 v174, v174
    v_exp_f32 v175, v175
    v_cvt_pk_bf16_f32 v176, v160, v161
    v_cvt_pk_bf16_f32 v177, v162, v163
    v_cvt_pk_bf16_f32 v178, v164, v165
    v_cvt_pk_bf16_f32 v179, v166, v167
    v_cvt_pk_bf16_f32 v180, v168, v169
    v_cvt_pk_bf16_f32 v181, v170, v171
    v_cvt_pk_bf16_f32 v182, v172, v173
    v_cvt_pk_bf16_f32 v183, v174, v175
    s_cmp_gt_u32 s54, 5
    s_cbranch_scc0 L_ok_2058
    v_mov_b32 v144, 0xf149f2ca
    v_mov_b32 v145, 0xf149f2ca
    v_mov_b32 v146, 0xf149f2ca
    v_mov_b32 v147, 0xf149f2ca
    v_mov_b32 v148, 0xf149f2ca
    v_mov_b32 v149, 0xf149f2ca
    v_mov_b32 v150, 0xf149f2ca
    v_mov_b32 v151, 0xf149f2ca
    v_mov_b32 v152, 0xf149f2ca
    v_mov_b32 v153, 0xf149f2ca
    v_mov_b32 v154, 0xf149f2ca
    v_mov_b32 v155, 0xf149f2ca
    v_mov_b32 v156, 0xf149f2ca
    v_mov_b32 v157, 0xf149f2ca
    v_mov_b32 v158, 0xf149f2ca
    v_mov_b32 v159, 0xf149f2ca
L_ok_2058:
    v_mfma_f32_32x32x16_bf16 v[160:175], v[92:95], v[20:23], v[112:127]
    v_exp_f32 v144, v144
    s_mov_b64 exec, s[96:97]
    ds_read_b128 v[48:51], v109 offset:5120
    ds_read_b128 v[52:55], v109 offset:5632
    s_mov_b64 exec, -1
    v_exp_f32 v145, v145
    v_exp_f32 v146, v146
    v_exp_f32 v147, v147
    v_exp_f32 v148, v148
    v_exp_f32 v149, v149
    s_waitcnt lgkmcnt(2)
    v_mfma_f32_32x32x16_bf16 v[32:47], v[128:131], v[176:179], v[32:47]
    v_exp_f32 v150, v150
    v_exp_f32 v151, v151
    v_exp_f32 v152, v152
    v_exp_f32 v153, v153
    v_exp_f32 v154, v154
    v_exp_f32 v155, v155
    v_mfma_f32_32x32x16_bf16 v[32:47], v[132:135], v[180:183], v[32:47]
    v_exp_f32 v156, v156
    v_exp_f32 v157, v157
    v_exp_f32 v158, v158
    v_exp_f32 v159, v159
    v_cvt_pk_bf16_f32 v184, v144, v145
    v_cvt_pk_bf16_f32 v185, v146, v147
    v_cvt_pk_bf16_f32 v186, v148, v149
    v_cvt_pk_bf16_f32 v187, v150, v151
    v_cvt_pk_bf16_f32 v188, v152, v153
    v_cvt_pk_bf16_f32 v189, v154, v155
    v_cvt_pk_bf16_f32 v190, v156, v157
    v_cvt_pk_bf16_f32 v191, v158, v159
    s_cmp_gt_u32 s54, 6
    s_cbranch_scc0 L_ok_2059
    v_mov_b32 v160, 0xf149f2ca
    v_mov_b32 v161, 0xf149f2ca
    v_mov_b32 v162, 0xf149f2ca
    v_mov_b32 v163, 0xf149f2ca
    v_mov_b32 v164, 0xf149f2ca
    v_mov_b32 v165, 0xf149f2ca
    v_mov_b32 v166, 0xf149f2ca
    v_mov_b32 v167, 0xf149f2ca
    v_mov_b32 v168, 0xf149f2ca
    v_mov_b32 v169, 0xf149f2ca
    v_mov_b32 v170, 0xf149f2ca
    v_mov_b32 v171, 0xf149f2ca
    v_mov_b32 v172, 0xf149f2ca
    v_mov_b32 v173, 0xf149f2ca
    v_mov_b32 v174, 0xf149f2ca
    v_mov_b32 v175, 0xf149f2ca
L_ok_2059:
    v_mfma_f32_32x32x16_bf16 v[144:159], v[96:99], v[20:23], v[112:127]
    v_exp_f32 v160, v160
    s_mov_b64 exec, s[96:97]
    ds_read_b128 v[56:59], v109 offset:6144
    ds_read_b128 v[60:63], v109 offset:6656
    s_mov_b64 exec, -1
    v_exp_f32 v161, v161
    v_exp_f32 v162, v162
    v_exp_f32 v163, v163
    v_exp_f32 v164, v164
    v_exp_f32 v165, v165
    s_waitcnt lgkmcnt(2)
    v_mfma_f32_32x32x16_bf16 v[32:47], v[48:51], v[184:187], v[32:47]
    v_exp_f32 v166, v166
    v_exp_f32 v167, v167
    v_exp_f32 v168, v168
    v_exp_f32 v169, v169
    v_exp_f32 v170, v170
    v_exp_f32 v171, v171
    v_mfma_f32_32x32x16_bf16 v[32:47], v[52:55], v[188:191], v[32:47]
    v_exp_f32 v172, v172
    v_exp_f32 v173, v173
    v_exp_f32 v174, v174
    v_exp_f32 v175, v175
    v_cvt_pk_bf16_f32 v176, v160, v161
    v_cvt_pk_bf16_f32 v177, v162, v163
    v_cvt_pk_bf16_f32 v178, v164, v165
    v_cvt_pk_bf16_f32 v179, v166, v167
    v_cvt_pk_bf16_f32 v180, v168, v169
    v_cvt_pk_bf16_f32 v181, v170, v171
    v_cvt_pk_bf16_f32 v182, v172, v173
    v_cvt_pk_bf16_f32 v183, v174, v175
    s_cmp_gt_u32 s54, 7
    s_cbranch_scc0 L_ok_2060
    v_mov_b32 v144, 0xf149f2ca
    v_mov_b32 v145, 0xf149f2ca
    v_mov_b32 v146, 0xf149f2ca
    v_mov_b32 v147, 0xf149f2ca
    v_mov_b32 v148, 0xf149f2ca
    v_mov_b32 v149, 0xf149f2ca
    v_mov_b32 v150, 0xf149f2ca
    v_mov_b32 v151, 0xf149f2ca
    v_mov_b32 v152, 0xf149f2ca
    v_mov_b32 v153, 0xf149f2ca
    v_mov_b32 v154, 0xf149f2ca
    v_mov_b32 v155, 0xf149f2ca
    v_mov_b32 v156, 0xf149f2ca
    v_mov_b32 v157, 0xf149f2ca
    v_mov_b32 v158, 0xf149f2ca
    v_mov_b32 v159, 0xf149f2ca
L_ok_2060:
    v_exp_f32 v144, v144
    s_mov_b64 exec, s[96:97]
    ds_read_b128 v[128:131], v109 offset:7168
    ds_read_b128 v[132:135], v109 offset:7680
    s_mov_b64 exec, -1
    v_exp_f32 v145, v145
    v_exp_f32 v146, v146
    v_exp_f32 v147, v147
    v_exp_f32 v148, v148
    v_exp_f32 v149, v149
    s_waitcnt lgkmcnt(2)
    v_mfma_f32_32x32x16_bf16 v[32:47], v[56:59], v[176:179], v[32:47]
    v_exp_f32 v150, v150
    v_exp_f32 v151, v151
    v_exp_f32 v152, v152
    v_exp_f32 v153, v153
    v_exp_f32 v154, v154
    v_exp_f32 v155, v155
    v_mfma_f32_32x32x16_bf16 v[32:47], v[60:63], v[180:183], v[32:47]
    v_exp_f32 v156, v156
    v_exp_f32 v157, v157
    v_exp_f32 v158, v158
    v_exp_f32 v159, v159
    v_cvt_pk_bf16_f32 v184, v144, v145
    v_cvt_pk_bf16_f32 v185, v146, v147
    v_cvt_pk_bf16_f32 v186, v148, v149
    v_cvt_pk_bf16_f32 v187, v150, v151
    v_cvt_pk_bf16_f32 v188, v152, v153
    v_cvt_pk_bf16_f32 v189, v154, v155
    v_cvt_pk_bf16_f32 v190, v156, v157
    v_cvt_pk_bf16_f32 v191, v158, v159
    s_waitcnt lgkmcnt(0)
    v_mfma_f32_32x32x16_bf16 v[32:47], v[128:131], v[184:187], v[32:47]
    s_lshl_b32 s56, s51, 3
    s_add_u32 s56, s56, s44
    s_lshl_b32 s56, s56, 5
    s_add_u32 s56, s56, s50
    v_mfma_f32_32x32x16_bf16 v[32:47], v[132:135], v[188:191], v[32:47]
    s_lshl_b32 s56, s56, 10
    s_add_u32 s56, s56, 27262976
    s_andn2_b32 s59, s56, 0x1fff
    s_add_u32 s56, s56, s59
    s_andn2_b32 s59, s56, 0x1fffff
    s_add_u32 s56, s56, s59
    s_add_u32 s56, s56, s25
    s_nop 4
    v_mov_b32 v41, 0x67800000
    s_cmp_eq_u32 s3, 1
    s_cbranch_scc1 L_attr_35
    s_branch L_attr_100010
L_fin_4:
L_end_1:
    s_endpgm
.section .rodata,"a"
.p2align 6
.amdhsa_kernel gated_mix__sliding_block__mixer_s_mlp__prompt_kernel
  .amdhsa_next_free_vgpr 256
  .amdhsa_next_free_sgpr 102
  .amdhsa_accum_offset 256
  .amdhsa_group_segment_fixed_size 0
  .amdhsa_kernarg_size 96
  .amdhsa_user_sgpr_count 2
  .amdhsa_user_sgpr_kernarg_segment_ptr 1
  .amdhsa_system_sgpr_workgroup_id_x 1
  .amdhsa_float_denorm_mode_32 3
.end_amdhsa_kernel
```
